```python
import torch

def _softmax(x, axis=-1):
    return torch.softmax(x, dim=axis)
def _gelu(x):
    return torch.nn.functional.gelu(x, approximate="tanh")
def _silu(x):
    return torch.nn.functional.silu(x)
def _sigmoid(x):
    return torch.sigmoid(x)
def _layernorm(x, axis=-1, eps=1e-5):
    m = x.mean(dim=axis, keepdim=True)
    v = x.var(dim=axis, keepdim=True, unbiased=False)
    return (x - m) / torch.sqrt(v + eps)
def _scatter_add(tgt, idx, src, axis=0):
    return tgt.clone().index_add_(axis, idx, src)
def _segment_sum(src, seg, n):
    out = torch.zeros((n,) + src.shape[1:], dtype=src.dtype)
    return out.index_add_(0, seg, src)
def _pad(x, pw):
    flat = tuple(v for pair in reversed(pw) for v in pair)
    return torch.nn.functional.pad(x, flat)

kernel_name = 'parallel_sum__grouped_kv_mqa__dense_activation_squared_relu__prompt'

def setup_inputs():

    _w = (lambda a: (lambda t: t.to(torch.bfloat16) if t.is_floating_point() else t)(torch.as_tensor(a)))
    def _A_setup():
        B, S, D, H = 1, 2048, 576, 32
        Dh = D // H
        return {
            "x": _w((lambda *s: torch.randn(*s, dtype=torch.bfloat16) * 0.05)(B, S, D)),
            "wq": _w((lambda *s: torch.randn(*s, dtype=torch.bfloat16) * 0.2)(D, H * Dh)),
            "wk": _w((lambda *s: torch.randn(*s, dtype=torch.bfloat16) * 0.2)(D, Dh)),
            "wv": _w((lambda *s: torch.randn(*s, dtype=torch.bfloat16) * 0.1)(D, Dh)),
            "wo": _w((lambda *s: torch.randn(*s, dtype=torch.bfloat16) * 0.1)(H * Dh, D)),
        }
    _A_in = _A_setup()

    def _B_setup():
        B, S, D, F = 1, 2048, 576, 4608
        return {
            "x": _w((lambda *s: torch.randn(*s, dtype=torch.bfloat16) * 0.05)(B, S, D)),
            "w1": _w((lambda *s: torch.randn(*s, dtype=torch.bfloat16) * 0.05)(D, F)),
            "b1": _w((lambda *s: torch.randn(*s, dtype=torch.bfloat16) * 0.8)(F)),
            "w2": _w((lambda *s: torch.randn(*s, dtype=torch.bfloat16) * 0.05)(F, D)),
            "b2": _w((lambda *s: torch.randn(*s, dtype=torch.bfloat16) * 12.8)(D)),
        }
    _B_in = _B_setup()

    return {
        "A_x": _A_in["x"],
        "A_wq": _A_in["wq"],
        "A_wk": _A_in["wk"],
        "A_wv": _A_in["wv"],
        "A_wo": _A_in["wo"],
        "B_x": _B_in["x"],
        "B_w1": _B_in["w1"],
        "B_b1": _B_in["b1"],
        "B_w2": _B_in["w2"],
        "B_b2": _B_in["b2"],
    }

def reference(A_x, A_wq, A_wk, A_wv, A_wo, B_x, B_w1, B_b1, B_w2, B_b2):
    def _A_ref(x, wq, wk, wv, wo):
        B, S, D = x.shape
        H = 32
        Dh = D // H
        q = (lambda x, *d: x.permute(*d))((x @ wq).reshape(B, S, H, Dh), 0, 2, 1, 3)
        k = x @ wk
        v = x @ wv
        scores = torch.einsum("bhqd,bkd->bhqk", q, k) * (Dh ** -0.5)
        p = _softmax(scores, axis=-1)
        o = torch.einsum("bhqk,bkd->bhqd", p, v)
        return (lambda x, *d: x.permute(*d))(o, 0, 2, 1, 3).reshape(B, S, H * Dh) @ wo

    def _B_ref(x, w1, b1, w2, b2):
        h = torch.einsum("bsd,df->bsf", x, w1) + b1
        zero = torch.zeros_like(h)
        r = torch.where(h > zero, h, zero)
        h = r * r
        out = torch.einsum("bsf,fd->bsd", h, w2) + b2
        return out

    x = A_x
    xn = _layernorm(x, axis=-1)
    return x + _A_ref(xn, A_wq, A_wk, A_wv, A_wo) + _B_ref(xn, B_w1, B_b1, B_w2, B_b2)
```

```asm
; @launch grid=(256,1,1) block=(512,1,1) lds=163840
.amdgcn_target "amdgcn-amd-amdhsa--gfx950"
.text

.globl parallel_sum__grouped_kv_mqa__dense_activation_squared_relu__prompt_kernel
.p2align 8
.type parallel_sum__grouped_kv_mqa__dense_activation_squared_relu__prompt_kernel,@function
parallel_sum__grouped_kv_mqa__dense_activation_squared_relu__prompt_kernel:
    s_cmp_ge_u32 s2, 256
    s_cbranch_scc1 LM_end
    s_load_dwordx16 s[16:31], s[0:1], 0
    s_load_dwordx8 s[32:39], s[0:1], 64
    s_load_dwordx2 s[40:41], s[0:1], 96
    v_and_b32 v1, 63, v0
    v_lshrrev_b32 v2, 6, v0
    s_lshr_b32 s8, s2, 3
    s_and_b32 s9, s2, 3
    s_lshl_b32 s9, s9, 1
    s_and_b32 s10, s8, 1
    s_add_u32 s5, s9, s10
    s_bfe_u32 s9, s2, 0x10002
    s_lshl_b32 s9, s9, 4
    s_lshr_b32 s10, s8, 1
    s_add_u32 s4, s9, s10
    v_readfirstlane_b32 s6, v2
    s_mov_b32 s80, -1
    s_mov_b32 s81, 0
    s_mov_b32 s82, 0
    s_mov_b32 s83, -1
    s_and_b32 s7, s6, 3
    s_mov_b32 s3, s4
    s_waitcnt lgkmcnt(0)
    s_mov_b32 s44, s16
    s_and_b32 s45, s17, 0xffff
    s_mov_b32 s46, 2359296
    s_mov_b32 s47, 0x00020000
    s_mov_b32 s68, s40
    s_and_b32 s69, s41, 0xffff
    s_mov_b32 s70, 33554432
    s_mov_b32 s71, 0x00020000
    s_cmp_lg_u32 s6, 0
    s_cbranch_scc1 LM_noflag_1
    v_lshlrev_b32 v5, 2, v1
    v_and_b32 v5, 127, v5
    v_add_u32 v5, 163712, v5
    v_mov_b32 v6, 0
    ds_write_b32 v5, v6
    s_waitcnt lgkmcnt(0)
LM_noflag_1:
    s_barrier
    s_cmp_ge_u32 s6, 4
    s_cbranch_scc1 LM_fwaves_2
    s_lshr_b32 s3, s7, 1
    s_lshl_b32 s3, s3, 4
    s_xor_b32 s3, s3, s4
    s_bitcmp1_b32 s7, 0
    s_cbranch_scc1 LM_tc_3
    s_mov_b32 s48, s18
    s_and_b32 s49, s19, 0xffff
    s_mov_b32 s50, 663552
    s_mov_b32 s51, 0x00020000
    v_min_u32 v5, 53, v1
    v_mul_u32_u24 v6, 21846, v5
    v_lshrrev_b32 v6, 16, v6
    v_mul_u32_u24 v7, 3, v6
    v_sub_u32 v7, v5, v7
    v_mul_u32_u24 v6, 1152, v6
    v_lshl_add_u32 v6, v7, 6, v6
    s_mul_i32 s9, s3, 20736
    s_mul_i32 s10, s5, 144
    s_add_u32 s9, s9, s10
    buffer_load_dword v252, v6, s[48:51], s9 offen offset:12
    s_branch LM_tcd_4
LM_tc_3:
    s_mov_b32 s60, s24
    s_and_b32 s61, s25, 0xffff
    s_mov_b32 s62, 663552
    s_mov_b32 s63, 0x00020000
    v_min_u32 v6, 26, v1
    v_lshlrev_b32 v6, 7, v6
    s_mul_i32 s9, s5, 82944
    s_mul_i32 s10, s3, 3456
    s_add_u32 s9, s9, s10
    buffer_load_dword v252, v6, s[60:63], s9 offen
LM_tcd_4:
    v_and_b32 v2, 31, v1
    v_lshrrev_b32 v3, 5, v1
    v_bfe_u32 v4, v2, 1, 3
    v_xor_b32 v4, v4, v3
    v_mul_u32_u24 v5, 1152, v2
    v_xor_b32 v6, 0, v4
    v_lshl_add_u32 v160, v6, 4, v5
    v_xor_b32 v6, 2, v4
    v_lshl_add_u32 v161, v6, 4, v5
    v_xor_b32 v6, 4, v4
    v_lshl_add_u32 v162, v6, 4, v5
    v_xor_b32 v6, 6, v4
    v_lshl_add_u32 v163, v6, 4, v5
    v_bfe_u32 v4, v1, 2, 2
    v_lshl_add_u32 v4, v3, 2, v4
    v_bfe_u32 v5, v1, 4, 1
    v_and_b32 v6, 3, v1
    v_lshl_add_u32 v5, v5, 2, v6
    s_mul_i32 s9, s7, 36
    s_and_b32 s10, s7, 1
    s_lshl_b32 s10, s10, 2
    s_sub_u32 s9, s9, s10
    s_add_u32 s9, s9, 73728
    s_mov_b32 s11, 1145319712
    s_cmp_lg_u32 s10, 0
    s_cselect_b32 s11, 1145188640, s11
    v_lshlrev_b32 v5, 2, v5
    v_bfe_u32 v5, s11, v5, 4
    v_lshlrev_b32 v6, 3, v5
    v_add_u32 v6, s9, v6
    v_mul_u32_u24 v4, 144, v4
    v_add_u32 v164, v4, v6
    v_add_u32 v165, 59904, v164
    v_and_b32 v4, 3, v1
    v_lshlrev_b32 v4, 2, v4
    v_add_u32 v181, 163712, v4
    s_lshl_b32 s9, s7, 2
    s_add_u32 s9, s9, 163712
    v_mov_b32 v183, s9
    v_mov_b32 v200, 1
    v_add_u32 v166, 112, v183
    v_add_u32 v167, 112, v181
    v_lshrrev_b32 v2, 3, v1
    v_and_b32 v3, 7, v1
    v_mul_u32_u24 v4, 1152, v2
    v_lshl_add_u32 v4, v3, 4, v4
    s_lshl_b32 s11, s7, 4
    s_add_u32 s12, s11, 8
    v_and_b32 v48, 3, v1
    v_lshlrev_b32 v48, 2, v48
    v_add_u32 v48, 163776, v48
    s_lshr_b32 s9, s5, 1
    s_cmp_eq_u32 s9, s7
    s_cbranch_scc1 LM_lnskip_5
    s_lshl_b32 s8, s4, 6
    s_add_u32 s8, s8, s11
    s_mul_i32 s8, s8, 1152
    buffer_load_dwordx4 v[8:11], v4, s[44:47], s8 offen offset:0
    buffer_load_dwordx4 v[12:15], v4, s[44:47], s8 offen offset:128
    buffer_load_dwordx4 v[16:19], v4, s[44:47], s8 offen offset:256
    buffer_load_dwordx4 v[20:23], v4, s[44:47], s8 offen offset:384
    buffer_load_dwordx4 v[24:27], v4, s[44:47], s8 offen offset:512
    buffer_load_dwordx4 v[28:31], v4, s[44:47], s8 offen offset:640
    buffer_load_dwordx4 v[32:35], v4, s[44:47], s8 offen offset:768
    buffer_load_dwordx4 v[36:39], v4, s[44:47], s8 offen offset:896
    buffer_load_dwordx4 v[40:43], v4, s[44:47], s8 offen offset:1024
    s_lshl_b32 s8, s4, 6
    s_add_u32 s8, s8, s12
    s_mul_i32 s8, s8, 1152
    buffer_load_dwordx4 v[68:71], v4, s[44:47], s8 offen offset:0
    buffer_load_dwordx4 v[72:75], v4, s[44:47], s8 offen offset:128
    buffer_load_dwordx4 v[76:79], v4, s[44:47], s8 offen offset:256
    buffer_load_dwordx4 v[80:83], v4, s[44:47], s8 offen offset:384
    buffer_load_dwordx4 v[84:87], v4, s[44:47], s8 offen offset:512
    buffer_load_dwordx4 v[88:91], v4, s[44:47], s8 offen offset:640
    buffer_load_dwordx4 v[92:95], v4, s[44:47], s8 offen offset:768
    buffer_load_dwordx4 v[96:99], v4, s[44:47], s8 offen offset:896
    buffer_load_dwordx4 v[100:103], v4, s[44:47], s8 offen offset:1024
    v_add_u32 v5, s11, v2
    v_bfe_u32 v6, v5, 1, 3
    v_lshrrev_b32 v7, 2, v3
    v_lshlrev_b32 v7, 2, v7
    v_and_b32 v44, 1, v3
    v_lshl_add_u32 v7, v44, 1, v7
    v_xor_b32 v7, v7, v6
    v_mul_u32_u24 v44, 1152, v5
    v_lshl_add_u32 v44, v7, 4, v44
    v_bfe_u32 v7, v3, 1, 1
    v_lshl_add_u32 v44, v7, 3, v44
    v_xor_b32 v45, 16, v44
    v_add_u32 v5, s12, v2
    v_bfe_u32 v6, v5, 1, 3
    v_lshrrev_b32 v7, 2, v3
    v_lshlrev_b32 v7, 2, v7
    v_and_b32 v46, 1, v3
    v_lshl_add_u32 v7, v46, 1, v7
    v_xor_b32 v7, v7, v6
    v_mul_u32_u24 v46, 1152, v5
    v_lshl_add_u32 v46, v7, 4, v46
    v_bfe_u32 v7, v3, 1, 1
    v_lshl_add_u32 v46, v7, 3, v46
    v_xor_b32 v47, 16, v46
    s_waitcnt vmcnt(9)
    v_mov_b32 v52, 0
    v_mov_b32 v53, 0
    v_mov_b32 v54, 0
    v_mov_b32 v55, 0
    s_mov_b32 s9, 0x3f803f80
    v_dot2c_f32_bf16 v52, s9, v8
    v_dot2c_f32_bf16 v54, v8, v8
    v_dot2c_f32_bf16 v53, s9, v9
    v_dot2c_f32_bf16 v55, v9, v9
    v_dot2c_f32_bf16 v52, s9, v10
    v_dot2c_f32_bf16 v54, v10, v10
    v_dot2c_f32_bf16 v53, s9, v11
    v_dot2c_f32_bf16 v55, v11, v11
    v_dot2c_f32_bf16 v52, s9, v12
    v_dot2c_f32_bf16 v54, v12, v12
    v_dot2c_f32_bf16 v53, s9, v13
    v_dot2c_f32_bf16 v55, v13, v13
    v_dot2c_f32_bf16 v52, s9, v14
    v_dot2c_f32_bf16 v54, v14, v14
    v_dot2c_f32_bf16 v53, s9, v15
    v_dot2c_f32_bf16 v55, v15, v15
    v_dot2c_f32_bf16 v52, s9, v16
    v_dot2c_f32_bf16 v54, v16, v16
    v_dot2c_f32_bf16 v53, s9, v17
    v_dot2c_f32_bf16 v55, v17, v17
    v_dot2c_f32_bf16 v52, s9, v18
    v_dot2c_f32_bf16 v54, v18, v18
    v_dot2c_f32_bf16 v53, s9, v19
    v_dot2c_f32_bf16 v55, v19, v19
    v_dot2c_f32_bf16 v52, s9, v20
    v_dot2c_f32_bf16 v54, v20, v20
    v_dot2c_f32_bf16 v53, s9, v21
    v_dot2c_f32_bf16 v55, v21, v21
    v_dot2c_f32_bf16 v52, s9, v22
    v_dot2c_f32_bf16 v54, v22, v22
    v_dot2c_f32_bf16 v53, s9, v23
    v_dot2c_f32_bf16 v55, v23, v23
    v_dot2c_f32_bf16 v52, s9, v24
    v_dot2c_f32_bf16 v54, v24, v24
    v_dot2c_f32_bf16 v53, s9, v25
    v_dot2c_f32_bf16 v55, v25, v25
    v_dot2c_f32_bf16 v52, s9, v26
    v_dot2c_f32_bf16 v54, v26, v26
    v_dot2c_f32_bf16 v53, s9, v27
    v_dot2c_f32_bf16 v55, v27, v27
    v_dot2c_f32_bf16 v52, s9, v28
    v_dot2c_f32_bf16 v54, v28, v28
    v_dot2c_f32_bf16 v53, s9, v29
    v_dot2c_f32_bf16 v55, v29, v29
    v_dot2c_f32_bf16 v52, s9, v30
    v_dot2c_f32_bf16 v54, v30, v30
    v_dot2c_f32_bf16 v53, s9, v31
    v_dot2c_f32_bf16 v55, v31, v31
    v_dot2c_f32_bf16 v52, s9, v32
    v_dot2c_f32_bf16 v54, v32, v32
    v_dot2c_f32_bf16 v53, s9, v33
    v_dot2c_f32_bf16 v55, v33, v33
    v_dot2c_f32_bf16 v52, s9, v34
    v_dot2c_f32_bf16 v54, v34, v34
    v_dot2c_f32_bf16 v53, s9, v35
    v_dot2c_f32_bf16 v55, v35, v35
    v_dot2c_f32_bf16 v52, s9, v36
    v_dot2c_f32_bf16 v54, v36, v36
    v_dot2c_f32_bf16 v53, s9, v37
    v_dot2c_f32_bf16 v55, v37, v37
    v_dot2c_f32_bf16 v52, s9, v38
    v_dot2c_f32_bf16 v54, v38, v38
    v_dot2c_f32_bf16 v53, s9, v39
    v_dot2c_f32_bf16 v55, v39, v39
    v_dot2c_f32_bf16 v52, s9, v40
    v_dot2c_f32_bf16 v54, v40, v40
    v_dot2c_f32_bf16 v53, s9, v41
    v_dot2c_f32_bf16 v55, v41, v41
    v_dot2c_f32_bf16 v52, s9, v42
    v_dot2c_f32_bf16 v54, v42, v42
    v_dot2c_f32_bf16 v53, s9, v43
    v_dot2c_f32_bf16 v55, v43, v43
    s_nop 3
    v_add_f32 v52, v52, v53
    v_add_f32 v54, v54, v55
    s_nop 1
    v_add_f32_dpp v52, v52, v52 quad_perm:[1,0,3,2] row_mask:0xf bank_mask:0xf
    v_add_f32_dpp v54, v54, v54 quad_perm:[1,0,3,2] row_mask:0xf bank_mask:0xf
    s_nop 1
    v_add_f32_dpp v52, v52, v52 quad_perm:[2,3,0,1] row_mask:0xf bank_mask:0xf
    v_add_f32_dpp v54, v54, v54 quad_perm:[2,3,0,1] row_mask:0xf bank_mask:0xf
    s_nop 1
    v_add_f32_dpp v52, v52, v52 row_half_mirror row_mask:0xf bank_mask:0xf
    v_add_f32_dpp v54, v54, v54 row_half_mirror row_mask:0xf bank_mask:0xf
    s_mov_b32 s9, 987991609
    v_mul_f32 v52, s9, v52
    v_mul_f32 v54, s9, v54
    v_fma_f32 v54, -v52, v52, v54
    v_max_f32 v54, 0, v54
    v_add_f32 v54, 925353388, v54
    v_rsq_f32 v56, v54
    s_nop 0
    v_mov_b32 v57, v56
    v_mul_f32 v58, v52, v56
    v_sub_f32 v58, 0, v58
    v_mov_b32 v59, v58
    v_lshlrev_b32 v60, 16, v8
    v_and_b32 v61, 0xffff0000, v8
    v_pk_fma_f32 v[60:61], v[60:61], v[56:57], v[58:59]
    v_cvt_pk_bf16_f32 v8, v60, v61
    v_lshlrev_b32 v62, 16, v9
    v_and_b32 v63, 0xffff0000, v9
    v_pk_fma_f32 v[62:63], v[62:63], v[56:57], v[58:59]
    v_cvt_pk_bf16_f32 v9, v62, v63
    v_lshlrev_b32 v64, 16, v10
    v_and_b32 v65, 0xffff0000, v10
    v_pk_fma_f32 v[64:65], v[64:65], v[56:57], v[58:59]
    v_cvt_pk_bf16_f32 v10, v64, v65
    v_lshlrev_b32 v66, 16, v11
    v_and_b32 v67, 0xffff0000, v11
    v_pk_fma_f32 v[66:67], v[66:67], v[56:57], v[58:59]
    v_cvt_pk_bf16_f32 v11, v66, v67
    v_lshlrev_b32 v60, 16, v12
    v_and_b32 v61, 0xffff0000, v12
    v_pk_fma_f32 v[60:61], v[60:61], v[56:57], v[58:59]
    v_cvt_pk_bf16_f32 v12, v60, v61
    v_lshlrev_b32 v62, 16, v13
    v_and_b32 v63, 0xffff0000, v13
    v_pk_fma_f32 v[62:63], v[62:63], v[56:57], v[58:59]
    v_cvt_pk_bf16_f32 v13, v62, v63
    v_lshlrev_b32 v64, 16, v14
    v_and_b32 v65, 0xffff0000, v14
    v_pk_fma_f32 v[64:65], v[64:65], v[56:57], v[58:59]
    v_cvt_pk_bf16_f32 v14, v64, v65
    v_lshlrev_b32 v66, 16, v15
    v_and_b32 v67, 0xffff0000, v15
    v_pk_fma_f32 v[66:67], v[66:67], v[56:57], v[58:59]
    v_cvt_pk_bf16_f32 v15, v66, v67
    v_lshlrev_b32 v60, 16, v16
    v_and_b32 v61, 0xffff0000, v16
    v_pk_fma_f32 v[60:61], v[60:61], v[56:57], v[58:59]
    v_cvt_pk_bf16_f32 v16, v60, v61
    v_lshlrev_b32 v62, 16, v17
    v_and_b32 v63, 0xffff0000, v17
    v_pk_fma_f32 v[62:63], v[62:63], v[56:57], v[58:59]
    v_cvt_pk_bf16_f32 v17, v62, v63
    v_lshlrev_b32 v64, 16, v18
    v_and_b32 v65, 0xffff0000, v18
    v_pk_fma_f32 v[64:65], v[64:65], v[56:57], v[58:59]
    v_cvt_pk_bf16_f32 v18, v64, v65
    v_lshlrev_b32 v66, 16, v19
    v_and_b32 v67, 0xffff0000, v19
    v_pk_fma_f32 v[66:67], v[66:67], v[56:57], v[58:59]
    v_cvt_pk_bf16_f32 v19, v66, v67
    v_lshlrev_b32 v60, 16, v20
    v_and_b32 v61, 0xffff0000, v20
    v_pk_fma_f32 v[60:61], v[60:61], v[56:57], v[58:59]
    v_cvt_pk_bf16_f32 v20, v60, v61
    v_lshlrev_b32 v62, 16, v21
    v_and_b32 v63, 0xffff0000, v21
    v_pk_fma_f32 v[62:63], v[62:63], v[56:57], v[58:59]
    v_cvt_pk_bf16_f32 v21, v62, v63
    v_lshlrev_b32 v64, 16, v22
    v_and_b32 v65, 0xffff0000, v22
    v_pk_fma_f32 v[64:65], v[64:65], v[56:57], v[58:59]
    v_cvt_pk_bf16_f32 v22, v64, v65
    v_lshlrev_b32 v66, 16, v23
    v_and_b32 v67, 0xffff0000, v23
    v_pk_fma_f32 v[66:67], v[66:67], v[56:57], v[58:59]
    v_cvt_pk_bf16_f32 v23, v66, v67
    v_lshlrev_b32 v60, 16, v24
    v_and_b32 v61, 0xffff0000, v24
    v_pk_fma_f32 v[60:61], v[60:61], v[56:57], v[58:59]
    v_cvt_pk_bf16_f32 v24, v60, v61
    v_lshlrev_b32 v62, 16, v25
    v_and_b32 v63, 0xffff0000, v25
    v_pk_fma_f32 v[62:63], v[62:63], v[56:57], v[58:59]
    v_cvt_pk_bf16_f32 v25, v62, v63
    v_lshlrev_b32 v64, 16, v26
    v_and_b32 v65, 0xffff0000, v26
    v_pk_fma_f32 v[64:65], v[64:65], v[56:57], v[58:59]
    v_cvt_pk_bf16_f32 v26, v64, v65
    v_lshlrev_b32 v66, 16, v27
    v_and_b32 v67, 0xffff0000, v27
    v_pk_fma_f32 v[66:67], v[66:67], v[56:57], v[58:59]
    v_cvt_pk_bf16_f32 v27, v66, v67
    v_lshlrev_b32 v60, 16, v28
    v_and_b32 v61, 0xffff0000, v28
    v_pk_fma_f32 v[60:61], v[60:61], v[56:57], v[58:59]
    v_cvt_pk_bf16_f32 v28, v60, v61
    v_lshlrev_b32 v62, 16, v29
    v_and_b32 v63, 0xffff0000, v29
    v_pk_fma_f32 v[62:63], v[62:63], v[56:57], v[58:59]
    v_cvt_pk_bf16_f32 v29, v62, v63
    v_lshlrev_b32 v64, 16, v30
    v_and_b32 v65, 0xffff0000, v30
    v_pk_fma_f32 v[64:65], v[64:65], v[56:57], v[58:59]
    v_cvt_pk_bf16_f32 v30, v64, v65
    v_lshlrev_b32 v66, 16, v31
    v_and_b32 v67, 0xffff0000, v31
    v_pk_fma_f32 v[66:67], v[66:67], v[56:57], v[58:59]
    v_cvt_pk_bf16_f32 v31, v66, v67
    v_lshlrev_b32 v60, 16, v32
    v_and_b32 v61, 0xffff0000, v32
    v_pk_fma_f32 v[60:61], v[60:61], v[56:57], v[58:59]
    v_cvt_pk_bf16_f32 v32, v60, v61
    v_lshlrev_b32 v62, 16, v33
    v_and_b32 v63, 0xffff0000, v33
    v_pk_fma_f32 v[62:63], v[62:63], v[56:57], v[58:59]
    v_cvt_pk_bf16_f32 v33, v62, v63
    v_lshlrev_b32 v64, 16, v34
    v_and_b32 v65, 0xffff0000, v34
    v_pk_fma_f32 v[64:65], v[64:65], v[56:57], v[58:59]
    v_cvt_pk_bf16_f32 v34, v64, v65
    v_lshlrev_b32 v66, 16, v35
    v_and_b32 v67, 0xffff0000, v35
    v_pk_fma_f32 v[66:67], v[66:67], v[56:57], v[58:59]
    v_cvt_pk_bf16_f32 v35, v66, v67
    v_lshlrev_b32 v60, 16, v36
    v_and_b32 v61, 0xffff0000, v36
    v_pk_fma_f32 v[60:61], v[60:61], v[56:57], v[58:59]
    v_cvt_pk_bf16_f32 v36, v60, v61
    v_lshlrev_b32 v62, 16, v37
    v_and_b32 v63, 0xffff0000, v37
    v_pk_fma_f32 v[62:63], v[62:63], v[56:57], v[58:59]
    v_cvt_pk_bf16_f32 v37, v62, v63
    v_lshlrev_b32 v64, 16, v38
    v_and_b32 v65, 0xffff0000, v38
    v_pk_fma_f32 v[64:65], v[64:65], v[56:57], v[58:59]
    v_cvt_pk_bf16_f32 v38, v64, v65
    v_lshlrev_b32 v66, 16, v39
    v_and_b32 v67, 0xffff0000, v39
    v_pk_fma_f32 v[66:67], v[66:67], v[56:57], v[58:59]
    v_cvt_pk_bf16_f32 v39, v66, v67
    v_lshlrev_b32 v60, 16, v40
    v_and_b32 v61, 0xffff0000, v40
    v_pk_fma_f32 v[60:61], v[60:61], v[56:57], v[58:59]
    v_cvt_pk_bf16_f32 v40, v60, v61
    v_lshlrev_b32 v62, 16, v41
    v_and_b32 v63, 0xffff0000, v41
    v_pk_fma_f32 v[62:63], v[62:63], v[56:57], v[58:59]
    v_cvt_pk_bf16_f32 v41, v62, v63
    v_lshlrev_b32 v64, 16, v42
    v_and_b32 v65, 0xffff0000, v42
    v_pk_fma_f32 v[64:65], v[64:65], v[56:57], v[58:59]
    v_cvt_pk_bf16_f32 v42, v64, v65
    v_lshlrev_b32 v66, 16, v43
    v_and_b32 v67, 0xffff0000, v43
    v_pk_fma_f32 v[66:67], v[66:67], v[56:57], v[58:59]
    v_cvt_pk_bf16_f32 v43, v66, v67
    s_waitcnt vmcnt(0)
    v_mov_b32 v52, 0
    v_mov_b32 v53, 0
    v_mov_b32 v54, 0
    v_mov_b32 v55, 0
    s_mov_b32 s9, 0x3f803f80
    v_dot2c_f32_bf16 v52, s9, v68
    v_dot2c_f32_bf16 v54, v68, v68
    v_dot2c_f32_bf16 v53, s9, v69
    v_dot2c_f32_bf16 v55, v69, v69
    v_dot2c_f32_bf16 v52, s9, v70
    v_dot2c_f32_bf16 v54, v70, v70
    v_dot2c_f32_bf16 v53, s9, v71
    v_dot2c_f32_bf16 v55, v71, v71
    v_dot2c_f32_bf16 v52, s9, v72
    v_dot2c_f32_bf16 v54, v72, v72
    v_dot2c_f32_bf16 v53, s9, v73
    v_dot2c_f32_bf16 v55, v73, v73
    v_dot2c_f32_bf16 v52, s9, v74
    v_dot2c_f32_bf16 v54, v74, v74
    v_dot2c_f32_bf16 v53, s9, v75
    v_dot2c_f32_bf16 v55, v75, v75
    v_dot2c_f32_bf16 v52, s9, v76
    v_dot2c_f32_bf16 v54, v76, v76
    v_dot2c_f32_bf16 v53, s9, v77
    v_dot2c_f32_bf16 v55, v77, v77
    v_dot2c_f32_bf16 v52, s9, v78
    v_dot2c_f32_bf16 v54, v78, v78
    v_dot2c_f32_bf16 v53, s9, v79
    v_dot2c_f32_bf16 v55, v79, v79
    v_dot2c_f32_bf16 v52, s9, v80
    v_dot2c_f32_bf16 v54, v80, v80
    v_dot2c_f32_bf16 v53, s9, v81
    v_dot2c_f32_bf16 v55, v81, v81
    v_dot2c_f32_bf16 v52, s9, v82
    v_dot2c_f32_bf16 v54, v82, v82
    v_dot2c_f32_bf16 v53, s9, v83
    v_dot2c_f32_bf16 v55, v83, v83
    v_dot2c_f32_bf16 v52, s9, v84
    v_dot2c_f32_bf16 v54, v84, v84
    v_dot2c_f32_bf16 v53, s9, v85
    v_dot2c_f32_bf16 v55, v85, v85
    v_dot2c_f32_bf16 v52, s9, v86
    v_dot2c_f32_bf16 v54, v86, v86
    v_dot2c_f32_bf16 v53, s9, v87
    v_dot2c_f32_bf16 v55, v87, v87
    v_dot2c_f32_bf16 v52, s9, v88
    v_dot2c_f32_bf16 v54, v88, v88
    v_dot2c_f32_bf16 v53, s9, v89
    v_dot2c_f32_bf16 v55, v89, v89
    v_dot2c_f32_bf16 v52, s9, v90
    v_dot2c_f32_bf16 v54, v90, v90
    v_dot2c_f32_bf16 v53, s9, v91
    v_dot2c_f32_bf16 v55, v91, v91
    v_dot2c_f32_bf16 v52, s9, v92
    v_dot2c_f32_bf16 v54, v92, v92
    v_dot2c_f32_bf16 v53, s9, v93
    v_dot2c_f32_bf16 v55, v93, v93
    v_dot2c_f32_bf16 v52, s9, v94
    v_dot2c_f32_bf16 v54, v94, v94
    v_dot2c_f32_bf16 v53, s9, v95
    v_dot2c_f32_bf16 v55, v95, v95
    v_dot2c_f32_bf16 v52, s9, v96
    v_dot2c_f32_bf16 v54, v96, v96
    v_dot2c_f32_bf16 v53, s9, v97
    v_dot2c_f32_bf16 v55, v97, v97
    v_dot2c_f32_bf16 v52, s9, v98
    v_dot2c_f32_bf16 v54, v98, v98
    v_dot2c_f32_bf16 v53, s9, v99
    v_dot2c_f32_bf16 v55, v99, v99
    v_dot2c_f32_bf16 v52, s9, v100
    v_dot2c_f32_bf16 v54, v100, v100
    v_dot2c_f32_bf16 v53, s9, v101
    v_dot2c_f32_bf16 v55, v101, v101
    v_dot2c_f32_bf16 v52, s9, v102
    v_dot2c_f32_bf16 v54, v102, v102
    v_dot2c_f32_bf16 v53, s9, v103
    v_dot2c_f32_bf16 v55, v103, v103
    s_nop 3
    v_add_f32 v52, v52, v53
    v_add_f32 v54, v54, v55
    s_nop 1
    v_add_f32_dpp v52, v52, v52 quad_perm:[1,0,3,2] row_mask:0xf bank_mask:0xf
    v_add_f32_dpp v54, v54, v54 quad_perm:[1,0,3,2] row_mask:0xf bank_mask:0xf
    s_nop 1
    v_add_f32_dpp v52, v52, v52 quad_perm:[2,3,0,1] row_mask:0xf bank_mask:0xf
    v_add_f32_dpp v54, v54, v54 quad_perm:[2,3,0,1] row_mask:0xf bank_mask:0xf
    s_nop 1
    v_add_f32_dpp v52, v52, v52 row_half_mirror row_mask:0xf bank_mask:0xf
    v_add_f32_dpp v54, v54, v54 row_half_mirror row_mask:0xf bank_mask:0xf
    s_mov_b32 s9, 987991609
    v_mul_f32 v52, s9, v52
    v_mul_f32 v54, s9, v54
    v_fma_f32 v54, -v52, v52, v54
    v_max_f32 v54, 0, v54
    v_add_f32 v54, 925353388, v54
    v_rsq_f32 v56, v54
    s_nop 0
    v_mov_b32 v57, v56
    v_mul_f32 v58, v52, v56
    v_sub_f32 v58, 0, v58
    v_mov_b32 v59, v58
    v_lshlrev_b32 v60, 16, v68
    v_and_b32 v61, 0xffff0000, v68
    v_pk_fma_f32 v[60:61], v[60:61], v[56:57], v[58:59]
    v_cvt_pk_bf16_f32 v68, v60, v61
    v_lshlrev_b32 v62, 16, v69
    v_and_b32 v63, 0xffff0000, v69
    v_pk_fma_f32 v[62:63], v[62:63], v[56:57], v[58:59]
    v_cvt_pk_bf16_f32 v69, v62, v63
    v_lshlrev_b32 v64, 16, v70
    v_and_b32 v65, 0xffff0000, v70
    v_pk_fma_f32 v[64:65], v[64:65], v[56:57], v[58:59]
    v_cvt_pk_bf16_f32 v70, v64, v65
    v_lshlrev_b32 v66, 16, v71
    v_and_b32 v67, 0xffff0000, v71
    v_pk_fma_f32 v[66:67], v[66:67], v[56:57], v[58:59]
    v_cvt_pk_bf16_f32 v71, v66, v67
    v_lshlrev_b32 v60, 16, v72
    v_and_b32 v61, 0xffff0000, v72
    v_pk_fma_f32 v[60:61], v[60:61], v[56:57], v[58:59]
    v_cvt_pk_bf16_f32 v72, v60, v61
    v_lshlrev_b32 v62, 16, v73
    v_and_b32 v63, 0xffff0000, v73
    v_pk_fma_f32 v[62:63], v[62:63], v[56:57], v[58:59]
    v_cvt_pk_bf16_f32 v73, v62, v63
    v_lshlrev_b32 v64, 16, v74
    v_and_b32 v65, 0xffff0000, v74
    v_pk_fma_f32 v[64:65], v[64:65], v[56:57], v[58:59]
    v_cvt_pk_bf16_f32 v74, v64, v65
    v_lshlrev_b32 v66, 16, v75
    v_and_b32 v67, 0xffff0000, v75
    v_pk_fma_f32 v[66:67], v[66:67], v[56:57], v[58:59]
    v_cvt_pk_bf16_f32 v75, v66, v67
    v_lshlrev_b32 v60, 16, v76
    v_and_b32 v61, 0xffff0000, v76
    v_pk_fma_f32 v[60:61], v[60:61], v[56:57], v[58:59]
    v_cvt_pk_bf16_f32 v76, v60, v61
    v_lshlrev_b32 v62, 16, v77
    v_and_b32 v63, 0xffff0000, v77
    v_pk_fma_f32 v[62:63], v[62:63], v[56:57], v[58:59]
    v_cvt_pk_bf16_f32 v77, v62, v63
    v_lshlrev_b32 v64, 16, v78
    v_and_b32 v65, 0xffff0000, v78
    v_pk_fma_f32 v[64:65], v[64:65], v[56:57], v[58:59]
    v_cvt_pk_bf16_f32 v78, v64, v65
    v_lshlrev_b32 v66, 16, v79
    v_and_b32 v67, 0xffff0000, v79
    v_pk_fma_f32 v[66:67], v[66:67], v[56:57], v[58:59]
    v_cvt_pk_bf16_f32 v79, v66, v67
    v_lshlrev_b32 v60, 16, v80
    v_and_b32 v61, 0xffff0000, v80
    v_pk_fma_f32 v[60:61], v[60:61], v[56:57], v[58:59]
    v_cvt_pk_bf16_f32 v80, v60, v61
    v_lshlrev_b32 v62, 16, v81
    v_and_b32 v63, 0xffff0000, v81
    v_pk_fma_f32 v[62:63], v[62:63], v[56:57], v[58:59]
    v_cvt_pk_bf16_f32 v81, v62, v63
    v_lshlrev_b32 v64, 16, v82
    v_and_b32 v65, 0xffff0000, v82
    v_pk_fma_f32 v[64:65], v[64:65], v[56:57], v[58:59]
    v_cvt_pk_bf16_f32 v82, v64, v65
    v_lshlrev_b32 v66, 16, v83
    v_and_b32 v67, 0xffff0000, v83
    v_pk_fma_f32 v[66:67], v[66:67], v[56:57], v[58:59]
    v_cvt_pk_bf16_f32 v83, v66, v67
    v_lshlrev_b32 v60, 16, v84
    v_and_b32 v61, 0xffff0000, v84
    v_pk_fma_f32 v[60:61], v[60:61], v[56:57], v[58:59]
    v_cvt_pk_bf16_f32 v84, v60, v61
    v_lshlrev_b32 v62, 16, v85
    v_and_b32 v63, 0xffff0000, v85
    v_pk_fma_f32 v[62:63], v[62:63], v[56:57], v[58:59]
    v_cvt_pk_bf16_f32 v85, v62, v63
    v_lshlrev_b32 v64, 16, v86
    v_and_b32 v65, 0xffff0000, v86
    v_pk_fma_f32 v[64:65], v[64:65], v[56:57], v[58:59]
    v_cvt_pk_bf16_f32 v86, v64, v65
    v_lshlrev_b32 v66, 16, v87
    v_and_b32 v67, 0xffff0000, v87
    v_pk_fma_f32 v[66:67], v[66:67], v[56:57], v[58:59]
    v_cvt_pk_bf16_f32 v87, v66, v67
    v_lshlrev_b32 v60, 16, v88
    v_and_b32 v61, 0xffff0000, v88
    v_pk_fma_f32 v[60:61], v[60:61], v[56:57], v[58:59]
    v_cvt_pk_bf16_f32 v88, v60, v61
    v_lshlrev_b32 v62, 16, v89
    v_and_b32 v63, 0xffff0000, v89
    v_pk_fma_f32 v[62:63], v[62:63], v[56:57], v[58:59]
    v_cvt_pk_bf16_f32 v89, v62, v63
    v_lshlrev_b32 v64, 16, v90
    v_and_b32 v65, 0xffff0000, v90
    v_pk_fma_f32 v[64:65], v[64:65], v[56:57], v[58:59]
    v_cvt_pk_bf16_f32 v90, v64, v65
    v_lshlrev_b32 v66, 16, v91
    v_and_b32 v67, 0xffff0000, v91
    v_pk_fma_f32 v[66:67], v[66:67], v[56:57], v[58:59]
    v_cvt_pk_bf16_f32 v91, v66, v67
    v_lshlrev_b32 v60, 16, v92
    v_and_b32 v61, 0xffff0000, v92
    v_pk_fma_f32 v[60:61], v[60:61], v[56:57], v[58:59]
    v_cvt_pk_bf16_f32 v92, v60, v61
    v_lshlrev_b32 v62, 16, v93
    v_and_b32 v63, 0xffff0000, v93
    v_pk_fma_f32 v[62:63], v[62:63], v[56:57], v[58:59]
    v_cvt_pk_bf16_f32 v93, v62, v63
    v_lshlrev_b32 v64, 16, v94
    v_and_b32 v65, 0xffff0000, v94
    v_pk_fma_f32 v[64:65], v[64:65], v[56:57], v[58:59]
    v_cvt_pk_bf16_f32 v94, v64, v65
    v_lshlrev_b32 v66, 16, v95
    v_and_b32 v67, 0xffff0000, v95
    v_pk_fma_f32 v[66:67], v[66:67], v[56:57], v[58:59]
    v_cvt_pk_bf16_f32 v95, v66, v67
    v_lshlrev_b32 v60, 16, v96
    v_and_b32 v61, 0xffff0000, v96
    v_pk_fma_f32 v[60:61], v[60:61], v[56:57], v[58:59]
    v_cvt_pk_bf16_f32 v96, v60, v61
    v_lshlrev_b32 v62, 16, v97
    v_and_b32 v63, 0xffff0000, v97
    v_pk_fma_f32 v[62:63], v[62:63], v[56:57], v[58:59]
    v_cvt_pk_bf16_f32 v97, v62, v63
    v_lshlrev_b32 v64, 16, v98
    v_and_b32 v65, 0xffff0000, v98
    v_pk_fma_f32 v[64:65], v[64:65], v[56:57], v[58:59]
    v_cvt_pk_bf16_f32 v98, v64, v65
    v_lshlrev_b32 v66, 16, v99
    v_and_b32 v67, 0xffff0000, v99
    v_pk_fma_f32 v[66:67], v[66:67], v[56:57], v[58:59]
    v_cvt_pk_bf16_f32 v99, v66, v67
    v_lshlrev_b32 v60, 16, v100
    v_and_b32 v61, 0xffff0000, v100
    v_pk_fma_f32 v[60:61], v[60:61], v[56:57], v[58:59]
    v_cvt_pk_bf16_f32 v100, v60, v61
    v_lshlrev_b32 v62, 16, v101
    v_and_b32 v63, 0xffff0000, v101
    v_pk_fma_f32 v[62:63], v[62:63], v[56:57], v[58:59]
    v_cvt_pk_bf16_f32 v101, v62, v63
    v_lshlrev_b32 v64, 16, v102
    v_and_b32 v65, 0xffff0000, v102
    v_pk_fma_f32 v[64:65], v[64:65], v[56:57], v[58:59]
    v_cvt_pk_bf16_f32 v102, v64, v65
    v_lshlrev_b32 v66, 16, v103
    v_and_b32 v67, 0xffff0000, v103
    v_pk_fma_f32 v[66:67], v[66:67], v[56:57], v[58:59]
    v_cvt_pk_bf16_f32 v103, v66, v67
LM_kvw_6:
    ds_read_b32 v49, v48
    s_waitcnt lgkmcnt(0)
    v_cmp_gt_u32 vcc, 2, v49
    s_nop 4
    s_cbranch_vccz LM_kvwd_7
    s_sleep 1
    s_branch LM_kvw_6
LM_kvwd_7:
    ds_write_b64 v44, v[8:9] offset:0
    ds_write_b64 v45, v[10:11] offset:0
    ds_write_b64 v44, v[12:13] offset:128
    ds_write_b64 v45, v[14:15] offset:128
    ds_write_b64 v44, v[16:17] offset:256
    ds_write_b64 v45, v[18:19] offset:256
    ds_write_b64 v44, v[20:21] offset:384
    ds_write_b64 v45, v[22:23] offset:384
    ds_write_b64 v44, v[24:25] offset:512
    ds_write_b64 v45, v[26:27] offset:512
    ds_write_b64 v44, v[28:29] offset:640
    ds_write_b64 v45, v[30:31] offset:640
    ds_write_b64 v44, v[32:33] offset:768
    ds_write_b64 v45, v[34:35] offset:768
    ds_write_b64 v44, v[36:37] offset:896
    ds_write_b64 v45, v[38:39] offset:896
    ds_write_b64 v44, v[40:41] offset:1024
    ds_write_b64 v45, v[42:43] offset:1024
    ds_write_b64 v46, v[68:69] offset:0
    ds_write_b64 v47, v[70:71] offset:0
    ds_write_b64 v46, v[72:73] offset:128
    ds_write_b64 v47, v[74:75] offset:128
    ds_write_b64 v46, v[76:77] offset:256
    ds_write_b64 v47, v[78:79] offset:256
    ds_write_b64 v46, v[80:81] offset:384
    ds_write_b64 v47, v[82:83] offset:384
    ds_write_b64 v46, v[84:85] offset:512
    ds_write_b64 v47, v[86:87] offset:512
    ds_write_b64 v46, v[88:89] offset:640
    ds_write_b64 v47, v[90:91] offset:640
    ds_write_b64 v46, v[92:93] offset:768
    ds_write_b64 v47, v[94:95] offset:768
    ds_write_b64 v46, v[96:97] offset:896
    ds_write_b64 v47, v[98:99] offset:896
    ds_write_b64 v46, v[100:101] offset:1024
    ds_write_b64 v47, v[102:103] offset:1024
LM_lnskip_5:
LM_kvw2_8:
    ds_read_b32 v49, v48
    s_waitcnt lgkmcnt(0)
    v_cmp_gt_u32 vcc, 2, v49
    s_nop 4
    s_cbranch_vccz LM_kvw2d_9
    s_sleep 1
    s_branch LM_kvw2_8
LM_kvw2d_9:
    s_lshl_b32 s9, s7, 2
    s_add_u32 s9, s9, 163824
    v_mov_b32 v50, s9
    v_mov_b32 v51, 1
    s_waitcnt lgkmcnt(0)
    ds_write_b32 v50, v51
    v_and_b32 v2, 31, v1
    v_lshrrev_b32 v3, 5, v1
    v_lshlrev_b32 v4, 4, v1
    v_add_u32 v178, 147456, v4
    v_lshlrev_b32 v4, 2, v2
    v_add_u32 v179, 148480, v4
    v_min_u32 v4, 19, v2
    v_cmp_eq_u32 vcc, 22, v2
    s_nop 1
    v_cndmask_b32 v4, v4, 18, vcc
    v_lshlrev_b32 v4, 4, v4
    v_mul_u32_u24 v5, 320, v3
    v_add_u32 v4, v4, v5
    v_add_u32 v180, 148608, v4
    s_mul_i32 s9, s7, 1216
    v_lshlrev_b32 v4, 4, v1
    v_add_u32 v184, s9, v4
    s_add_u32 s87, s9, 147456
    s_mov_b32 s88, 1300234240
    v_and_b32 v2, 31, v1
    v_lshrrev_b32 v3, 5, v1
    v_mul_u32_u24 v4, 224, v2
    v_add_u32 v4, 147456, v4
    s_mul_i32 s9, s7, 18
    v_lshlrev_b32 v5, 2, v3
    v_add_u32 v5, s9, v5
    v_add_u32 v6, 0, v5
    v_lshrrev_b32 v7, 5, v6
    v_lshl_add_u32 v204, v7, 6, v4
    v_bfe_u32 v7, v6, 2, 2
    v_lshl_add_u32 v204, v7, 4, v204
    v_bfe_u32 v7, v6, 4, 1
    v_lshl_add_u32 v204, v7, 3, v204
    v_and_b32 v7, 3, v6
    v_lshl_add_u32 v204, v7, 1, v204
    v_add_u32 v6, 2, v5
    v_lshrrev_b32 v7, 5, v6
    v_lshl_add_u32 v205, v7, 6, v4
    v_bfe_u32 v7, v6, 2, 2
    v_lshl_add_u32 v205, v7, 4, v205
    v_bfe_u32 v7, v6, 4, 1
    v_lshl_add_u32 v205, v7, 3, v205
    v_and_b32 v7, 3, v6
    v_lshl_add_u32 v205, v7, 1, v205
    v_add_u32 v6, 8, v5
    v_lshrrev_b32 v7, 5, v6
    v_lshl_add_u32 v206, v7, 6, v4
    v_bfe_u32 v7, v6, 2, 2
    v_lshl_add_u32 v206, v7, 4, v206
    v_bfe_u32 v7, v6, 4, 1
    v_lshl_add_u32 v206, v7, 3, v206
    v_and_b32 v7, 3, v6
    v_lshl_add_u32 v206, v7, 1, v206
    v_add_u32 v6, 10, v5
    v_lshrrev_b32 v7, 5, v6
    v_lshl_add_u32 v207, v7, 6, v4
    v_bfe_u32 v7, v6, 2, 2
    v_lshl_add_u32 v207, v7, 4, v207
    v_bfe_u32 v7, v6, 4, 1
    v_lshl_add_u32 v207, v7, 3, v207
    v_and_b32 v7, 3, v6
    v_lshl_add_u32 v207, v7, 1, v207
    v_add_u32 v6, 16, v5
    v_lshrrev_b32 v7, 5, v6
    v_lshl_add_u32 v208, v7, 6, v4
    v_bfe_u32 v7, v6, 2, 2
    v_lshl_add_u32 v208, v7, 4, v208
    v_bfe_u32 v7, v6, 4, 1
    v_lshl_add_u32 v208, v7, 3, v208
    v_and_b32 v7, 3, v6
    v_lshl_add_u32 v208, v7, 1, v208
    v_and_b32 v6, 15, v1
    s_lshl_b32 s9, s7, 4
    v_add_u32 v6, s9, v6
    v_mul_u32_u24 v6, 224, v6
    v_add_u32 v6, 147584, v6
    v_lshrrev_b32 v7, 4, v1
    v_lshl_add_u32 v209, v7, 4, 16
    v_add_u32 v210, 8, v209
    v_cmp_eq_u32 vcc, 0, v7
    v_cmp_eq_u32 s[92:93], 3, v7
    s_nop 1
    s_or_b64 vcc, vcc, s[92:93]
    s_nop 1
    v_cndmask_b32 v209, v209, 8, vcc
    v_cndmask_b32 v210, v210, 24, vcc
    v_add_u32 v209, v209, v6
    v_add_u32 v210, v210, v6
    s_mov_b32 s86, 0
    s_mov_b32 s89, 0
    v_mov_b32 v80, 0
    v_mov_b32 v81, 0
    v_mov_b32 v82, 0
    v_mov_b32 v83, 0
    v_mov_b32 v84, 0
    v_mov_b32 v85, 0
    v_mov_b32 v86, 0
    v_mov_b32 v87, 0
    v_mov_b32 v88, 0
    v_mov_b32 v89, 0
    v_mov_b32 v90, 0
    v_mov_b32 v91, 0
    v_mov_b32 v92, 0
    v_mov_b32 v93, 0
    v_mov_b32 v94, 0
    v_mov_b32 v95, 0
    v_mov_b32 v64, 0
    v_mov_b32 v65, 0
    v_mov_b32 v66, 0
    v_mov_b32 v67, 0
    v_mov_b32 v68, 0
    v_mov_b32 v69, 0
    v_mov_b32 v70, 0
    v_mov_b32 v71, 0
    v_mov_b32 v96, 0
    v_mov_b32 v97, 0
    v_mov_b32 v98, 0
    v_mov_b32 v99, 0
    v_mov_b32 v100, 0
    v_mov_b32 v101, 0
    v_mov_b32 v102, 0
    v_mov_b32 v103, 0
    v_mov_b32 v104, 0
    v_mov_b32 v105, 0
    v_mov_b32 v106, 0
    v_mov_b32 v107, 0
    v_mov_b32 v108, 0
    v_mov_b32 v109, 0
    v_mov_b32 v110, 0
    v_mov_b32 v111, 0
    v_mov_b32 v72, 0
    v_mov_b32 v73, 0
    v_mov_b32 v74, 0
    v_mov_b32 v75, 0
    v_mov_b32 v76, 0
    v_mov_b32 v77, 0
    v_mov_b32 v78, 0
    v_mov_b32 v79, 0
    v_and_b32 v50, 1, v1
    v_lshlrev_b32 v50, 2, v50
    v_add_u32 v50, 163784, v50
LM_qst_10:
    ds_read_b32 v49, v50
    s_waitcnt lgkmcnt(0)
    v_cmp_gt_u32 vcc, 4, v49
    s_nop 4
    s_cbranch_vccz LM_qstd_11
    s_sleep 1
    s_branch LM_qst_10
LM_qstd_11:
    v_add_u32 v48, 48, v48
LM_xn_12:
    ds_read_b32 v49, v48
    s_waitcnt lgkmcnt(0)
    v_cmp_gt_u32 vcc, 1, v49
    s_nop 4
    s_cbranch_vccz LM_xnd_13
    s_sleep 1
    s_branch LM_xn_12
LM_xnd_13:
    ds_read_b64_tr_b16 v[112:113], v165 offset:13824
    ds_read_b64_tr_b16 v[114:115], v165 offset:16128
    ds_read_b128 v[128:131], v160 offset:0
    ds_read_b128 v[136:139], v160 offset:36864
    ds_read_b64_tr_b16 v[116:117], v165 offset:14976
    ds_read_b64_tr_b16 v[118:119], v165 offset:17280
    ds_read_b128 v[132:135], v161 offset:0
    ds_read_b128 v[140:143], v161 offset:36864
    ds_read_b64_tr_b16 v[120:121], v165 offset:18432
    ds_read_b64_tr_b16 v[122:123], v165 offset:20736
    ds_read_b128 v[144:147], v162 offset:0
    ds_read_b128 v[152:155], v162 offset:36864
    ds_read_b64_tr_b16 v[124:125], v165 offset:19584
    ds_read_b64_tr_b16 v[126:127], v165 offset:21888
    ds_read_b128 v[148:151], v163 offset:0
    ds_read_b128 v[156:159], v163 offset:36864
    s_waitcnt lgkmcnt(8)
    v_mfma_f32_32x32x16_bf16 v[32:47], v[112:115], v[128:131], 0
    v_mfma_f32_32x32x16_bf16 v[48:63], v[112:115], v[136:139], 0
    ds_read_b64_tr_b16 v[112:113], v164 offset:0
    ds_read_b64_tr_b16 v[114:115], v164 offset:2304
    v_mfma_f32_32x32x16_bf16 v[32:47], v[116:119], v[132:135], v[32:47]
    ds_read_b128 v[128:131], v160 offset:128
    ds_read_b128 v[136:139], v160 offset:36992
    v_mfma_f32_32x32x16_bf16 v[48:63], v[116:119], v[140:143], v[48:63]
    ds_read_b64_tr_b16 v[116:117], v164 offset:1152
    ds_read_b64_tr_b16 v[118:119], v164 offset:3456
    ds_read_b128 v[132:135], v161 offset:128
    ds_read_b128 v[140:143], v161 offset:36992
    s_waitcnt lgkmcnt(8)
    v_mfma_f32_32x32x16_bf16 v[32:47], v[120:123], v[144:147], v[32:47]
    v_mfma_f32_32x32x16_bf16 v[48:63], v[120:123], v[152:155], v[48:63]
    ds_read_b64_tr_b16 v[120:121], v164 offset:4608
    ds_read_b64_tr_b16 v[122:123], v164 offset:6912
    v_mfma_f32_32x32x16_bf16 v[32:47], v[124:127], v[148:151], v[32:47]
    ds_read_b128 v[144:147], v162 offset:128
    ds_read_b128 v[152:155], v162 offset:36992
    v_mfma_f32_32x32x16_bf16 v[48:63], v[124:127], v[156:159], v[48:63]
    ds_read_b64_tr_b16 v[124:125], v164 offset:5760
    ds_read_b64_tr_b16 v[126:127], v164 offset:8064
    ds_read_b128 v[148:151], v163 offset:128
    ds_read_b128 v[156:159], v163 offset:36992
    s_waitcnt lgkmcnt(8)
    v_mov_b32 v3, 2
    ds_write_b32 v166, v3
    v_mfma_f32_32x32x16_bf16 v[32:47], v[112:115], v[128:131], v[32:47]
    v_mfma_f32_32x32x16_bf16 v[48:63], v[112:115], v[136:139], v[48:63]
    ds_read_b64_tr_b16 v[112:113], v164 offset:9216
    ds_read_b64_tr_b16 v[114:115], v164 offset:11520
    v_mfma_f32_32x32x16_bf16 v[32:47], v[116:119], v[132:135], v[32:47]
    ds_read_b128 v[128:131], v160 offset:256
    ds_read_b128 v[136:139], v160 offset:37120
    v_mfma_f32_32x32x16_bf16 v[48:63], v[116:119], v[140:143], v[48:63]
    ds_read_b64_tr_b16 v[116:117], v164 offset:10368
    ds_read_b64_tr_b16 v[118:119], v164 offset:12672
    ds_read_b128 v[132:135], v161 offset:256
    ds_read_b128 v[140:143], v161 offset:37120
    s_waitcnt lgkmcnt(8)
    v_mfma_f32_32x32x16_bf16 v[32:47], v[120:123], v[144:147], v[32:47]
    v_mfma_f32_32x32x16_bf16 v[48:63], v[120:123], v[152:155], v[48:63]
    ds_read_b64_tr_b16 v[120:121], v164 offset:13824
    ds_read_b64_tr_b16 v[122:123], v164 offset:16128
    v_mfma_f32_32x32x16_bf16 v[32:47], v[124:127], v[148:151], v[32:47]
    ds_read_b128 v[144:147], v162 offset:256
    ds_read_b128 v[152:155], v162 offset:37120
    v_mfma_f32_32x32x16_bf16 v[48:63], v[124:127], v[156:159], v[48:63]
    ds_read_b64_tr_b16 v[124:125], v164 offset:14976
    ds_read_b64_tr_b16 v[126:127], v164 offset:17280
    ds_read_b128 v[148:151], v163 offset:256
    ds_read_b128 v[156:159], v163 offset:37120
    s_waitcnt lgkmcnt(8)
    v_mfma_f32_32x32x16_bf16 v[32:47], v[112:115], v[128:131], v[32:47]
    v_mfma_f32_32x32x16_bf16 v[48:63], v[112:115], v[136:139], v[48:63]
    ds_read_b64_tr_b16 v[112:113], v164 offset:18432
    ds_read_b64_tr_b16 v[114:115], v164 offset:20736
    v_mfma_f32_32x32x16_bf16 v[32:47], v[116:119], v[132:135], v[32:47]
    ds_read_b128 v[128:131], v160 offset:384
    ds_read_b128 v[136:139], v160 offset:37248
    v_mfma_f32_32x32x16_bf16 v[48:63], v[116:119], v[140:143], v[48:63]
    ds_read_b64_tr_b16 v[116:117], v164 offset:19584
    ds_read_b64_tr_b16 v[118:119], v164 offset:21888
    ds_read_b128 v[132:135], v161 offset:384
    ds_read_b128 v[140:143], v161 offset:37248
    s_waitcnt lgkmcnt(8)
    v_mfma_f32_32x32x16_bf16 v[32:47], v[120:123], v[144:147], v[32:47]
    v_mfma_f32_32x32x16_bf16 v[48:63], v[120:123], v[152:155], v[48:63]
    ds_read_b64_tr_b16 v[120:121], v164 offset:23040
    ds_read_b64_tr_b16 v[122:123], v164 offset:25344
    v_mfma_f32_32x32x16_bf16 v[32:47], v[124:127], v[148:151], v[32:47]
    ds_read_b128 v[144:147], v162 offset:384
    ds_read_b128 v[152:155], v162 offset:37248
    v_mfma_f32_32x32x16_bf16 v[48:63], v[124:127], v[156:159], v[48:63]
    ds_read_b64_tr_b16 v[124:125], v164 offset:24192
    ds_read_b64_tr_b16 v[126:127], v164 offset:26496
    ds_read_b128 v[148:151], v163 offset:384
    ds_read_b128 v[156:159], v163 offset:37248
    s_waitcnt lgkmcnt(8)
    v_mfma_f32_32x32x16_bf16 v[32:47], v[112:115], v[128:131], v[32:47]
    v_mfma_f32_32x32x16_bf16 v[48:63], v[112:115], v[136:139], v[48:63]
    ds_read_b64_tr_b16 v[112:113], v164 offset:27648
    ds_read_b64_tr_b16 v[114:115], v164 offset:29952
    v_mfma_f32_32x32x16_bf16 v[32:47], v[116:119], v[132:135], v[32:47]
    ds_read_b128 v[128:131], v160 offset:512
    ds_read_b128 v[136:139], v160 offset:37376
    v_mfma_f32_32x32x16_bf16 v[48:63], v[116:119], v[140:143], v[48:63]
    ds_read_b64_tr_b16 v[116:117], v164 offset:28800
    ds_read_b64_tr_b16 v[118:119], v164 offset:31104
    ds_read_b128 v[132:135], v161 offset:512
    ds_read_b128 v[140:143], v161 offset:37376
    s_waitcnt lgkmcnt(8)
    v_mfma_f32_32x32x16_bf16 v[32:47], v[120:123], v[144:147], v[32:47]
    v_mfma_f32_32x32x16_bf16 v[48:63], v[120:123], v[152:155], v[48:63]
    ds_read_b64_tr_b16 v[120:121], v164 offset:32256
    ds_read_b64_tr_b16 v[122:123], v164 offset:34560
    v_mfma_f32_32x32x16_bf16 v[32:47], v[124:127], v[148:151], v[32:47]
    ds_read_b128 v[144:147], v162 offset:512
    ds_read_b128 v[152:155], v162 offset:37376
    v_mfma_f32_32x32x16_bf16 v[48:63], v[124:127], v[156:159], v[48:63]
    ds_read_b64_tr_b16 v[124:125], v164 offset:33408
    ds_read_b64_tr_b16 v[126:127], v164 offset:35712
    ds_read_b128 v[148:151], v163 offset:512
    ds_read_b128 v[156:159], v163 offset:37376
    s_waitcnt lgkmcnt(8)
    v_mfma_f32_32x32x16_bf16 v[32:47], v[112:115], v[128:131], v[32:47]
    v_mfma_f32_32x32x16_bf16 v[48:63], v[112:115], v[136:139], v[48:63]
    ds_read_b64_tr_b16 v[112:113], v164 offset:36864
    ds_read_b64_tr_b16 v[114:115], v164 offset:39168
    v_mfma_f32_32x32x16_bf16 v[32:47], v[116:119], v[132:135], v[32:47]
    ds_read_b128 v[128:131], v160 offset:640
    ds_read_b128 v[136:139], v160 offset:37504
    v_mfma_f32_32x32x16_bf16 v[48:63], v[116:119], v[140:143], v[48:63]
    ds_read_b64_tr_b16 v[116:117], v164 offset:38016
    ds_read_b64_tr_b16 v[118:119], v164 offset:40320
    ds_read_b128 v[132:135], v161 offset:640
    ds_read_b128 v[140:143], v161 offset:37504
    s_waitcnt lgkmcnt(8)
    v_mfma_f32_32x32x16_bf16 v[32:47], v[120:123], v[144:147], v[32:47]
    v_mfma_f32_32x32x16_bf16 v[48:63], v[120:123], v[152:155], v[48:63]
    ds_read_b64_tr_b16 v[120:121], v164 offset:41472
    ds_read_b64_tr_b16 v[122:123], v164 offset:43776
    v_mfma_f32_32x32x16_bf16 v[32:47], v[124:127], v[148:151], v[32:47]
    ds_read_b128 v[144:147], v162 offset:640
    ds_read_b128 v[152:155], v162 offset:37504
    v_mfma_f32_32x32x16_bf16 v[48:63], v[124:127], v[156:159], v[48:63]
    ds_read_b64_tr_b16 v[124:125], v164 offset:42624
    ds_read_b64_tr_b16 v[126:127], v164 offset:44928
    ds_read_b128 v[148:151], v163 offset:640
    ds_read_b128 v[156:159], v163 offset:37504
    s_waitcnt lgkmcnt(8)
    v_mfma_f32_32x32x16_bf16 v[32:47], v[112:115], v[128:131], v[32:47]
    v_mfma_f32_32x32x16_bf16 v[48:63], v[112:115], v[136:139], v[48:63]
    ds_read_b64_tr_b16 v[112:113], v164 offset:46080
    ds_read_b64_tr_b16 v[114:115], v164 offset:48384
    v_mfma_f32_32x32x16_bf16 v[32:47], v[116:119], v[132:135], v[32:47]
    ds_read_b128 v[128:131], v160 offset:768
    ds_read_b128 v[136:139], v160 offset:37632
    v_mfma_f32_32x32x16_bf16 v[48:63], v[116:119], v[140:143], v[48:63]
    ds_read_b64_tr_b16 v[116:117], v164 offset:47232
    ds_read_b64_tr_b16 v[118:119], v164 offset:49536
    ds_read_b128 v[132:135], v161 offset:768
    ds_read_b128 v[140:143], v161 offset:37632
    s_waitcnt lgkmcnt(8)
    v_mfma_f32_32x32x16_bf16 v[32:47], v[120:123], v[144:147], v[32:47]
    v_mfma_f32_32x32x16_bf16 v[48:63], v[120:123], v[152:155], v[48:63]
    ds_read_b64_tr_b16 v[120:121], v164 offset:50688
    ds_read_b64_tr_b16 v[122:123], v164 offset:52992
    v_mfma_f32_32x32x16_bf16 v[32:47], v[124:127], v[148:151], v[32:47]
    ds_read_b128 v[144:147], v162 offset:768
    ds_read_b128 v[152:155], v162 offset:37632
    v_mfma_f32_32x32x16_bf16 v[48:63], v[124:127], v[156:159], v[48:63]
    ds_read_b64_tr_b16 v[124:125], v164 offset:51840
    ds_read_b64_tr_b16 v[126:127], v164 offset:54144
    ds_read_b128 v[148:151], v163 offset:768
    ds_read_b128 v[156:159], v163 offset:37632
    s_waitcnt lgkmcnt(8)
    s_mov_b32 s12, s38
    s_and_b32 s13, s39, 0xffff
    s_mov_b32 s14, 256
    s_mov_b32 s15, 0x00020000
    v_and_b32 v202, 15, v1
    v_lshlrev_b32 v202, 4, v202
    buffer_load_dword v203, v202, s[12:15], 0 offen sc1
    ds_read_b32 v201, v167
    v_mfma_f32_32x32x16_bf16 v[32:47], v[112:115], v[128:131], v[32:47]
    v_mfma_f32_32x32x16_bf16 v[48:63], v[112:115], v[136:139], v[48:63]
    ds_read_b64_tr_b16 v[112:113], v164 offset:55296
    ds_read_b64_tr_b16 v[114:115], v164 offset:57600
    v_mfma_f32_32x32x16_bf16 v[32:47], v[116:119], v[132:135], v[32:47]
    ds_read_b128 v[128:131], v160 offset:896
    ds_read_b128 v[136:139], v160 offset:37760
    v_mfma_f32_32x32x16_bf16 v[48:63], v[116:119], v[140:143], v[48:63]
    ds_read_b64_tr_b16 v[116:117], v164 offset:56448
    ds_read_b64_tr_b16 v[118:119], v164 offset:58752
    ds_read_b128 v[132:135], v161 offset:896
    ds_read_b128 v[140:143], v161 offset:37760
    s_waitcnt lgkmcnt(8)
    v_mfma_f32_32x32x16_bf16 v[32:47], v[120:123], v[144:147], v[32:47]
    v_mfma_f32_32x32x16_bf16 v[48:63], v[120:123], v[152:155], v[48:63]
    ds_read_b64_tr_b16 v[120:121], v164 offset:59904
    ds_read_b64_tr_b16 v[122:123], v164 offset:62208
    v_mfma_f32_32x32x16_bf16 v[32:47], v[124:127], v[148:151], v[32:47]
    ds_read_b128 v[144:147], v162 offset:896
    ds_read_b128 v[152:155], v162 offset:37760
    v_mfma_f32_32x32x16_bf16 v[48:63], v[124:127], v[156:159], v[48:63]
    ds_read_b64_tr_b16 v[124:125], v164 offset:61056
    ds_read_b64_tr_b16 v[126:127], v164 offset:63360
    ds_read_b128 v[148:151], v163 offset:896
    ds_read_b128 v[156:159], v163 offset:37760
    s_waitcnt lgkmcnt(8)
    v_mfma_f32_32x32x16_bf16 v[32:47], v[112:115], v[128:131], v[32:47]
    v_mfma_f32_32x32x16_bf16 v[48:63], v[112:115], v[136:139], v[48:63]
    ds_read_b64_tr_b16 v[112:113], v165 offset:4608
    ds_read_b64_tr_b16 v[114:115], v165 offset:6912
    v_mfma_f32_32x32x16_bf16 v[32:47], v[116:119], v[132:135], v[32:47]
    ds_read_b128 v[128:131], v160 offset:1024
    ds_read_b128 v[136:139], v160 offset:37888
    v_mfma_f32_32x32x16_bf16 v[48:63], v[116:119], v[140:143], v[48:63]
    ds_read_b64_tr_b16 v[116:117], v165 offset:5760
    ds_read_b64_tr_b16 v[118:119], v165 offset:8064
    ds_read_b128 v[132:135], v161 offset:1024
    ds_read_b128 v[140:143], v161 offset:37888
    s_waitcnt lgkmcnt(8)
    v_mfma_f32_32x32x16_bf16 v[32:47], v[120:123], v[144:147], v[32:47]
    v_mfma_f32_32x32x16_bf16 v[48:63], v[120:123], v[152:155], v[48:63]
    ds_read_b64_tr_b16 v[120:121], v165 offset:9216
    ds_read_b64_tr_b16 v[122:123], v165 offset:11520
    v_mfma_f32_32x32x16_bf16 v[32:47], v[124:127], v[148:151], v[32:47]
    ds_read_b128 v[144:147], v162 offset:1024
    ds_read_b128 v[152:155], v162 offset:37888
    v_mfma_f32_32x32x16_bf16 v[48:63], v[124:127], v[156:159], v[48:63]
    ds_read_b64_tr_b16 v[124:125], v165 offset:10368
    ds_read_b64_tr_b16 v[126:127], v165 offset:12672
    ds_read_b128 v[148:151], v163 offset:1024
    ds_read_b128 v[156:159], v163 offset:37888
    s_waitcnt lgkmcnt(8)
    s_waitcnt vmcnt(0)
    v_cmp_gt_u32 vcc, 16, v203
    v_cmp_gt_u32 s[90:91], 2, v201
    s_nop 3
    s_or_b64 vcc, vcc, s[90:91]
    s_cbranch_vccnz LM_qearly_14
    s_cmp_lg_u32 s7, 3
    s_cbranch_scc1 LM_kvt_15
    s_lshr_b32 s9, s2, 3
    s_mul_i32 s9, s9, 4864
    s_add_u32 s9, s9, 0
    v_min_u32 v5, 38, v1
    v_lshlrev_b32 v5, 7, v5
    buffer_load_dword v203, v5, s[68:71], s9 offen sc1
LM_kvt_15:
    s_add_u32 m0, s87, 0
    s_nop 0
    buffer_load_dwordx4 v184, s[68:71], s86 offen sc1 lds
    s_mov_b64 exec, 0xfff
    buffer_load_dwordx4 v184, s[68:71], s86 offen offset:1024 sc1 lds
    s_mov_b64 exec, -1
    s_add_u32 s86, s86, 4864
    s_add_u32 m0, s87, 4864
    s_nop 0
    buffer_load_dwordx4 v184, s[68:71], s86 offen sc1 lds
    s_mov_b64 exec, 0xfff
    buffer_load_dwordx4 v184, s[68:71], s86 offen offset:1024 sc1 lds
    s_mov_b64 exec, -1
    s_add_u32 s86, s86, 4864
    s_add_u32 m0, s87, 9728
    s_nop 0
    buffer_load_dwordx4 v184, s[68:71], s86 offen sc1 lds
    s_mov_b64 exec, 0xfff
    buffer_load_dwordx4 v184, s[68:71], s86 offen offset:1024 sc1 lds
    s_mov_b64 exec, -1
    s_add_u32 s86, s86, 4864
    s_mov_b32 s89, 1
LM_qearly_14:
    v_mfma_f32_32x32x16_bf16 v[32:47], v[112:115], v[128:131], v[32:47]
    v_mfma_f32_32x32x16_bf16 v[48:63], v[112:115], v[136:139], v[48:63]
    v_mfma_f32_32x32x16_bf16 v[32:47], v[116:119], v[132:135], v[32:47]
    v_mfma_f32_32x32x16_bf16 v[48:63], v[116:119], v[140:143], v[48:63]
    s_waitcnt lgkmcnt(0)
    ds_write_b32 v183, v200
    v_mfma_f32_32x32x16_bf16 v[32:47], v[120:123], v[144:147], v[32:47]
    v_mfma_f32_32x32x16_bf16 v[48:63], v[120:123], v[152:155], v[48:63]
    v_mfma_f32_32x32x16_bf16 v[32:47], v[124:127], v[148:151], v[32:47]
    v_mfma_f32_32x32x16_bf16 v[48:63], v[124:127], v[156:159], v[48:63]
    s_mov_b32 s9, 1051597459
    s_nop 15
    v_mul_f32 v32, s9, v32
    v_mul_f32 v33, s9, v33
    v_mul_f32 v34, s9, v34
    v_mul_f32 v35, s9, v35
    v_mul_f32 v36, s9, v36
    v_mul_f32 v37, s9, v37
    v_mul_f32 v38, s9, v38
    v_mul_f32 v39, s9, v39
    v_mul_f32 v40, s9, v40
    v_mul_f32 v41, s9, v41
    v_mul_f32 v42, s9, v42
    v_mul_f32 v43, s9, v43
    v_mul_f32 v44, s9, v44
    v_mul_f32 v45, s9, v45
    v_mul_f32 v46, s9, v46
    v_mul_f32 v47, s9, v47
    v_mul_f32 v48, s9, v48
    v_mul_f32 v49, s9, v49
    v_mul_f32 v50, s9, v50
    v_mul_f32 v51, s9, v51
    v_mul_f32 v52, s9, v52
    v_mul_f32 v53, s9, v53
    v_mul_f32 v54, s9, v54
    v_mul_f32 v55, s9, v55
    v_mul_f32 v56, s9, v56
    v_mul_f32 v57, s9, v57
    v_mul_f32 v58, s9, v58
    v_mul_f32 v59, s9, v59
    v_mul_f32 v60, s9, v60
    v_mul_f32 v61, s9, v61
    v_mul_f32 v62, s9, v62
    v_mul_f32 v63, s9, v63
    s_bitcmp1_b32 s7, 0
    s_cbranch_scc1 LM_odd_16
    v_cvt_pk_bf16_f32 v16, v32, v33
    v_cvt_pk_bf16_f32 v17, v34, v35
    v_cvt_pk_bf16_f32 v18, v36, v37
    v_cvt_pk_bf16_f32 v19, v38, v39
    v_cvt_pk_bf16_f32 v194, v40, v41
    v_cndmask_b32 v24, 0, v194, s[80:81]
    v_cvt_pk_bf16_f32 v20, v48, v49
    v_cvt_pk_bf16_f32 v21, v50, v51
    v_cvt_pk_bf16_f32 v22, v52, v53
    v_cvt_pk_bf16_f32 v23, v54, v55
    v_cvt_pk_bf16_f32 v194, v56, v57
    v_cndmask_b32 v28, 0, v194, s[80:81]
    s_branch LM_qdone_17
LM_odd_16:
    v_cvt_pk_bf16_f32 v16, v34, v35
    v_cvt_pk_bf16_f32 v17, v36, v37
    v_cvt_pk_bf16_f32 v18, v38, v39
    v_cvt_pk_bf16_f32 v19, v40, v41
    v_cvt_pk_bf16_f32 v194, v46, v47
    v_cndmask_b32 v24, 0, v194, s[80:81]
    v_cvt_pk_bf16_f32 v20, v50, v51
    v_cvt_pk_bf16_f32 v21, v52, v53
    v_cvt_pk_bf16_f32 v22, v54, v55
    v_cvt_pk_bf16_f32 v23, v56, v57
    v_cvt_pk_bf16_f32 v194, v62, v63
    v_cndmask_b32 v28, 0, v194, s[80:81]
LM_qdone_17:
    v_mov_b32 v25, 0
    v_mov_b32 v26, 0
    v_mov_b32 v27, 0
    v_mov_b32 v29, 0
    v_mov_b32 v30, 0
    v_mov_b32 v31, 0
    v_mov_b32 v117, 0x3f803f80
    v_mov_b32 v118, 0x3f80
    v_mov_b32 v119, 0
    v_mov_b32 v133, 0x3f803f80
    v_mov_b32 v134, 0x3f80
    v_mov_b32 v135, 0
    v_mov_b32 v149, 0x3f803f80
    v_mov_b32 v150, 0x3f80
    v_mov_b32 v151, 0
    v_mov_b32 v165, 0x3f803f80
    v_mov_b32 v166, 0x3f80
    v_mov_b32 v167, 0
    v_mov_b32 v172, 0
    v_mov_b32 v173, 0
    v_mov_b32 v174, 0
    v_mov_b32 v175, 0
    s_cmp_eq_u32 s89, 1
    s_cbranch_scc1 LM_kvearly_18
    s_mov_b32 s12, s38
    s_and_b32 s13, s39, 0xffff
    s_mov_b32 s14, 256
    s_mov_b32 s15, 0x00020000
    v_and_b32 v202, 15, v1
    v_lshlrev_b32 v202, 4, v202
LM_gpoll_19:
    buffer_load_dword v203, v202, s[12:15], 0 offen sc1
    s_waitcnt vmcnt(0)
    v_cmp_gt_u32 vcc, 16, v203
    s_nop 4
    s_cbranch_vccz LM_gpolld_20
    s_sleep 8
    s_branch LM_gpoll_19
LM_gpolld_20:
    v_add_u32 v2, 112, v181
LM_gsa_21:
    ds_read_b32 v182, v2
    s_waitcnt lgkmcnt(0)
    v_cmp_gt_u32 vcc, 2, v182
    s_nop 4
    s_cbranch_vccz LM_gsad_22
    s_sleep 1
    s_branch LM_gsa_21
LM_gsad_22:
    s_cmp_lg_u32 s7, 3
    s_cbranch_scc1 LM_kvt_23
    s_lshr_b32 s9, s2, 3
    s_mul_i32 s9, s9, 4864
    s_add_u32 s9, s9, 0
    v_min_u32 v5, 38, v1
    v_lshlrev_b32 v5, 7, v5
    buffer_load_dword v203, v5, s[68:71], s9 offen sc1
LM_kvt_23:
    s_add_u32 m0, s87, 0
    s_nop 0
    buffer_load_dwordx4 v184, s[68:71], s86 offen sc1 lds
    s_mov_b64 exec, 0xfff
    buffer_load_dwordx4 v184, s[68:71], s86 offen offset:1024 sc1 lds
    s_mov_b64 exec, -1
    s_add_u32 s86, s86, 4864
    s_add_u32 m0, s87, 4864
    s_nop 0
    buffer_load_dwordx4 v184, s[68:71], s86 offen sc1 lds
    s_mov_b64 exec, 0xfff
    buffer_load_dwordx4 v184, s[68:71], s86 offen offset:1024 sc1 lds
    s_mov_b64 exec, -1
    s_add_u32 s86, s86, 4864
    s_add_u32 m0, s87, 9728
    s_nop 0
    buffer_load_dwordx4 v184, s[68:71], s86 offen sc1 lds
    s_mov_b64 exec, 0xfff
    buffer_load_dwordx4 v184, s[68:71], s86 offen offset:1024 sc1 lds
    s_mov_b64 exec, -1
    s_add_u32 s86, s86, 4864
    s_mov_b32 s89, 1
LM_kvearly_18:
    s_setprio 2
    s_waitcnt vmcnt(4)
    v_mov_b32 v200, 3
    ds_write_b32 v183, v200
LM_kb_24:
    ds_read_b32 v182, v181
    s_waitcnt lgkmcnt(0)
    v_cmp_gt_u32 vcc, 3, v182
    s_nop 4
    s_cbranch_vccz LM_kbd_25
    s_sleep 1
    s_branch LM_kb_24
LM_kbd_25:
    ds_read_b128 v[112:115], v178 offset:0
    ds_read_b32 v116, v179 offset:0
    ds_read_b128 v[120:123], v180 offset:0
    ds_read_b128 v[124:127], v180 offset:640
    ds_read_b128 v[128:131], v178 offset:2432
    ds_read_b32 v132, v179 offset:2432
    ds_read_b128 v[136:139], v180 offset:2432
    ds_read_b128 v[140:143], v180 offset:3072
    s_waitcnt lgkmcnt(0)
    v_mfma_f32_32x32x16_bf16 v[32:47], v[112:115], v[16:19], 0
    v_mfma_f32_32x32x16_bf16 v[32:47], v[116:119], v[24:27], v[32:47]
    v_mfma_f32_32x32x16_bf16 v[48:63], v[112:115], v[20:23], 0
    v_mfma_f32_32x32x16_bf16 v[48:63], v[116:119], v[28:31], v[48:63]
    s_nop 15
    s_nop 3
    v_max_f32 v196, v32, v47
    v_max3_f32 v196, v196, v33, v34
    v_max3_f32 v196, v196, v35, v36
    v_max3_f32 v196, v196, v37, v38
    v_max3_f32 v196, v196, v39, v40
    v_max3_f32 v196, v196, v41, v42
    v_max3_f32 v196, v196, v43, v44
    v_max3_f32 v196, v196, v45, v46
    v_max_f32 v197, v48, v63
    v_max3_f32 v197, v197, v49, v50
    v_max3_f32 v197, v197, v51, v52
    v_max3_f32 v197, v197, v53, v54
    v_max3_f32 v197, v197, v55, v56
    v_max3_f32 v197, v197, v57, v58
    v_max3_f32 v197, v197, v59, v60
    v_max3_f32 v197, v197, v61, v62
    v_mfma_f32_32x32x16_bf16 v[32:47], v[128:131], v[16:19], 0
    v_mfma_f32_32x32x16_bf16 v[32:47], v[132:135], v[24:27], v[32:47]
    v_mfma_f32_32x32x16_bf16 v[48:63], v[128:131], v[20:23], 0
    v_mfma_f32_32x32x16_bf16 v[48:63], v[132:135], v[28:31], v[48:63]
    s_nop 15
    s_nop 3
    v_max3_f32 v196, v196, v32, v47
    v_max3_f32 v196, v196, v33, v34
    v_max3_f32 v196, v196, v35, v36
    v_max3_f32 v196, v196, v37, v38
    v_max3_f32 v196, v196, v39, v40
    v_max3_f32 v196, v196, v41, v42
    v_max3_f32 v196, v196, v43, v44
    v_max3_f32 v196, v196, v45, v46
    v_max3_f32 v197, v197, v48, v63
    v_max3_f32 v197, v197, v49, v50
    v_max3_f32 v197, v197, v51, v52
    v_max3_f32 v197, v197, v53, v54
    v_max3_f32 v197, v197, v55, v56
    v_max3_f32 v197, v197, v57, v58
    v_max3_f32 v197, v197, v59, v60
    v_max3_f32 v197, v197, v61, v62
    v_mov_b32 v187, v196
    s_nop 1
    v_permlane32_swap_b32 v196, v187
    s_nop 1
    v_max_f32 v186, v196, v187
    v_ceil_f32 v186, v186
    v_add_f32 v176, 1116733440, v186
    v_sub_f32 v186, 0, v176
    v_and_b32 v187, 0xffff0000, v186
    v_sub_f32 v186, v186, v187
    v_and_b32 v188, 0xffff0000, v186
    v_sub_f32 v186, v186, v188
    v_lshrrev_b32 v187, 16, v187
    v_or_b32 v187, v187, v188
    v_lshrrev_b32 v186, 16, v186
    v_cndmask_b32 v25, 0, v187, s[80:81]
    v_cndmask_b32 v26, 0, v186, s[80:81]
    v_mov_b32 v187, v197
    s_nop 1
    v_permlane32_swap_b32 v197, v187
    s_nop 1
    v_max_f32 v186, v197, v187
    v_ceil_f32 v186, v186
    v_add_f32 v177, 1116733440, v186
    v_sub_f32 v186, 0, v177
    v_and_b32 v187, 0xffff0000, v186
    v_sub_f32 v186, v186, v187
    v_and_b32 v188, 0xffff0000, v186
    v_sub_f32 v186, v186, v188
    v_lshrrev_b32 v187, 16, v187
    v_or_b32 v187, v187, v188
    v_lshrrev_b32 v186, 16, v186
    v_cndmask_b32 v29, 0, v187, s[80:81]
    v_cndmask_b32 v30, 0, v186, s[80:81]
    s_nop 1
    v_mfma_f32_32x32x16_bf16 v[32:47], v[112:115], v[16:19], 0
    v_mfma_f32_32x32x16_bf16 v[32:47], v[116:119], v[24:27], v[32:47]
    s_nop 15
    s_mov_b32 s94, 0
    s_mov_b32 s84, 0
    s_mov_b32 s85, 4
LM_aloop_26:
    v_mfma_f32_32x32x16_bf16 v[48:63], v[112:115], v[20:23], 0
    v_exp_f32 v32, v32
    v_exp_f32 v33, v33
    s_waitcnt vmcnt(2)
    v_exp_f32 v34, v34
    v_mov_b32 v200, s85
    v_exp_f32 v35, v35
    ds_write_b32 v183, v200
    v_cvt_pk_bf16_f32 v64, v32, v33
    v_cvt_pk_bf16_f32 v65, v34, v35
    v_mfma_f32_32x32x16_bf16 v[48:63], v[116:119], v[28:31], v[48:63]
    v_exp_f32 v36, v36
    v_exp_f32 v37, v37
    v_exp_f32 v38, v38
    v_exp_f32 v39, v39
    v_cvt_pk_bf16_f32 v66, v36, v37
    v_cvt_pk_bf16_f32 v67, v38, v39
    v_mfma_f32_32x32x16_bf16 v[96:111], v[172:175], v[76:79], v[96:111]
    v_exp_f32 v40, v40
    v_exp_f32 v41, v41
    v_exp_f32 v42, v42
    v_exp_f32 v43, v43
    v_cvt_pk_bf16_f32 v68, v40, v41
    v_cvt_pk_bf16_f32 v69, v42, v43
    v_mfma_f32_32x32x16_bf16 v[80:95], v[120:123], v[64:67], v[80:95]
    v_exp_f32 v44, v44
    v_exp_f32 v45, v45
    ds_read_b32 v182, v181
    v_exp_f32 v46, v46
    v_exp_f32 v47, v47
    v_cvt_pk_bf16_f32 v70, v44, v45
    v_cvt_pk_bf16_f32 v71, v46, v47
    v_mfma_f32_32x32x16_bf16 v[32:47], v[128:131], v[16:19], 0
    v_exp_f32 v48, v48
    v_exp_f32 v49, v49
    v_exp_f32 v50, v50
    v_exp_f32 v51, v51
    v_cvt_pk_bf16_f32 v72, v48, v49
    v_cvt_pk_bf16_f32 v73, v50, v51
    v_mfma_f32_32x32x16_bf16 v[32:47], v[132:135], v[24:27], v[32:47]
    v_exp_f32 v52, v52
    s_waitcnt lgkmcnt(0)
    v_exp_f32 v53, v53
    v_cmp_gt_u32 vcc, s85, v182
    v_exp_f32 v54, v54
    v_exp_f32 v55, v55
    v_cvt_pk_bf16_f32 v74, v52, v53
    v_cvt_pk_bf16_f32 v75, v54, v55
    v_mfma_f32_32x32x16_bf16 v[80:95], v[124:127], v[68:71], v[80:95]
    v_exp_f32 v56, v56
    s_cbranch_vccnz LM_aspin_28
    LM_aback_29:
    v_exp_f32 v57, v57
    ds_read_b128 v[144:147], v178 offset:4864
    v_exp_f32 v58, v58
    ds_read_b32 v148, v179 offset:4864
    v_exp_f32 v59, v59
    ds_read_b128 v[160:163], v178 offset:7296
    v_cvt_pk_bf16_f32 v76, v56, v57
    v_cmp_lt_f32 s[92:93], s88, v106
    v_cvt_pk_bf16_f32 v77, v58, v59
    v_mfma_f32_32x32x16_bf16 v[96:111], v[120:123], v[72:75], v[96:111]
    v_exp_f32 v60, v60
    ds_read_b32 v164, v179 offset:7296
    v_exp_f32 v61, v61
    ds_read_b128 v[152:155], v180 offset:4864
    v_exp_f32 v62, v62
    ds_read_b128 v[156:159], v180 offset:5504
    v_exp_f32 v63, v63
    ds_read_b128 v[168:171], v180 offset:7296
    v_cvt_pk_bf16_f32 v78, v60, v61
    v_cvt_pk_bf16_f32 v79, v62, v63
    s_cmp_lg_u64 s[92:93], 0
    s_cbranch_scc1 LM_rare1_30
    LM_rback1_31:
    v_mfma_f32_32x32x16_bf16 v[48:63], v[128:131], v[20:23], 0
    v_exp_f32 v32, v32
    ds_read_b128 v[172:175], v180 offset:7936
    v_exp_f32 v33, v33
    s_add_u32 m0, s87, 0
    v_exp_f32 v34, v34
    buffer_load_dwordx4 v184, s[68:71], s86 offen sc1 lds
    v_exp_f32 v35, v35
    v_cvt_pk_bf16_f32 v64, v32, v33
    v_cvt_pk_bf16_f32 v65, v34, v35
    v_mfma_f32_32x32x16_bf16 v[48:63], v[132:135], v[28:31], v[48:63]
    v_exp_f32 v36, v36
    v_exp_f32 v37, v37
    s_mov_b64 exec, 0xfff
    buffer_load_dwordx4 v184, s[68:71], s86 offen offset:1024 sc1 lds
    s_mov_b64 exec, -1
    v_exp_f32 v38, v38
    v_exp_f32 v39, v39
    s_add_u32 s86, s86, 4864
    v_cvt_pk_bf16_f32 v66, v36, v37
    v_cvt_pk_bf16_f32 v67, v38, v39
    v_mfma_f32_32x32x16_bf16 v[96:111], v[124:127], v[76:79], v[96:111]
    v_exp_f32 v40, v40
    v_exp_f32 v41, v41
    v_exp_f32 v42, v42
    v_exp_f32 v43, v43
    v_cvt_pk_bf16_f32 v68, v40, v41
    v_cmp_lt_f32 s[90:91], s88, v90
    v_cvt_pk_bf16_f32 v69, v42, v43
    v_mfma_f32_32x32x16_bf16 v[80:95], v[136:139], v[64:67], v[80:95]
    v_exp_f32 v44, v44
    v_exp_f32 v45, v45
    v_exp_f32 v46, v46
    v_exp_f32 v47, v47
    v_cvt_pk_bf16_f32 v70, v44, v45
    v_cvt_pk_bf16_f32 v71, v46, v47
    s_waitcnt lgkmcnt(0)
    s_cmp_lg_u64 s[90:91], 0
    s_cbranch_scc1 LM_rare0_32
    LM_rback0_33:
    v_mfma_f32_32x32x16_bf16 v[32:47], v[144:147], v[16:19], 0
    v_exp_f32 v48, v48
    v_exp_f32 v49, v49
    v_exp_f32 v50, v50
    v_exp_f32 v51, v51
    v_cvt_pk_bf16_f32 v72, v48, v49
    v_cvt_pk_bf16_f32 v73, v50, v51
    v_mfma_f32_32x32x16_bf16 v[32:47], v[148:151], v[24:27], v[32:47]
    v_exp_f32 v52, v52
    v_exp_f32 v53, v53
    v_exp_f32 v54, v54
    v_exp_f32 v55, v55
    v_cvt_pk_bf16_f32 v74, v52, v53
    v_cvt_pk_bf16_f32 v75, v54, v55
    v_mfma_f32_32x32x16_bf16 v[80:95], v[140:143], v[68:71], v[80:95]
    v_exp_f32 v56, v56
    v_exp_f32 v57, v57
    s_add_u32 s85, s85, 1
    v_exp_f32 v58, v58
    v_exp_f32 v59, v59
    v_cvt_pk_bf16_f32 v76, v56, v57
    v_cvt_pk_bf16_f32 v77, v58, v59
    v_mfma_f32_32x32x16_bf16 v[96:111], v[136:139], v[72:75], v[96:111]
    v_exp_f32 v60, v60
    v_exp_f32 v61, v61
    v_exp_f32 v62, v62
    v_exp_f32 v63, v63
    v_cvt_pk_bf16_f32 v78, v60, v61
    v_cvt_pk_bf16_f32 v79, v62, v63
    v_mfma_f32_32x32x16_bf16 v[48:63], v[144:147], v[20:23], 0
    v_exp_f32 v32, v32
    v_exp_f32 v33, v33
    s_waitcnt vmcnt(2)
    v_exp_f32 v34, v34
    v_mov_b32 v200, s85
    v_exp_f32 v35, v35
    ds_write_b32 v183, v200
    v_cvt_pk_bf16_f32 v64, v32, v33
    v_cvt_pk_bf16_f32 v65, v34, v35
    v_mfma_f32_32x32x16_bf16 v[48:63], v[148:151], v[28:31], v[48:63]
    v_exp_f32 v36, v36
    v_exp_f32 v37, v37
    v_exp_f32 v38, v38
    v_exp_f32 v39, v39
    v_cvt_pk_bf16_f32 v66, v36, v37
    v_cvt_pk_bf16_f32 v67, v38, v39
    v_mfma_f32_32x32x16_bf16 v[96:111], v[140:143], v[76:79], v[96:111]
    v_exp_f32 v40, v40
    v_exp_f32 v41, v41
    v_exp_f32 v42, v42
    v_exp_f32 v43, v43
    v_cvt_pk_bf16_f32 v68, v40, v41
    v_cvt_pk_bf16_f32 v69, v42, v43
    v_mfma_f32_32x32x16_bf16 v[80:95], v[152:155], v[64:67], v[80:95]
    v_exp_f32 v44, v44
    v_exp_f32 v45, v45
    ds_read_b32 v182, v181
    v_exp_f32 v46, v46
    v_exp_f32 v47, v47
    v_cvt_pk_bf16_f32 v70, v44, v45
    v_cvt_pk_bf16_f32 v71, v46, v47
    v_mfma_f32_32x32x16_bf16 v[32:47], v[160:163], v[16:19], 0
    v_exp_f32 v48, v48
    v_exp_f32 v49, v49
    v_exp_f32 v50, v50
    v_exp_f32 v51, v51
    v_cvt_pk_bf16_f32 v72, v48, v49
    v_cvt_pk_bf16_f32 v73, v50, v51
    v_mfma_f32_32x32x16_bf16 v[32:47], v[164:167], v[24:27], v[32:47]
    v_exp_f32 v52, v52
    s_waitcnt lgkmcnt(0)
    v_exp_f32 v53, v53
    v_cmp_gt_u32 vcc, s85, v182
    v_exp_f32 v54, v54
    v_exp_f32 v55, v55
    v_cvt_pk_bf16_f32 v74, v52, v53
    v_cvt_pk_bf16_f32 v75, v54, v55
    v_mfma_f32_32x32x16_bf16 v[80:95], v[156:159], v[68:71], v[80:95]
    v_exp_f32 v56, v56
    s_cbranch_vccnz LM_aspin_34
    LM_aback_35:
    v_exp_f32 v57, v57
    ds_read_b128 v[112:115], v178 offset:9728
    v_exp_f32 v58, v58
    ds_read_b32 v116, v179 offset:9728
    v_exp_f32 v59, v59
    ds_read_b128 v[128:131], v178 offset:12160
    v_cvt_pk_bf16_f32 v76, v56, v57
    v_cvt_pk_bf16_f32 v77, v58, v59
    v_mfma_f32_32x32x16_bf16 v[96:111], v[152:155], v[72:75], v[96:111]
    v_exp_f32 v60, v60
    ds_read_b32 v132, v179 offset:12160
    v_exp_f32 v61, v61
    ds_read_b128 v[120:123], v180 offset:9728
    v_exp_f32 v62, v62
    ds_read_b128 v[124:127], v180 offset:10368
    v_exp_f32 v63, v63
    ds_read_b128 v[136:139], v180 offset:12160
    v_cvt_pk_bf16_f32 v78, v60, v61
    v_cvt_pk_bf16_f32 v79, v62, v63
    v_mfma_f32_32x32x16_bf16 v[48:63], v[160:163], v[20:23], 0
    v_exp_f32 v32, v32
    ds_read_b128 v[140:143], v180 offset:12800
    v_exp_f32 v33, v33
    s_add_u32 m0, s87, 4864
    v_exp_f32 v34, v34
    buffer_load_dwordx4 v184, s[68:71], s86 offen sc1 lds
    v_exp_f32 v35, v35
    v_cvt_pk_bf16_f32 v64, v32, v33
    v_cvt_pk_bf16_f32 v65, v34, v35
    v_mfma_f32_32x32x16_bf16 v[48:63], v[164:167], v[28:31], v[48:63]
    v_exp_f32 v36, v36
    v_exp_f32 v37, v37
    s_mov_b64 exec, 0xfff
    buffer_load_dwordx4 v184, s[68:71], s86 offen offset:1024 sc1 lds
    s_mov_b64 exec, -1
    v_exp_f32 v38, v38
    v_exp_f32 v39, v39
    s_add_u32 s86, s86, 4864
    v_cvt_pk_bf16_f32 v66, v36, v37
    v_cvt_pk_bf16_f32 v67, v38, v39
    v_mfma_f32_32x32x16_bf16 v[96:111], v[156:159], v[76:79], v[96:111]
    v_exp_f32 v40, v40
    v_exp_f32 v41, v41
    v_exp_f32 v42, v42
    v_exp_f32 v43, v43
    v_cvt_pk_bf16_f32 v68, v40, v41
    v_cvt_pk_bf16_f32 v69, v42, v43
    v_mfma_f32_32x32x16_bf16 v[80:95], v[168:171], v[64:67], v[80:95]
    v_exp_f32 v44, v44
    v_exp_f32 v45, v45
    v_exp_f32 v46, v46
    v_exp_f32 v47, v47
    v_cvt_pk_bf16_f32 v70, v44, v45
    v_cvt_pk_bf16_f32 v71, v46, v47
    s_waitcnt lgkmcnt(0)
    v_mfma_f32_32x32x16_bf16 v[32:47], v[112:115], v[16:19], 0
    v_exp_f32 v48, v48
    v_exp_f32 v49, v49
    v_exp_f32 v50, v50
    v_exp_f32 v51, v51
    v_cvt_pk_bf16_f32 v72, v48, v49
    v_cvt_pk_bf16_f32 v73, v50, v51
    v_mfma_f32_32x32x16_bf16 v[32:47], v[116:119], v[24:27], v[32:47]
    v_exp_f32 v52, v52
    v_exp_f32 v53, v53
    v_exp_f32 v54, v54
    v_exp_f32 v55, v55
    v_cvt_pk_bf16_f32 v74, v52, v53
    v_cvt_pk_bf16_f32 v75, v54, v55
    v_mfma_f32_32x32x16_bf16 v[80:95], v[172:175], v[68:71], v[80:95]
    v_exp_f32 v56, v56
    v_exp_f32 v57, v57
    s_add_u32 s85, s85, 1
    v_exp_f32 v58, v58
    s_cmp_eq_u32 s85, 36
    v_exp_f32 v59, v59
    v_cvt_pk_bf16_f32 v76, v56, v57
    v_cvt_pk_bf16_f32 v77, v58, v59
    v_mfma_f32_32x32x16_bf16 v[96:111], v[168:171], v[72:75], v[96:111]
    v_exp_f32 v60, v60
    v_exp_f32 v61, v61
    v_exp_f32 v62, v62
    v_exp_f32 v63, v63
    v_cvt_pk_bf16_f32 v78, v60, v61
    v_cvt_pk_bf16_f32 v79, v62, v63
    s_cbranch_scc1 LM_aexit_27
    v_mfma_f32_32x32x16_bf16 v[48:63], v[112:115], v[20:23], 0
    v_exp_f32 v32, v32
    v_exp_f32 v33, v33
    s_waitcnt vmcnt(2)
    v_exp_f32 v34, v34
    v_mov_b32 v200, s85
    v_exp_f32 v35, v35
    ds_write_b32 v183, v200
    v_cvt_pk_bf16_f32 v64, v32, v33
    v_cvt_pk_bf16_f32 v65, v34, v35
    v_mfma_f32_32x32x16_bf16 v[48:63], v[116:119], v[28:31], v[48:63]
    v_exp_f32 v36, v36
    v_exp_f32 v37, v37
    v_exp_f32 v38, v38
    v_exp_f32 v39, v39
    v_cvt_pk_bf16_f32 v66, v36, v37
    v_cvt_pk_bf16_f32 v67, v38, v39
    v_mfma_f32_32x32x16_bf16 v[96:111], v[172:175], v[76:79], v[96:111]
    v_exp_f32 v40, v40
    v_exp_f32 v41, v41
    v_exp_f32 v42, v42
    v_exp_f32 v43, v43
    v_cvt_pk_bf16_f32 v68, v40, v41
    v_cvt_pk_bf16_f32 v69, v42, v43
    v_mfma_f32_32x32x16_bf16 v[80:95], v[120:123], v[64:67], v[80:95]
    v_exp_f32 v44, v44
    v_exp_f32 v45, v45
    ds_read_b32 v182, v181
    v_exp_f32 v46, v46
    v_exp_f32 v47, v47
    v_cvt_pk_bf16_f32 v70, v44, v45
    v_cvt_pk_bf16_f32 v71, v46, v47
    v_mfma_f32_32x32x16_bf16 v[32:47], v[128:131], v[16:19], 0
    v_exp_f32 v48, v48
    v_exp_f32 v49, v49
    v_exp_f32 v50, v50
    v_exp_f32 v51, v51
    v_cvt_pk_bf16_f32 v72, v48, v49
    v_cvt_pk_bf16_f32 v73, v50, v51
    v_mfma_f32_32x32x16_bf16 v[32:47], v[132:135], v[24:27], v[32:47]
    v_exp_f32 v52, v52
    s_waitcnt lgkmcnt(0)
    v_exp_f32 v53, v53
    v_cmp_gt_u32 vcc, s85, v182
    v_exp_f32 v54, v54
    v_exp_f32 v55, v55
    v_cvt_pk_bf16_f32 v74, v52, v53
    v_cvt_pk_bf16_f32 v75, v54, v55
    v_mfma_f32_32x32x16_bf16 v[80:95], v[124:127], v[68:71], v[80:95]
    v_exp_f32 v56, v56
    s_cbranch_vccnz LM_aspin_36
    LM_aback_37:
    v_exp_f32 v57, v57
    ds_read_b128 v[144:147], v178 offset:0
    v_exp_f32 v58, v58
    ds_read_b32 v148, v179 offset:0
    v_exp_f32 v59, v59
    ds_read_b128 v[160:163], v178 offset:2432
    v_cvt_pk_bf16_f32 v76, v56, v57
    v_cmp_lt_f32 s[92:93], s88, v106
    v_cvt_pk_bf16_f32 v77, v58, v59
    v_mfma_f32_32x32x16_bf16 v[96:111], v[120:123], v[72:75], v[96:111]
    v_exp_f32 v60, v60
    ds_read_b32 v164, v179 offset:2432
    v_exp_f32 v61, v61
    ds_read_b128 v[152:155], v180 offset:0
    v_exp_f32 v62, v62
    ds_read_b128 v[156:159], v180 offset:640
    v_exp_f32 v63, v63
    ds_read_b128 v[168:171], v180 offset:2432
    v_cvt_pk_bf16_f32 v78, v60, v61
    v_cvt_pk_bf16_f32 v79, v62, v63
    s_cmp_lg_u64 s[92:93], 0
    s_cbranch_scc1 LM_rare1_38
    LM_rback1_39:
    v_mfma_f32_32x32x16_bf16 v[48:63], v[128:131], v[20:23], 0
    v_exp_f32 v32, v32
    ds_read_b128 v[172:175], v180 offset:3072
    v_exp_f32 v33, v33
    s_add_u32 m0, s87, 9728
    v_exp_f32 v34, v34
    buffer_load_dwordx4 v184, s[68:71], s86 offen sc1 lds
    v_exp_f32 v35, v35
    v_cvt_pk_bf16_f32 v64, v32, v33
    v_cvt_pk_bf16_f32 v65, v34, v35
    v_mfma_f32_32x32x16_bf16 v[48:63], v[132:135], v[28:31], v[48:63]
    v_exp_f32 v36, v36
    v_exp_f32 v37, v37
    s_mov_b64 exec, 0xfff
    buffer_load_dwordx4 v184, s[68:71], s86 offen offset:1024 sc1 lds
    s_mov_b64 exec, -1
    v_exp_f32 v38, v38
    v_exp_f32 v39, v39
    s_add_u32 s86, s86, 4864
    v_cvt_pk_bf16_f32 v66, v36, v37
    v_cvt_pk_bf16_f32 v67, v38, v39
    v_mfma_f32_32x32x16_bf16 v[96:111], v[124:127], v[76:79], v[96:111]
    v_exp_f32 v40, v40
    v_exp_f32 v41, v41
    v_exp_f32 v42, v42
    v_exp_f32 v43, v43
    v_cvt_pk_bf16_f32 v68, v40, v41
    v_cmp_lt_f32 s[90:91], s88, v90
    v_cvt_pk_bf16_f32 v69, v42, v43
    v_mfma_f32_32x32x16_bf16 v[80:95], v[136:139], v[64:67], v[80:95]
    v_exp_f32 v44, v44
    v_exp_f32 v45, v45
    v_exp_f32 v46, v46
    v_exp_f32 v47, v47
    v_cvt_pk_bf16_f32 v70, v44, v45
    v_cvt_pk_bf16_f32 v71, v46, v47
    s_waitcnt lgkmcnt(0)
    s_cmp_lg_u64 s[90:91], 0
    s_cbranch_scc1 LM_rare0_40
    LM_rback0_41:
    v_mfma_f32_32x32x16_bf16 v[32:47], v[144:147], v[16:19], 0
    v_exp_f32 v48, v48
    v_exp_f32 v49, v49
    v_exp_f32 v50, v50
    v_exp_f32 v51, v51
    v_cvt_pk_bf16_f32 v72, v48, v49
    v_cvt_pk_bf16_f32 v73, v50, v51
    v_mfma_f32_32x32x16_bf16 v[32:47], v[148:151], v[24:27], v[32:47]
    v_exp_f32 v52, v52
    v_exp_f32 v53, v53
    v_exp_f32 v54, v54
    v_exp_f32 v55, v55
    v_cvt_pk_bf16_f32 v74, v52, v53
    v_cvt_pk_bf16_f32 v75, v54, v55
    v_mfma_f32_32x32x16_bf16 v[80:95], v[140:143], v[68:71], v[80:95]
    v_exp_f32 v56, v56
    v_exp_f32 v57, v57
    s_add_u32 s85, s85, 1
    v_exp_f32 v58, v58
    v_exp_f32 v59, v59
    v_cvt_pk_bf16_f32 v76, v56, v57
    v_cvt_pk_bf16_f32 v77, v58, v59
    v_mfma_f32_32x32x16_bf16 v[96:111], v[136:139], v[72:75], v[96:111]
    v_exp_f32 v60, v60
    v_exp_f32 v61, v61
    v_exp_f32 v62, v62
    v_exp_f32 v63, v63
    v_cvt_pk_bf16_f32 v78, v60, v61
    v_cvt_pk_bf16_f32 v79, v62, v63
    v_mfma_f32_32x32x16_bf16 v[48:63], v[144:147], v[20:23], 0
    v_exp_f32 v32, v32
    v_exp_f32 v33, v33
    s_waitcnt vmcnt(2)
    v_exp_f32 v34, v34
    v_mov_b32 v200, s85
    v_exp_f32 v35, v35
    ds_write_b32 v183, v200
    v_cvt_pk_bf16_f32 v64, v32, v33
    v_cvt_pk_bf16_f32 v65, v34, v35
    v_mfma_f32_32x32x16_bf16 v[48:63], v[148:151], v[28:31], v[48:63]
    v_exp_f32 v36, v36
    v_exp_f32 v37, v37
    v_exp_f32 v38, v38
    v_exp_f32 v39, v39
    v_cvt_pk_bf16_f32 v66, v36, v37
    v_cvt_pk_bf16_f32 v67, v38, v39
    v_mfma_f32_32x32x16_bf16 v[96:111], v[140:143], v[76:79], v[96:111]
    v_exp_f32 v40, v40
    v_exp_f32 v41, v41
    v_exp_f32 v42, v42
    v_exp_f32 v43, v43
    v_cvt_pk_bf16_f32 v68, v40, v41
    v_cvt_pk_bf16_f32 v69, v42, v43
    v_mfma_f32_32x32x16_bf16 v[80:95], v[152:155], v[64:67], v[80:95]
    v_exp_f32 v44, v44
    v_exp_f32 v45, v45
    ds_read_b32 v182, v181
    v_exp_f32 v46, v46
    v_exp_f32 v47, v47
    v_cvt_pk_bf16_f32 v70, v44, v45
    v_cvt_pk_bf16_f32 v71, v46, v47
    v_mfma_f32_32x32x16_bf16 v[32:47], v[160:163], v[16:19], 0
    v_exp_f32 v48, v48
    v_exp_f32 v49, v49
    v_exp_f32 v50, v50
    v_exp_f32 v51, v51
    v_cvt_pk_bf16_f32 v72, v48, v49
    v_cvt_pk_bf16_f32 v73, v50, v51
    v_mfma_f32_32x32x16_bf16 v[32:47], v[164:167], v[24:27], v[32:47]
    v_exp_f32 v52, v52
    s_waitcnt lgkmcnt(0)
    v_exp_f32 v53, v53
    v_cmp_gt_u32 vcc, s85, v182
    v_exp_f32 v54, v54
    v_exp_f32 v55, v55
    v_cvt_pk_bf16_f32 v74, v52, v53
    v_cvt_pk_bf16_f32 v75, v54, v55
    v_mfma_f32_32x32x16_bf16 v[80:95], v[156:159], v[68:71], v[80:95]
    v_exp_f32 v56, v56
    s_cbranch_vccnz LM_aspin_42
    LM_aback_43:
    v_exp_f32 v57, v57
    ds_read_b128 v[112:115], v178 offset:4864
    v_exp_f32 v58, v58
    ds_read_b32 v116, v179 offset:4864
    v_exp_f32 v59, v59
    ds_read_b128 v[128:131], v178 offset:7296
    v_cvt_pk_bf16_f32 v76, v56, v57
    v_cvt_pk_bf16_f32 v77, v58, v59
    v_mfma_f32_32x32x16_bf16 v[96:111], v[152:155], v[72:75], v[96:111]
    v_exp_f32 v60, v60
    ds_read_b32 v132, v179 offset:7296
    v_exp_f32 v61, v61
    ds_read_b128 v[120:123], v180 offset:4864
    v_exp_f32 v62, v62
    ds_read_b128 v[124:127], v180 offset:5504
    v_exp_f32 v63, v63
    ds_read_b128 v[136:139], v180 offset:7296
    v_cvt_pk_bf16_f32 v78, v60, v61
    v_cvt_pk_bf16_f32 v79, v62, v63
    v_mfma_f32_32x32x16_bf16 v[48:63], v[160:163], v[20:23], 0
    v_exp_f32 v32, v32
    ds_read_b128 v[140:143], v180 offset:7936
    v_exp_f32 v33, v33
    s_add_u32 m0, s87, 0
    v_exp_f32 v34, v34
    buffer_load_dwordx4 v184, s[68:71], s86 offen sc1 lds
    v_exp_f32 v35, v35
    v_cvt_pk_bf16_f32 v64, v32, v33
    v_cvt_pk_bf16_f32 v65, v34, v35
    v_mfma_f32_32x32x16_bf16 v[48:63], v[164:167], v[28:31], v[48:63]
    v_exp_f32 v36, v36
    v_exp_f32 v37, v37
    s_mov_b64 exec, 0xfff
    buffer_load_dwordx4 v184, s[68:71], s86 offen offset:1024 sc1 lds
    s_mov_b64 exec, -1
    v_exp_f32 v38, v38
    v_exp_f32 v39, v39
    s_add_u32 s86, s86, 4864
    v_cvt_pk_bf16_f32 v66, v36, v37
    v_cvt_pk_bf16_f32 v67, v38, v39
    v_mfma_f32_32x32x16_bf16 v[96:111], v[156:159], v[76:79], v[96:111]
    v_exp_f32 v40, v40
    v_exp_f32 v41, v41
    v_exp_f32 v42, v42
    v_exp_f32 v43, v43
    v_cvt_pk_bf16_f32 v68, v40, v41
    v_cvt_pk_bf16_f32 v69, v42, v43
    v_mfma_f32_32x32x16_bf16 v[80:95], v[168:171], v[64:67], v[80:95]
    v_exp_f32 v44, v44
    v_exp_f32 v45, v45
    v_exp_f32 v46, v46
    v_exp_f32 v47, v47
    v_cvt_pk_bf16_f32 v70, v44, v45
    v_cvt_pk_bf16_f32 v71, v46, v47
    s_waitcnt lgkmcnt(0)
    v_mfma_f32_32x32x16_bf16 v[32:47], v[112:115], v[16:19], 0
    v_exp_f32 v48, v48
    v_exp_f32 v49, v49
    v_exp_f32 v50, v50
    v_exp_f32 v51, v51
    v_cvt_pk_bf16_f32 v72, v48, v49
    v_cvt_pk_bf16_f32 v73, v50, v51
    v_mfma_f32_32x32x16_bf16 v[32:47], v[116:119], v[24:27], v[32:47]
    v_exp_f32 v52, v52
    v_exp_f32 v53, v53
    v_exp_f32 v54, v54
    v_exp_f32 v55, v55
    v_cvt_pk_bf16_f32 v74, v52, v53
    v_cvt_pk_bf16_f32 v75, v54, v55
    v_mfma_f32_32x32x16_bf16 v[80:95], v[172:175], v[68:71], v[80:95]
    v_exp_f32 v56, v56
    v_exp_f32 v57, v57
    s_add_u32 s85, s85, 1
    v_exp_f32 v58, v58
    v_exp_f32 v59, v59
    v_cvt_pk_bf16_f32 v76, v56, v57
    v_cvt_pk_bf16_f32 v77, v58, v59
    v_mfma_f32_32x32x16_bf16 v[96:111], v[168:171], v[72:75], v[96:111]
    v_exp_f32 v60, v60
    v_exp_f32 v61, v61
    v_exp_f32 v62, v62
    v_exp_f32 v63, v63
    v_cvt_pk_bf16_f32 v78, v60, v61
    v_cvt_pk_bf16_f32 v79, v62, v63
    v_mfma_f32_32x32x16_bf16 v[48:63], v[112:115], v[20:23], 0
    v_exp_f32 v32, v32
    v_exp_f32 v33, v33
    s_waitcnt vmcnt(2)
    v_exp_f32 v34, v34
    v_mov_b32 v200, s85
    v_exp_f32 v35, v35
    ds_write_b32 v183, v200
    v_cvt_pk_bf16_f32 v64, v32, v33
    v_cvt_pk_bf16_f32 v65, v34, v35
    v_mfma_f32_32x32x16_bf16 v[48:63], v[116:119], v[28:31], v[48:63]
    v_exp_f32 v36, v36
    v_exp_f32 v37, v37
    v_exp_f32 v38, v38
    v_exp_f32 v39, v39
    v_cvt_pk_bf16_f32 v66, v36, v37
    v_cvt_pk_bf16_f32 v67, v38, v39
    v_mfma_f32_32x32x16_bf16 v[96:111], v[172:175], v[76:79], v[96:111]
    v_exp_f32 v40, v40
    v_exp_f32 v41, v41
    v_exp_f32 v42, v42
    v_exp_f32 v43, v43
    v_cvt_pk_bf16_f32 v68, v40, v41
    v_cvt_pk_bf16_f32 v69, v42, v43
    v_mfma_f32_32x32x16_bf16 v[80:95], v[120:123], v[64:67], v[80:95]
    v_exp_f32 v44, v44
    v_exp_f32 v45, v45
    ds_read_b32 v182, v181
    v_exp_f32 v46, v46
    v_exp_f32 v47, v47
    v_cvt_pk_bf16_f32 v70, v44, v45
    v_cvt_pk_bf16_f32 v71, v46, v47
    v_mfma_f32_32x32x16_bf16 v[32:47], v[128:131], v[16:19], 0
    v_exp_f32 v48, v48
    v_exp_f32 v49, v49
    v_exp_f32 v50, v50
    v_exp_f32 v51, v51
    v_cvt_pk_bf16_f32 v72, v48, v49
    v_cvt_pk_bf16_f32 v73, v50, v51
    v_mfma_f32_32x32x16_bf16 v[32:47], v[132:135], v[24:27], v[32:47]
    v_exp_f32 v52, v52
    s_waitcnt lgkmcnt(0)
    v_exp_f32 v53, v53
    v_cmp_gt_u32 vcc, s85, v182
    v_exp_f32 v54, v54
    v_exp_f32 v55, v55
    v_cvt_pk_bf16_f32 v74, v52, v53
    v_cvt_pk_bf16_f32 v75, v54, v55
    v_mfma_f32_32x32x16_bf16 v[80:95], v[124:127], v[68:71], v[80:95]
    v_exp_f32 v56, v56
    s_cbranch_vccnz LM_aspin_44
    LM_aback_45:
    v_exp_f32 v57, v57
    ds_read_b128 v[144:147], v178 offset:9728
    v_exp_f32 v58, v58
    ds_read_b32 v148, v179 offset:9728
    v_exp_f32 v59, v59
    ds_read_b128 v[160:163], v178 offset:12160
    v_cvt_pk_bf16_f32 v76, v56, v57
    v_cmp_lt_f32 s[92:93], s88, v106
    v_cvt_pk_bf16_f32 v77, v58, v59
    v_mfma_f32_32x32x16_bf16 v[96:111], v[120:123], v[72:75], v[96:111]
    v_exp_f32 v60, v60
    ds_read_b32 v164, v179 offset:12160
    v_exp_f32 v61, v61
    ds_read_b128 v[152:155], v180 offset:9728
    v_exp_f32 v62, v62
    ds_read_b128 v[156:159], v180 offset:10368
    v_exp_f32 v63, v63
    ds_read_b128 v[168:171], v180 offset:12160
    v_cvt_pk_bf16_f32 v78, v60, v61
    v_cvt_pk_bf16_f32 v79, v62, v63
    s_cmp_lg_u64 s[92:93], 0
    s_cbranch_scc1 LM_rare1_46
    LM_rback1_47:
    v_mfma_f32_32x32x16_bf16 v[48:63], v[128:131], v[20:23], 0
    v_exp_f32 v32, v32
    ds_read_b128 v[172:175], v180 offset:12800
    v_exp_f32 v33, v33
    s_add_u32 m0, s87, 4864
    v_exp_f32 v34, v34
    buffer_load_dwordx4 v184, s[68:71], s86 offen sc1 lds
    v_exp_f32 v35, v35
    v_cvt_pk_bf16_f32 v64, v32, v33
    v_cvt_pk_bf16_f32 v65, v34, v35
    v_mfma_f32_32x32x16_bf16 v[48:63], v[132:135], v[28:31], v[48:63]
    v_exp_f32 v36, v36
    v_exp_f32 v37, v37
    s_mov_b64 exec, 0xfff
    buffer_load_dwordx4 v184, s[68:71], s86 offen offset:1024 sc1 lds
    s_mov_b64 exec, -1
    v_exp_f32 v38, v38
    v_exp_f32 v39, v39
    s_add_u32 s86, s86, 4864
    v_cvt_pk_bf16_f32 v66, v36, v37
    v_cvt_pk_bf16_f32 v67, v38, v39
    v_mfma_f32_32x32x16_bf16 v[96:111], v[124:127], v[76:79], v[96:111]
    v_exp_f32 v40, v40
    v_exp_f32 v41, v41
    v_exp_f32 v42, v42
    v_exp_f32 v43, v43
    v_cvt_pk_bf16_f32 v68, v40, v41
    v_cmp_lt_f32 s[90:91], s88, v90
    v_cvt_pk_bf16_f32 v69, v42, v43
    v_mfma_f32_32x32x16_bf16 v[80:95], v[136:139], v[64:67], v[80:95]
    v_exp_f32 v44, v44
    v_exp_f32 v45, v45
    v_exp_f32 v46, v46
    v_exp_f32 v47, v47
    v_cvt_pk_bf16_f32 v70, v44, v45
    v_cvt_pk_bf16_f32 v71, v46, v47
    s_waitcnt lgkmcnt(0)
    s_cmp_lg_u64 s[90:91], 0
    s_cbranch_scc1 LM_rare0_48
    LM_rback0_49:
    v_mfma_f32_32x32x16_bf16 v[32:47], v[144:147], v[16:19], 0
    v_exp_f32 v48, v48
    v_exp_f32 v49, v49
    v_exp_f32 v50, v50
    v_exp_f32 v51, v51
    v_cvt_pk_bf16_f32 v72, v48, v49
    v_cvt_pk_bf16_f32 v73, v50, v51
    v_mfma_f32_32x32x16_bf16 v[32:47], v[148:151], v[24:27], v[32:47]
    v_exp_f32 v52, v52
    v_exp_f32 v53, v53
    v_exp_f32 v54, v54
    v_exp_f32 v55, v55
    v_cvt_pk_bf16_f32 v74, v52, v53
    v_cvt_pk_bf16_f32 v75, v54, v55
    v_mfma_f32_32x32x16_bf16 v[80:95], v[140:143], v[68:71], v[80:95]
    v_exp_f32 v56, v56
    v_exp_f32 v57, v57
    s_add_u32 s85, s85, 1
    v_exp_f32 v58, v58
    v_exp_f32 v59, v59
    v_cvt_pk_bf16_f32 v76, v56, v57
    v_cvt_pk_bf16_f32 v77, v58, v59
    v_mfma_f32_32x32x16_bf16 v[96:111], v[136:139], v[72:75], v[96:111]
    v_exp_f32 v60, v60
    v_exp_f32 v61, v61
    v_exp_f32 v62, v62
    v_exp_f32 v63, v63
    v_cvt_pk_bf16_f32 v78, v60, v61
    v_cvt_pk_bf16_f32 v79, v62, v63
    v_mfma_f32_32x32x16_bf16 v[48:63], v[144:147], v[20:23], 0
    v_exp_f32 v32, v32
    v_exp_f32 v33, v33
    s_waitcnt vmcnt(2)
    v_exp_f32 v34, v34
    v_mov_b32 v200, s85
    v_exp_f32 v35, v35
    ds_write_b32 v183, v200
    v_cvt_pk_bf16_f32 v64, v32, v33
    v_cvt_pk_bf16_f32 v65, v34, v35
    v_mfma_f32_32x32x16_bf16 v[48:63], v[148:151], v[28:31], v[48:63]
    v_exp_f32 v36, v36
    v_exp_f32 v37, v37
    v_exp_f32 v38, v38
    v_exp_f32 v39, v39
    v_cvt_pk_bf16_f32 v66, v36, v37
    v_cvt_pk_bf16_f32 v67, v38, v39
    v_mfma_f32_32x32x16_bf16 v[96:111], v[140:143], v[76:79], v[96:111]
    v_exp_f32 v40, v40
    v_exp_f32 v41, v41
    v_exp_f32 v42, v42
    v_exp_f32 v43, v43
    v_cvt_pk_bf16_f32 v68, v40, v41
    v_cvt_pk_bf16_f32 v69, v42, v43
    v_mfma_f32_32x32x16_bf16 v[80:95], v[152:155], v[64:67], v[80:95]
    v_exp_f32 v44, v44
    v_exp_f32 v45, v45
    ds_read_b32 v182, v181
    v_exp_f32 v46, v46
    v_exp_f32 v47, v47
    v_cvt_pk_bf16_f32 v70, v44, v45
    v_cvt_pk_bf16_f32 v71, v46, v47
    v_mfma_f32_32x32x16_bf16 v[32:47], v[160:163], v[16:19], 0
    v_exp_f32 v48, v48
    v_exp_f32 v49, v49
    v_exp_f32 v50, v50
    v_exp_f32 v51, v51
    v_cvt_pk_bf16_f32 v72, v48, v49
    v_cvt_pk_bf16_f32 v73, v50, v51
    v_mfma_f32_32x32x16_bf16 v[32:47], v[164:167], v[24:27], v[32:47]
    v_exp_f32 v52, v52
    s_waitcnt lgkmcnt(0)
    v_exp_f32 v53, v53
    v_cmp_gt_u32 vcc, s85, v182
    v_exp_f32 v54, v54
    v_exp_f32 v55, v55
    v_cvt_pk_bf16_f32 v74, v52, v53
    v_cvt_pk_bf16_f32 v75, v54, v55
    v_mfma_f32_32x32x16_bf16 v[80:95], v[156:159], v[68:71], v[80:95]
    v_exp_f32 v56, v56
    s_cbranch_vccnz LM_aspin_50
    LM_aback_51:
    v_exp_f32 v57, v57
    ds_read_b128 v[112:115], v178 offset:0
    v_exp_f32 v58, v58
    ds_read_b32 v116, v179 offset:0
    v_exp_f32 v59, v59
    ds_read_b128 v[128:131], v178 offset:2432
    v_cvt_pk_bf16_f32 v76, v56, v57
    v_cvt_pk_bf16_f32 v77, v58, v59
    v_mfma_f32_32x32x16_bf16 v[96:111], v[152:155], v[72:75], v[96:111]
    v_exp_f32 v60, v60
    ds_read_b32 v132, v179 offset:2432
    v_exp_f32 v61, v61
    ds_read_b128 v[120:123], v180 offset:0
    v_exp_f32 v62, v62
    ds_read_b128 v[124:127], v180 offset:640
    v_exp_f32 v63, v63
    ds_read_b128 v[136:139], v180 offset:2432
    v_cvt_pk_bf16_f32 v78, v60, v61
    v_cvt_pk_bf16_f32 v79, v62, v63
    v_mfma_f32_32x32x16_bf16 v[48:63], v[160:163], v[20:23], 0
    v_exp_f32 v32, v32
    ds_read_b128 v[140:143], v180 offset:3072
    v_exp_f32 v33, v33
    s_add_u32 m0, s87, 9728
    v_exp_f32 v34, v34
    buffer_load_dwordx4 v184, s[68:71], s86 offen sc1 lds
    v_exp_f32 v35, v35
    v_cvt_pk_bf16_f32 v64, v32, v33
    v_cvt_pk_bf16_f32 v65, v34, v35
    v_mfma_f32_32x32x16_bf16 v[48:63], v[164:167], v[28:31], v[48:63]
    v_exp_f32 v36, v36
    v_exp_f32 v37, v37
    s_mov_b64 exec, 0xfff
    buffer_load_dwordx4 v184, s[68:71], s86 offen offset:1024 sc1 lds
    s_mov_b64 exec, -1
    v_exp_f32 v38, v38
    v_exp_f32 v39, v39
    s_add_u32 s86, s86, 4864
    v_cvt_pk_bf16_f32 v66, v36, v37
    v_cvt_pk_bf16_f32 v67, v38, v39
    v_mfma_f32_32x32x16_bf16 v[96:111], v[156:159], v[76:79], v[96:111]
    v_exp_f32 v40, v40
    v_exp_f32 v41, v41
    v_exp_f32 v42, v42
    v_exp_f32 v43, v43
    v_cvt_pk_bf16_f32 v68, v40, v41
    v_cvt_pk_bf16_f32 v69, v42, v43
    v_mfma_f32_32x32x16_bf16 v[80:95], v[168:171], v[64:67], v[80:95]
    v_exp_f32 v44, v44
    v_exp_f32 v45, v45
    v_exp_f32 v46, v46
    v_exp_f32 v47, v47
    v_cvt_pk_bf16_f32 v70, v44, v45
    v_cvt_pk_bf16_f32 v71, v46, v47
    s_waitcnt lgkmcnt(0)
    v_mfma_f32_32x32x16_bf16 v[32:47], v[112:115], v[16:19], 0
    v_exp_f32 v48, v48
    v_exp_f32 v49, v49
    v_exp_f32 v50, v50
    v_exp_f32 v51, v51
    v_cvt_pk_bf16_f32 v72, v48, v49
    v_cvt_pk_bf16_f32 v73, v50, v51
    v_mfma_f32_32x32x16_bf16 v[32:47], v[116:119], v[24:27], v[32:47]
    v_exp_f32 v52, v52
    v_exp_f32 v53, v53
    v_exp_f32 v54, v54
    v_exp_f32 v55, v55
    v_cvt_pk_bf16_f32 v74, v52, v53
    v_cvt_pk_bf16_f32 v75, v54, v55
    v_mfma_f32_32x32x16_bf16 v[80:95], v[172:175], v[68:71], v[80:95]
    v_exp_f32 v56, v56
    v_exp_f32 v57, v57
    s_add_u32 s85, s85, 1
    v_exp_f32 v58, v58
    v_exp_f32 v59, v59
    v_cvt_pk_bf16_f32 v76, v56, v57
    v_cvt_pk_bf16_f32 v77, v58, v59
    v_mfma_f32_32x32x16_bf16 v[96:111], v[168:171], v[72:75], v[96:111]
    v_exp_f32 v60, v60
    v_exp_f32 v61, v61
    v_exp_f32 v62, v62
    v_exp_f32 v63, v63
    v_cvt_pk_bf16_f32 v78, v60, v61
    v_cvt_pk_bf16_f32 v79, v62, v63
    s_branch LM_aloop_26
LM_aspin_28:
    ds_read_b32 v182, v181
    s_waitcnt lgkmcnt(0)
    v_cmp_gt_u32 vcc, s85, v182
    s_nop 4
    s_add_u32 s94, s94, 1
    s_cbranch_vccz LM_aback_29
    s_sleep 1
    s_branch LM_aspin_28
LM_rare1_30:
    v_mfma_f32_32x32x16_bf16 v[96:111], v[124:127], v[76:79], v[96:111]
    s_nop 15
    s_nop 3
    v_frexp_exp_i32_f32 v189, v106
    v_add_u32 v189, 72, v189
    v_max_i32 v189, 0, v189
    v_cvt_f32_i32 v190, v189
    v_sub_u32 v189, 0, v189
    v_add_f32 v177, v177, v190
    v_ldexp_f32 v96, v96, v189
    v_ldexp_f32 v97, v97, v189
    v_ldexp_f32 v98, v98, v189
    v_ldexp_f32 v99, v99, v189
    v_ldexp_f32 v100, v100, v189
    v_ldexp_f32 v101, v101, v189
    v_ldexp_f32 v102, v102, v189
    v_ldexp_f32 v103, v103, v189
    v_ldexp_f32 v104, v104, v189
    v_ldexp_f32 v105, v105, v189
    v_ldexp_f32 v106, v106, v189
    v_mov_b32 v76, 0
    v_mov_b32 v77, 0
    v_mov_b32 v78, 0
    v_mov_b32 v79, 0
    v_sub_f32 v186, 0, v177
    v_and_b32 v187, 0xffff0000, v186
    v_sub_f32 v186, v186, v187
    v_and_b32 v188, 0xffff0000, v186
    v_sub_f32 v186, v186, v188
    v_lshrrev_b32 v187, 16, v187
    v_or_b32 v187, v187, v188
    v_lshrrev_b32 v186, 16, v186
    v_cndmask_b32 v29, 0, v187, s[80:81]
    v_cndmask_b32 v30, 0, v186, s[80:81]
    s_nop 1
    s_branch LM_rback1_31
LM_rare0_32:
    v_mfma_f32_32x32x16_bf16 v[80:95], v[140:143], v[68:71], v[80:95]
    s_nop 15
    s_nop 3
    v_frexp_exp_i32_f32 v189, v90
    v_add_u32 v189, 72, v189
    v_max_i32 v189, 0, v189
    v_cvt_f32_i32 v190, v189
    v_sub_u32 v189, 0, v189
    v_add_f32 v176, v176, v190
    v_ldexp_f32 v80, v80, v189
    v_ldexp_f32 v81, v81, v189
    v_ldexp_f32 v82, v82, v189
    v_ldexp_f32 v83, v83, v189
    v_ldexp_f32 v84, v84, v189
    v_ldexp_f32 v85, v85, v189
    v_ldexp_f32 v86, v86, v189
    v_ldexp_f32 v87, v87, v189
    v_ldexp_f32 v88, v88, v189
    v_ldexp_f32 v89, v89, v189
    v_ldexp_f32 v90, v90, v189
    v_mov_b32 v68, 0
    v_mov_b32 v69, 0
    v_mov_b32 v70, 0
    v_mov_b32 v71, 0
    v_sub_f32 v186, 0, v176
    v_and_b32 v187, 0xffff0000, v186
    v_sub_f32 v186, v186, v187
    v_and_b32 v188, 0xffff0000, v186
    v_sub_f32 v186, v186, v188
    v_lshrrev_b32 v187, 16, v187
    v_or_b32 v187, v187, v188
    v_lshrrev_b32 v186, 16, v186
    v_cndmask_b32 v25, 0, v187, s[80:81]
    v_cndmask_b32 v26, 0, v186, s[80:81]
    s_nop 1
    s_branch LM_rback0_33
LM_aspin_34:
    ds_read_b32 v182, v181
    s_waitcnt lgkmcnt(0)
    v_cmp_gt_u32 vcc, s85, v182
    s_nop 4
    s_add_u32 s94, s94, 1
    s_cbranch_vccz LM_aback_35
    s_sleep 1
    s_branch LM_aspin_34
LM_aspin_36:
    ds_read_b32 v182, v181
    s_waitcnt lgkmcnt(0)
    v_cmp_gt_u32 vcc, s85, v182
    s_nop 4
    s_add_u32 s94, s94, 1
    s_cbranch_vccz LM_aback_37
    s_sleep 1
    s_branch LM_aspin_36
LM_rare1_38:
    v_mfma_f32_32x32x16_bf16 v[96:111], v[124:127], v[76:79], v[96:111]
    s_nop 15
    s_nop 3
    v_frexp_exp_i32_f32 v189, v106
    v_add_u32 v189, 72, v189
    v_max_i32 v189, 0, v189
    v_cvt_f32_i32 v190, v189
    v_sub_u32 v189, 0, v189
    v_add_f32 v177, v177, v190
    v_ldexp_f32 v96, v96, v189
    v_ldexp_f32 v97, v97, v189
    v_ldexp_f32 v98, v98, v189
    v_ldexp_f32 v99, v99, v189
    v_ldexp_f32 v100, v100, v189
    v_ldexp_f32 v101, v101, v189
    v_ldexp_f32 v102, v102, v189
    v_ldexp_f32 v103, v103, v189
    v_ldexp_f32 v104, v104, v189
    v_ldexp_f32 v105, v105, v189
    v_ldexp_f32 v106, v106, v189
    v_mov_b32 v76, 0
    v_mov_b32 v77, 0
    v_mov_b32 v78, 0
    v_mov_b32 v79, 0
    v_sub_f32 v186, 0, v177
    v_and_b32 v187, 0xffff0000, v186
    v_sub_f32 v186, v186, v187
    v_and_b32 v188, 0xffff0000, v186
    v_sub_f32 v186, v186, v188
    v_lshrrev_b32 v187, 16, v187
    v_or_b32 v187, v187, v188
    v_lshrrev_b32 v186, 16, v186
    v_cndmask_b32 v29, 0, v187, s[80:81]
    v_cndmask_b32 v30, 0, v186, s[80:81]
    s_nop 1
    s_branch LM_rback1_39
LM_rare0_40:
    v_mfma_f32_32x32x16_bf16 v[80:95], v[140:143], v[68:71], v[80:95]
    s_nop 15
    s_nop 3
    v_frexp_exp_i32_f32 v189, v90
    v_add_u32 v189, 72, v189
    v_max_i32 v189, 0, v189
    v_cvt_f32_i32 v190, v189
    v_sub_u32 v189, 0, v189
    v_add_f32 v176, v176, v190
    v_ldexp_f32 v80, v80, v189
    v_ldexp_f32 v81, v81, v189
    v_ldexp_f32 v82, v82, v189
    v_ldexp_f32 v83, v83, v189
    v_ldexp_f32 v84, v84, v189
    v_ldexp_f32 v85, v85, v189
    v_ldexp_f32 v86, v86, v189
    v_ldexp_f32 v87, v87, v189
    v_ldexp_f32 v88, v88, v189
    v_ldexp_f32 v89, v89, v189
    v_ldexp_f32 v90, v90, v189
    v_mov_b32 v68, 0
    v_mov_b32 v69, 0
    v_mov_b32 v70, 0
    v_mov_b32 v71, 0
    v_sub_f32 v186, 0, v176
    v_and_b32 v187, 0xffff0000, v186
    v_sub_f32 v186, v186, v187
    v_and_b32 v188, 0xffff0000, v186
    v_sub_f32 v186, v186, v188
    v_lshrrev_b32 v187, 16, v187
    v_or_b32 v187, v187, v188
    v_lshrrev_b32 v186, 16, v186
    v_cndmask_b32 v25, 0, v187, s[80:81]
    v_cndmask_b32 v26, 0, v186, s[80:81]
    s_nop 1
    s_branch LM_rback0_41
LM_aspin_42:
    ds_read_b32 v182, v181
    s_waitcnt lgkmcnt(0)
    v_cmp_gt_u32 vcc, s85, v182
    s_nop 4
    s_add_u32 s94, s94, 1
    s_cbranch_vccz LM_aback_43
    s_sleep 1
    s_branch LM_aspin_42
LM_aspin_44:
    ds_read_b32 v182, v181
    s_waitcnt lgkmcnt(0)
    v_cmp_gt_u32 vcc, s85, v182
    s_nop 4
    s_add_u32 s94, s94, 1
    s_cbranch_vccz LM_aback_45
    s_sleep 1
    s_branch LM_aspin_44
LM_rare1_46:
    v_mfma_f32_32x32x16_bf16 v[96:111], v[124:127], v[76:79], v[96:111]
    s_nop 15
    s_nop 3
    v_frexp_exp_i32_f32 v189, v106
    v_add_u32 v189, 72, v189
    v_max_i32 v189, 0, v189
    v_cvt_f32_i32 v190, v189
    v_sub_u32 v189, 0, v189
    v_add_f32 v177, v177, v190
    v_ldexp_f32 v96, v96, v189
    v_ldexp_f32 v97, v97, v189
    v_ldexp_f32 v98, v98, v189
    v_ldexp_f32 v99, v99, v189
    v_ldexp_f32 v100, v100, v189
    v_ldexp_f32 v101, v101, v189
    v_ldexp_f32 v102, v102, v189
    v_ldexp_f32 v103, v103, v189
    v_ldexp_f32 v104, v104, v189
    v_ldexp_f32 v105, v105, v189
    v_ldexp_f32 v106, v106, v189
    v_mov_b32 v76, 0
    v_mov_b32 v77, 0
    v_mov_b32 v78, 0
    v_mov_b32 v79, 0
    v_sub_f32 v186, 0, v177
    v_and_b32 v187, 0xffff0000, v186
    v_sub_f32 v186, v186, v187
    v_and_b32 v188, 0xffff0000, v186
    v_sub_f32 v186, v186, v188
    v_lshrrev_b32 v187, 16, v187
    v_or_b32 v187, v187, v188
    v_lshrrev_b32 v186, 16, v186
    v_cndmask_b32 v29, 0, v187, s[80:81]
    v_cndmask_b32 v30, 0, v186, s[80:81]
    s_nop 1
    s_branch LM_rback1_47
LM_rare0_48:
    v_mfma_f32_32x32x16_bf16 v[80:95], v[140:143], v[68:71], v[80:95]
    s_nop 15
    s_nop 3
    v_frexp_exp_i32_f32 v189, v90
    v_add_u32 v189, 72, v189
    v_max_i32 v189, 0, v189
    v_cvt_f32_i32 v190, v189
    v_sub_u32 v189, 0, v189
    v_add_f32 v176, v176, v190
    v_ldexp_f32 v80, v80, v189
    v_ldexp_f32 v81, v81, v189
    v_ldexp_f32 v82, v82, v189
    v_ldexp_f32 v83, v83, v189
    v_ldexp_f32 v84, v84, v189
    v_ldexp_f32 v85, v85, v189
    v_ldexp_f32 v86, v86, v189
    v_ldexp_f32 v87, v87, v189
    v_ldexp_f32 v88, v88, v189
    v_ldexp_f32 v89, v89, v189
    v_ldexp_f32 v90, v90, v189
    v_mov_b32 v68, 0
    v_mov_b32 v69, 0
    v_mov_b32 v70, 0
    v_mov_b32 v71, 0
    v_sub_f32 v186, 0, v176
    v_and_b32 v187, 0xffff0000, v186
    v_sub_f32 v186, v186, v187
    v_and_b32 v188, 0xffff0000, v186
    v_sub_f32 v186, v186, v188
    v_lshrrev_b32 v187, 16, v187
    v_or_b32 v187, v187, v188
    v_lshrrev_b32 v186, 16, v186
    v_cndmask_b32 v25, 0, v187, s[80:81]
    v_cndmask_b32 v26, 0, v186, s[80:81]
    s_nop 1
    s_branch LM_rback0_49
LM_aspin_50:
    ds_read_b32 v182, v181
    s_waitcnt lgkmcnt(0)
    v_cmp_gt_u32 vcc, s85, v182
    s_nop 4
    s_add_u32 s94, s94, 1
    s_cbranch_vccz LM_aback_51
    s_sleep 1
    s_branch LM_aspin_50
LM_aexit_27:
    s_nop 1
    v_mfma_f32_32x32x16_bf16 v[96:111], v[172:175], v[76:79], v[96:111]
    s_setprio 0
    s_waitcnt vmcnt(0) lgkmcnt(0)
    v_mov_b32 v200, 100
    ds_write_b32 v183, v200
    s_nop 7
    s_nop 7
    s_movk_i32 s9, 0x207
    s_mov_b64 s[90:91], 0
    v_mul_f32 v186, 0, v80
    v_mul_f32 v187, 0, v81
    v_fma_f32 v186, v82, 0, v186
    v_fma_f32 v187, v83, 0, v187
    v_fma_f32 v186, v84, 0, v186
    v_fma_f32 v187, v85, 0, v187
    v_fma_f32 v186, v86, 0, v186
    v_fma_f32 v187, v87, 0, v187
    v_fma_f32 v186, v88, 0, v186
    v_fma_f32 v187, v89, 0, v187
    v_fma_f32 v186, v90, 0, v186
    v_cmp_u_f32 s[90:91], v186, v187
    s_nop 1
    s_cmp_eq_u64 s[90:91], 0
    s_cbranch_scc1 LM_fin_ok_52
    v_subrev_u32 v192, 147456, v178
    v_subrev_u32 v193, 147456, v179
    v_subrev_u32 v194, 147456, v180
    v_mov_b32 v80, 0
    v_mov_b32 v81, 0
    v_mov_b32 v82, 0
    v_mov_b32 v83, 0
    v_mov_b32 v84, 0
    v_mov_b32 v85, 0
    v_mov_b32 v86, 0
    v_mov_b32 v87, 0
    v_mov_b32 v88, 0
    v_mov_b32 v89, 0
    v_mov_b32 v90, 0
    v_mov_b32 v91, 0
    v_mov_b32 v92, 0
    v_mov_b32 v93, 0
    v_mov_b32 v94, 0
    v_mov_b32 v95, 0
    v_mov_b32 v176, 3405774848
    s_mov_b32 s10, 0
    s_mov_b32 s11, 0
LM_slow_53:
    buffer_load_dwordx4 v[112:115], v192, s[68:71], s10 offen sc1
    buffer_load_dword v116, v193, s[68:71], s10 offen sc1
    buffer_load_dwordx4 v[120:123], v194, s[68:71], s10 offen sc1
    buffer_load_dwordx4 v[124:127], v194, s[68:71], s10 offen offset:640 sc1
    v_mov_b32 v25, 0
    v_mov_b32 v26, 0
    s_waitcnt vmcnt(0)
    s_nop 1
    v_mfma_f32_32x32x16_bf16 v[32:47], v[112:115], v[16:19], 0
    v_mfma_f32_32x32x16_bf16 v[32:47], v[116:119], v[24:27], v[32:47]
    s_nop 15
    s_nop 3
    v_max3_f32 v186, v32, v33, v34
    v_max3_f32 v186, v186, v35, v36
    v_max3_f32 v186, v186, v37, v38
    v_max3_f32 v186, v186, v39, v40
    v_max3_f32 v186, v186, v41, v42
    v_max3_f32 v186, v186, v43, v44
    v_max3_f32 v186, v186, v45, v46
    v_max_f32 v186, v186, v47
    v_mov_b32 v187, v186
    s_nop 1
    v_permlane32_swap_b32 v186, v187
    s_nop 1
    v_max_f32 v186, v186, v187
    v_ceil_f32 v186, v186
    v_max_f32 v186, v186, v176
    v_sub_f32 v187, v176, v186
    v_max_f32 v187, 3296329728, v187
    v_cvt_i32_f32 v187, v187
    v_mov_b32 v176, v186
    v_ldexp_f32 v80, v80, v187
    v_ldexp_f32 v81, v81, v187
    v_ldexp_f32 v82, v82, v187
    v_ldexp_f32 v83, v83, v187
    v_ldexp_f32 v84, v84, v187
    v_ldexp_f32 v85, v85, v187
    v_ldexp_f32 v86, v86, v187
    v_ldexp_f32 v87, v87, v187
    v_ldexp_f32 v88, v88, v187
    v_ldexp_f32 v89, v89, v187
    v_ldexp_f32 v90, v90, v187
    v_ldexp_f32 v91, v91, v187
    v_ldexp_f32 v92, v92, v187
    v_ldexp_f32 v93, v93, v187
    v_ldexp_f32 v94, v94, v187
    v_ldexp_f32 v95, v95, v187
    v_sub_f32 v32, v32, v176
    v_exp_f32 v32, v32
    v_sub_f32 v33, v33, v176
    v_exp_f32 v33, v33
    v_sub_f32 v34, v34, v176
    v_exp_f32 v34, v34
    v_sub_f32 v35, v35, v176
    v_exp_f32 v35, v35
    v_sub_f32 v36, v36, v176
    v_exp_f32 v36, v36
    v_sub_f32 v37, v37, v176
    v_exp_f32 v37, v37
    v_sub_f32 v38, v38, v176
    v_exp_f32 v38, v38
    v_sub_f32 v39, v39, v176
    v_exp_f32 v39, v39
    v_sub_f32 v40, v40, v176
    v_exp_f32 v40, v40
    v_sub_f32 v41, v41, v176
    v_exp_f32 v41, v41
    v_sub_f32 v42, v42, v176
    v_exp_f32 v42, v42
    v_sub_f32 v43, v43, v176
    v_exp_f32 v43, v43
    v_sub_f32 v44, v44, v176
    v_exp_f32 v44, v44
    v_sub_f32 v45, v45, v176
    v_exp_f32 v45, v45
    v_sub_f32 v46, v46, v176
    v_exp_f32 v46, v46
    v_sub_f32 v47, v47, v176
    v_exp_f32 v47, v47
    s_nop 0
    v_cvt_pk_bf16_f32 v64, v32, v33
    v_cvt_pk_bf16_f32 v65, v34, v35
    v_cvt_pk_bf16_f32 v66, v36, v37
    v_cvt_pk_bf16_f32 v67, v38, v39
    v_cvt_pk_bf16_f32 v68, v40, v41
    v_cvt_pk_bf16_f32 v69, v42, v43
    v_cvt_pk_bf16_f32 v70, v44, v45
    v_cvt_pk_bf16_f32 v71, v46, v47
    s_nop 1
    v_mfma_f32_32x32x16_bf16 v[80:95], v[120:123], v[64:67], v[80:95]
    v_mfma_f32_32x32x16_bf16 v[80:95], v[124:127], v[68:71], v[80:95]
    s_nop 15
    s_nop 3
    s_add_u32 s10, s10, 2432
    s_add_u32 s11, s11, 1
    s_cmp_lt_u32 s11, 64
    s_cbranch_scc1 LM_slow_53
LM_fin_ok_52:
    v_mul_f32 v186, 0, v96
    v_mul_f32 v187, 0, v97
    v_fma_f32 v186, v98, 0, v186
    v_fma_f32 v187, v99, 0, v187
    v_fma_f32 v186, v100, 0, v186
    v_fma_f32 v187, v101, 0, v187
    v_fma_f32 v186, v102, 0, v186
    v_fma_f32 v187, v103, 0, v187
    v_fma_f32 v186, v104, 0, v186
    v_fma_f32 v187, v105, 0, v187
    v_fma_f32 v186, v106, 0, v186
    v_cmp_u_f32 s[90:91], v186, v187
    s_nop 1
    s_cmp_eq_u64 s[90:91], 0
    s_cbranch_scc1 LM_fin_ok_55
    v_subrev_u32 v192, 147456, v178
    v_subrev_u32 v193, 147456, v179
    v_subrev_u32 v194, 147456, v180
    v_mov_b32 v96, 0
    v_mov_b32 v97, 0
    v_mov_b32 v98, 0
    v_mov_b32 v99, 0
    v_mov_b32 v100, 0
    v_mov_b32 v101, 0
    v_mov_b32 v102, 0
    v_mov_b32 v103, 0
    v_mov_b32 v104, 0
    v_mov_b32 v105, 0
    v_mov_b32 v106, 0
    v_mov_b32 v107, 0
    v_mov_b32 v108, 0
    v_mov_b32 v109, 0
    v_mov_b32 v110, 0
    v_mov_b32 v111, 0
    v_mov_b32 v177, 3405774848
    s_mov_b32 s10, 0
    s_mov_b32 s11, 0
LM_slow_56:
    buffer_load_dwordx4 v[112:115], v192, s[68:71], s10 offen sc1
    buffer_load_dword v116, v193, s[68:71], s10 offen sc1
    buffer_load_dwordx4 v[120:123], v194, s[68:71], s10 offen sc1
    buffer_load_dwordx4 v[124:127], v194, s[68:71], s10 offen offset:640 sc1
    v_mov_b32 v29, 0
    v_mov_b32 v30, 0
    s_waitcnt vmcnt(0)
    s_nop 1
    v_mfma_f32_32x32x16_bf16 v[48:63], v[112:115], v[20:23], 0
    v_mfma_f32_32x32x16_bf16 v[48:63], v[116:119], v[28:31], v[48:63]
    s_nop 15
    s_nop 3
    v_max3_f32 v186, v48, v49, v50
    v_max3_f32 v186, v186, v51, v52
    v_max3_f32 v186, v186, v53, v54
    v_max3_f32 v186, v186, v55, v56
    v_max3_f32 v186, v186, v57, v58
    v_max3_f32 v186, v186, v59, v60
    v_max3_f32 v186, v186, v61, v62
    v_max_f32 v186, v186, v63
    v_mov_b32 v187, v186
    s_nop 1
    v_permlane32_swap_b32 v186, v187
    s_nop 1
    v_max_f32 v186, v186, v187
    v_ceil_f32 v186, v186
    v_max_f32 v186, v186, v177
    v_sub_f32 v187, v177, v186
    v_max_f32 v187, 3296329728, v187
    v_cvt_i32_f32 v187, v187
    v_mov_b32 v177, v186
    v_ldexp_f32 v96, v96, v187
    v_ldexp_f32 v97, v97, v187
    v_ldexp_f32 v98, v98, v187
    v_ldexp_f32 v99, v99, v187
    v_ldexp_f32 v100, v100, v187
    v_ldexp_f32 v101, v101, v187
    v_ldexp_f32 v102, v102, v187
    v_ldexp_f32 v103, v103, v187
    v_ldexp_f32 v104, v104, v187
    v_ldexp_f32 v105, v105, v187
    v_ldexp_f32 v106, v106, v187
    v_ldexp_f32 v107, v107, v187
    v_ldexp_f32 v108, v108, v187
    v_ldexp_f32 v109, v109, v187
    v_ldexp_f32 v110, v110, v187
    v_ldexp_f32 v111, v111, v187
    v_sub_f32 v48, v48, v177
    v_exp_f32 v48, v48
    v_sub_f32 v49, v49, v177
    v_exp_f32 v49, v49
    v_sub_f32 v50, v50, v177
    v_exp_f32 v50, v50
    v_sub_f32 v51, v51, v177
    v_exp_f32 v51, v51
    v_sub_f32 v52, v52, v177
    v_exp_f32 v52, v52
    v_sub_f32 v53, v53, v177
    v_exp_f32 v53, v53
    v_sub_f32 v54, v54, v177
    v_exp_f32 v54, v54
    v_sub_f32 v55, v55, v177
    v_exp_f32 v55, v55
    v_sub_f32 v56, v56, v177
    v_exp_f32 v56, v56
    v_sub_f32 v57, v57, v177
    v_exp_f32 v57, v57
    v_sub_f32 v58, v58, v177
    v_exp_f32 v58, v58
    v_sub_f32 v59, v59, v177
    v_exp_f32 v59, v59
    v_sub_f32 v60, v60, v177
    v_exp_f32 v60, v60
    v_sub_f32 v61, v61, v177
    v_exp_f32 v61, v61
    v_sub_f32 v62, v62, v177
    v_exp_f32 v62, v62
    v_sub_f32 v63, v63, v177
    v_exp_f32 v63, v63
    s_nop 0
    v_cvt_pk_bf16_f32 v72, v48, v49
    v_cvt_pk_bf16_f32 v73, v50, v51
    v_cvt_pk_bf16_f32 v74, v52, v53
    v_cvt_pk_bf16_f32 v75, v54, v55
    v_cvt_pk_bf16_f32 v76, v56, v57
    v_cvt_pk_bf16_f32 v77, v58, v59
    v_cvt_pk_bf16_f32 v78, v60, v61
    v_cvt_pk_bf16_f32 v79, v62, v63
    s_nop 1
    v_mfma_f32_32x32x16_bf16 v[96:111], v[120:123], v[72:75], v[96:111]
    v_mfma_f32_32x32x16_bf16 v[96:111], v[124:127], v[76:79], v[96:111]
    s_nop 15
    s_nop 3
    s_add_u32 s10, s10, 2432
    s_add_u32 s11, s11, 1
    s_cmp_lt_u32 s11, 64
    s_cbranch_scc1 LM_slow_56
LM_fin_ok_55:
    v_mov_b32 v6, 0
    v_mov_b32 v7, 0
    v_rcp_f32 v186, v90
    s_nop 0
    v_mul_f32 v80, v80, v186
    v_mul_f32 v81, v81, v186
    v_mul_f32 v82, v82, v186
    v_mul_f32 v83, v83, v186
    v_mul_f32 v84, v84, v186
    v_mul_f32 v85, v85, v186
    v_mul_f32 v86, v86, v186
    v_mul_f32 v87, v87, v186
    v_mul_f32 v88, v88, v186
    v_mul_f32 v89, v89, v186
    v_cvt_pk_bf16_f32 v80, v80, v81
    v_cvt_pk_bf16_f32 v81, v82, v83
    v_cvt_pk_bf16_f32 v82, v84, v85
    v_cvt_pk_bf16_f32 v83, v86, v87
    v_cvt_pk_bf16_f32 v84, v88, v89
    v_rcp_f32 v186, v106
    s_nop 0
    v_mul_f32 v96, v96, v186
    v_mul_f32 v97, v97, v186
    v_mul_f32 v98, v98, v186
    v_mul_f32 v99, v99, v186
    v_mul_f32 v100, v100, v186
    v_mul_f32 v101, v101, v186
    v_mul_f32 v102, v102, v186
    v_mul_f32 v103, v103, v186
    v_mul_f32 v104, v104, v186
    v_mul_f32 v105, v105, v186
    v_cvt_pk_bf16_f32 v96, v96, v97
    v_cvt_pk_bf16_f32 v97, v98, v99
    v_cvt_pk_bf16_f32 v98, v100, v101
    v_cvt_pk_bf16_f32 v99, v102, v103
    v_cvt_pk_bf16_f32 v100, v104, v105
LM_kend_58:
    ds_read_b32 v182, v181
    s_waitcnt lgkmcnt(0)
    v_cmp_gt_u32 vcc, 100, v182
    s_nop 4
    s_cbranch_vccz LM_kendd_59
    s_sleep 1
    s_branch LM_kend_58
LM_kendd_59:
    ds_write_b64 v209, v[6:7]
    ds_write_b64 v210, v[6:7]
    ds_write_b32 v204, v80 offset:0
    ds_write_b32 v205, v81 offset:0
    ds_write_b32 v206, v82 offset:0
    ds_write_b32 v207, v83 offset:0
    s_mov_b64 exec, s[80:81]
    ds_write_b32 v208, v84 offset:0
    s_mov_b64 exec, -1
    ds_write_b32 v204, v96 offset:7168
    ds_write_b32 v205, v97 offset:7168
    ds_write_b32 v206, v98 offset:7168
    ds_write_b32 v207, v99 offset:7168
    s_mov_b64 exec, s[80:81]
    ds_write_b32 v208, v100 offset:7168
    s_mov_b64 exec, -1
    s_waitcnt lgkmcnt(0)
    v_add_u32 v183, 32, v183
    v_mov_b32 v200, 1
    ds_write_b32 v183, v200
    s_mov_b32 s64, s34
    s_and_b32 s65, s35, 0xffff
    s_mov_b32 s66, 1152
    s_mov_b32 s67, 0x00020000
    s_mov_b32 s52, s36
    s_and_b32 s53, s37, 0xffff
    s_mov_b32 s54, 2359296
    s_mov_b32 s55, 0x00020000
    v_lshlrev_b32 v2, 4, v1
    s_lshr_b32 s10, s5, 1
    s_and_b32 s11, s5, 1
    s_mul_i32 s12, s10, 288
    s_lshl_b32 s9, s6, 5
    s_add_u32 s12, s12, s9
    v_lshrrev_b32 v3, 4, v1
    v_lshlrev_b32 v3, 3, v3
    v_add_u32 v3, s12, v3
    v_and_b32 v4, 15, v1
    v_mul_u32_u24 v4, 1152, v4
    v_add_u32 v4, v4, v3
    s_lshl_b32 s13, s4, 1
    s_add_u32 s13, s13, s11
    s_mul_i32 s13, s13, 36864
    s_add_u32 s14, s13, 18432
    buffer_load_dwordx2 v[112:113], v3, s[64:67], 0 offen offset:0
    buffer_load_dwordx2 v[114:115], v4, s[44:47], s13 offen offset:0
    buffer_load_dwordx2 v[116:117], v4, s[44:47], s14 offen offset:0
    buffer_load_dwordx2 v[118:119], v3, s[64:67], 0 offen offset:128
    buffer_load_dwordx2 v[120:121], v4, s[44:47], s13 offen offset:128
    buffer_load_dwordx2 v[122:123], v4, s[44:47], s14 offen offset:128
    buffer_load_dwordx2 v[124:125], v3, s[64:67], 0 offen offset:256
    buffer_load_dwordx2 v[126:127], v4, s[44:47], s13 offen offset:256
    buffer_load_dwordx2 v[128:129], v4, s[44:47], s14 offen offset:256
    s_mul_i32 s84, s4, 589824
    s_mul_i32 s12, s10, 18
    s_add_u32 s12, s12, s11
    s_lshl_b32 s15, s7, 1
    s_add_u32 s12, s12, s15
    s_lshl_b32 s12, s12, 10
    s_add_u32 s84, s84, s12
    s_add_u32 s84, s84, 1048576
    v_add_u32 v5, 8192, v2
    v_add_u32 v6, 16384, v2
    s_lshl_b32 s85, s4, 2
    s_add_u32 s85, s85, s10
    s_lshl_b32 s85, s85, 7
    s_add_u32 s85, s85, 524288
    v_and_b32 v7, 7, v1
    v_lshlrev_b32 v7, 2, v7
    s_movk_i32 s86, 0xff
    v_add_u32 v9, 80, v181
LM_rwait_60:
    ds_read_b32 v8, v9
    s_waitcnt lgkmcnt(0)
    v_cmp_gt_u32 vcc, 1, v8
    s_nop 4
    s_cbranch_vccz LM_rwaitd_61
    s_sleep 1
    s_branch LM_rwait_60
LM_rwaitd_61:
    s_lshl_b32 s9, 1, s5
    s_andn2_b32 s86, s86, s9
    s_mul_i32 s9, s10, 18432
    s_lshl_b32 s12, s7, 10
    s_add_u32 s9, s9, s12
    s_add_u32 s9, s9, 82944
    v_add_u32 v9, s9, v2
    s_cmp_lg_u32 s5, 0
    s_cbranch_scc1 LM_rown_62
    ds_read_b128 v[16:19], v9 offset:0
    ds_read_b128 v[20:23], v9 offset:4096
    ds_read_b128 v[24:27], v9 offset:8192
LM_rown_62:
    s_cmp_lg_u32 s5, 1
    s_cbranch_scc1 LM_rown_63
    ds_read_b128 v[28:31], v9 offset:0
    ds_read_b128 v[32:35], v9 offset:4096
    ds_read_b128 v[36:39], v9 offset:8192
LM_rown_63:
    s_cmp_lg_u32 s5, 2
    s_cbranch_scc1 LM_rown_64
    ds_read_b128 v[40:43], v9 offset:0
    ds_read_b128 v[44:47], v9 offset:4096
    ds_read_b128 v[48:51], v9 offset:8192
LM_rown_64:
    s_cmp_lg_u32 s5, 3
    s_cbranch_scc1 LM_rown_65
    ds_read_b128 v[52:55], v9 offset:0
    ds_read_b128 v[56:59], v9 offset:4096
    ds_read_b128 v[60:63], v9 offset:8192
LM_rown_65:
    s_cmp_lg_u32 s5, 4
    s_cbranch_scc1 LM_rown_66
    ds_read_b128 v[64:67], v9 offset:0
    ds_read_b128 v[68:71], v9 offset:4096
    ds_read_b128 v[72:75], v9 offset:8192
LM_rown_66:
    s_cmp_lg_u32 s5, 5
    s_cbranch_scc1 LM_rown_67
    ds_read_b128 v[76:79], v9 offset:0
    ds_read_b128 v[80:83], v9 offset:4096
    ds_read_b128 v[84:87], v9 offset:8192
LM_rown_67:
    s_cmp_lg_u32 s5, 6
    s_cbranch_scc1 LM_rown_68
    ds_read_b128 v[88:91], v9 offset:0
    ds_read_b128 v[92:95], v9 offset:4096
    ds_read_b128 v[96:99], v9 offset:8192
LM_rown_68:
    s_cmp_lg_u32 s5, 7
    s_cbranch_scc1 LM_rown_69
    ds_read_b128 v[100:103], v9 offset:0
    ds_read_b128 v[104:107], v9 offset:4096
    ds_read_b128 v[108:111], v9 offset:8192
LM_rown_69:
LM_rp_70:
    buffer_load_dword v8, v7, s[68:71], s85 offen sc1
    s_waitcnt vmcnt(0)
    v_cmp_eq_u32 vcc, 1, v8
    s_nop 4
    s_and_b32 s87, vcc_lo, s86
    s_andn2_b32 s86, s86, s87
    s_bitcmp1_b32 s87, 0
    s_cbranch_scc0 LM_rps_72
    s_add_u32 s9, s84, 0
    buffer_load_dwordx4 v[16:19], v2, s[68:71], s9 offen sc1
    buffer_load_dwordx4 v[20:23], v5, s[68:71], s9 offen sc1
    s_cmp_lg_u32 s7, 0
    s_cbranch_scc1 LM_rps_72
    buffer_load_dwordx4 v[24:27], v6, s[68:71], s9 offen sc1
LM_rps_72:
    s_bitcmp1_b32 s87, 1
    s_cbranch_scc0 LM_rps_73
    s_add_u32 s9, s84, 73728
    buffer_load_dwordx4 v[28:31], v2, s[68:71], s9 offen sc1
    buffer_load_dwordx4 v[32:35], v5, s[68:71], s9 offen sc1
    s_cmp_lg_u32 s7, 0
    s_cbranch_scc1 LM_rps_73
    buffer_load_dwordx4 v[36:39], v6, s[68:71], s9 offen sc1
LM_rps_73:
    s_bitcmp1_b32 s87, 2
    s_cbranch_scc0 LM_rps_74
    s_add_u32 s9, s84, 147456
    buffer_load_dwordx4 v[40:43], v2, s[68:71], s9 offen sc1
    buffer_load_dwordx4 v[44:47], v5, s[68:71], s9 offen sc1
    s_cmp_lg_u32 s7, 0
    s_cbranch_scc1 LM_rps_74
    buffer_load_dwordx4 v[48:51], v6, s[68:71], s9 offen sc1
LM_rps_74:
    s_bitcmp1_b32 s87, 3
    s_cbranch_scc0 LM_rps_75
    s_add_u32 s9, s84, 221184
    buffer_load_dwordx4 v[52:55], v2, s[68:71], s9 offen sc1
    buffer_load_dwordx4 v[56:59], v5, s[68:71], s9 offen sc1
    s_cmp_lg_u32 s7, 0
    s_cbranch_scc1 LM_rps_75
    buffer_load_dwordx4 v[60:63], v6, s[68:71], s9 offen sc1
LM_rps_75:
    s_bitcmp1_b32 s87, 4
    s_cbranch_scc0 LM_rps_76
    s_add_u32 s9, s84, 294912
    buffer_load_dwordx4 v[64:67], v2, s[68:71], s9 offen sc1
    buffer_load_dwordx4 v[68:71], v5, s[68:71], s9 offen sc1
    s_cmp_lg_u32 s7, 0
    s_cbranch_scc1 LM_rps_76
    buffer_load_dwordx4 v[72:75], v6, s[68:71], s9 offen sc1
LM_rps_76:
    s_bitcmp1_b32 s87, 5
    s_cbranch_scc0 LM_rps_77
    s_add_u32 s9, s84, 368640
    buffer_load_dwordx4 v[76:79], v2, s[68:71], s9 offen sc1
    buffer_load_dwordx4 v[80:83], v5, s[68:71], s9 offen sc1
    s_cmp_lg_u32 s7, 0
    s_cbranch_scc1 LM_rps_77
    buffer_load_dwordx4 v[84:87], v6, s[68:71], s9 offen sc1
LM_rps_77:
    s_bitcmp1_b32 s87, 6
    s_cbranch_scc0 LM_rps_78
    s_add_u32 s9, s84, 442368
    buffer_load_dwordx4 v[88:91], v2, s[68:71], s9 offen sc1
    buffer_load_dwordx4 v[92:95], v5, s[68:71], s9 offen sc1
    s_cmp_lg_u32 s7, 0
    s_cbranch_scc1 LM_rps_78
    buffer_load_dwordx4 v[96:99], v6, s[68:71], s9 offen sc1
LM_rps_78:
    s_bitcmp1_b32 s87, 7
    s_cbranch_scc0 LM_rps_79
    s_add_u32 s9, s84, 516096
    buffer_load_dwordx4 v[100:103], v2, s[68:71], s9 offen sc1
    buffer_load_dwordx4 v[104:107], v5, s[68:71], s9 offen sc1
    s_cmp_lg_u32 s7, 0
    s_cbranch_scc1 LM_rps_79
    buffer_load_dwordx4 v[108:111], v6, s[68:71], s9 offen sc1
LM_rps_79:
    s_cmp_eq_u32 s86, 0
    s_cbranch_scc1 LM_rpd_71
    s_sleep 2
    s_branch LM_rp_70
LM_rpd_71:
    s_waitcnt vmcnt(0) lgkmcnt(0)
    v_lshlrev_b32 v136, 16, v112
    v_and_b32 v137, 0xffff0000, v112
    v_lshlrev_b32 v144, 16, v114
    v_and_b32 v145, 0xffff0000, v114
    v_pk_add_f32 v[136:137], v[136:137], v[144:145]
    v_lshlrev_b32 v138, 16, v113
    v_and_b32 v139, 0xffff0000, v113
    v_lshlrev_b32 v144, 16, v115
    v_and_b32 v145, 0xffff0000, v115
    v_pk_add_f32 v[138:139], v[138:139], v[144:145]
    v_lshlrev_b32 v140, 16, v112
    v_and_b32 v141, 0xffff0000, v112
    v_lshlrev_b32 v144, 16, v116
    v_and_b32 v145, 0xffff0000, v116
    v_pk_add_f32 v[140:141], v[140:141], v[144:145]
    v_lshlrev_b32 v142, 16, v113
    v_and_b32 v143, 0xffff0000, v113
    v_lshlrev_b32 v144, 16, v117
    v_and_b32 v145, 0xffff0000, v117
    v_pk_add_f32 v[142:143], v[142:143], v[144:145]
    v_lshlrev_b32 v144, 16, v16
    v_and_b32 v145, 0xffff0000, v16
    v_pk_add_f32 v[136:137], v[136:137], v[144:145]
    v_lshlrev_b32 v146, 16, v17
    v_and_b32 v147, 0xffff0000, v17
    v_pk_add_f32 v[138:139], v[138:139], v[146:147]
    v_lshlrev_b32 v144, 16, v18
    v_and_b32 v145, 0xffff0000, v18
    v_pk_add_f32 v[140:141], v[140:141], v[144:145]
    v_lshlrev_b32 v146, 16, v19
    v_and_b32 v147, 0xffff0000, v19
    v_pk_add_f32 v[142:143], v[142:143], v[146:147]
    v_lshlrev_b32 v144, 16, v28
    v_and_b32 v145, 0xffff0000, v28
    v_pk_add_f32 v[136:137], v[136:137], v[144:145]
    v_lshlrev_b32 v146, 16, v29
    v_and_b32 v147, 0xffff0000, v29
    v_pk_add_f32 v[138:139], v[138:139], v[146:147]
    v_lshlrev_b32 v144, 16, v30
    v_and_b32 v145, 0xffff0000, v30
    v_pk_add_f32 v[140:141], v[140:141], v[144:145]
    v_lshlrev_b32 v146, 16, v31
    v_and_b32 v147, 0xffff0000, v31
    v_pk_add_f32 v[142:143], v[142:143], v[146:147]
    v_lshlrev_b32 v144, 16, v40
    v_and_b32 v145, 0xffff0000, v40
    v_pk_add_f32 v[136:137], v[136:137], v[144:145]
    v_lshlrev_b32 v146, 16, v41
    v_and_b32 v147, 0xffff0000, v41
    v_pk_add_f32 v[138:139], v[138:139], v[146:147]
    v_lshlrev_b32 v144, 16, v42
    v_and_b32 v145, 0xffff0000, v42
    v_pk_add_f32 v[140:141], v[140:141], v[144:145]
    v_lshlrev_b32 v146, 16, v43
    v_and_b32 v147, 0xffff0000, v43
    v_pk_add_f32 v[142:143], v[142:143], v[146:147]
    v_lshlrev_b32 v144, 16, v52
    v_and_b32 v145, 0xffff0000, v52
    v_pk_add_f32 v[136:137], v[136:137], v[144:145]
    v_lshlrev_b32 v146, 16, v53
    v_and_b32 v147, 0xffff0000, v53
    v_pk_add_f32 v[138:139], v[138:139], v[146:147]
    v_lshlrev_b32 v144, 16, v54
    v_and_b32 v145, 0xffff0000, v54
    v_pk_add_f32 v[140:141], v[140:141], v[144:145]
    v_lshlrev_b32 v146, 16, v55
    v_and_b32 v147, 0xffff0000, v55
    v_pk_add_f32 v[142:143], v[142:143], v[146:147]
    v_lshlrev_b32 v144, 16, v64
    v_and_b32 v145, 0xffff0000, v64
    v_pk_add_f32 v[136:137], v[136:137], v[144:145]
    v_lshlrev_b32 v146, 16, v65
    v_and_b32 v147, 0xffff0000, v65
    v_pk_add_f32 v[138:139], v[138:139], v[146:147]
    v_lshlrev_b32 v144, 16, v66
    v_and_b32 v145, 0xffff0000, v66
    v_pk_add_f32 v[140:141], v[140:141], v[144:145]
    v_lshlrev_b32 v146, 16, v67
    v_and_b32 v147, 0xffff0000, v67
    v_pk_add_f32 v[142:143], v[142:143], v[146:147]
    v_lshlrev_b32 v144, 16, v76
    v_and_b32 v145, 0xffff0000, v76
    v_pk_add_f32 v[136:137], v[136:137], v[144:145]
    v_lshlrev_b32 v146, 16, v77
    v_and_b32 v147, 0xffff0000, v77
    v_pk_add_f32 v[138:139], v[138:139], v[146:147]
    v_lshlrev_b32 v144, 16, v78
    v_and_b32 v145, 0xffff0000, v78
    v_pk_add_f32 v[140:141], v[140:141], v[144:145]
    v_lshlrev_b32 v146, 16, v79
    v_and_b32 v147, 0xffff0000, v79
    v_pk_add_f32 v[142:143], v[142:143], v[146:147]
    v_lshlrev_b32 v144, 16, v88
    v_and_b32 v145, 0xffff0000, v88
    v_pk_add_f32 v[136:137], v[136:137], v[144:145]
    v_lshlrev_b32 v146, 16, v89
    v_and_b32 v147, 0xffff0000, v89
    v_pk_add_f32 v[138:139], v[138:139], v[146:147]
    v_lshlrev_b32 v144, 16, v90
    v_and_b32 v145, 0xffff0000, v90
    v_pk_add_f32 v[140:141], v[140:141], v[144:145]
    v_lshlrev_b32 v146, 16, v91
    v_and_b32 v147, 0xffff0000, v91
    v_pk_add_f32 v[142:143], v[142:143], v[146:147]
    v_lshlrev_b32 v144, 16, v100
    v_and_b32 v145, 0xffff0000, v100
    v_pk_add_f32 v[136:137], v[136:137], v[144:145]
    v_lshlrev_b32 v146, 16, v101
    v_and_b32 v147, 0xffff0000, v101
    v_pk_add_f32 v[138:139], v[138:139], v[146:147]
    v_lshlrev_b32 v144, 16, v102
    v_and_b32 v145, 0xffff0000, v102
    v_pk_add_f32 v[140:141], v[140:141], v[144:145]
    v_lshlrev_b32 v146, 16, v103
    v_and_b32 v147, 0xffff0000, v103
    v_pk_add_f32 v[142:143], v[142:143], v[146:147]
    v_cvt_pk_bf16_f32 v148, v136, v137
    v_cvt_pk_bf16_f32 v149, v138, v139
    v_cvt_pk_bf16_f32 v150, v140, v141
    v_cvt_pk_bf16_f32 v151, v142, v143
    buffer_store_dwordx2 v[148:149], v4, s[52:55], s13 offen offset:0
    buffer_store_dwordx2 v[150:151], v4, s[52:55], s14 offen offset:0
    v_lshlrev_b32 v152, 16, v118
    v_and_b32 v153, 0xffff0000, v118
    v_lshlrev_b32 v160, 16, v120
    v_and_b32 v161, 0xffff0000, v120
    v_pk_add_f32 v[152:153], v[152:153], v[160:161]
    v_lshlrev_b32 v154, 16, v119
    v_and_b32 v155, 0xffff0000, v119
    v_lshlrev_b32 v160, 16, v121
    v_and_b32 v161, 0xffff0000, v121
    v_pk_add_f32 v[154:155], v[154:155], v[160:161]
    v_lshlrev_b32 v156, 16, v118
    v_and_b32 v157, 0xffff0000, v118
    v_lshlrev_b32 v160, 16, v122
    v_and_b32 v161, 0xffff0000, v122
    v_pk_add_f32 v[156:157], v[156:157], v[160:161]
    v_lshlrev_b32 v158, 16, v119
    v_and_b32 v159, 0xffff0000, v119
    v_lshlrev_b32 v160, 16, v123
    v_and_b32 v161, 0xffff0000, v123
    v_pk_add_f32 v[158:159], v[158:159], v[160:161]
    v_lshlrev_b32 v160, 16, v20
    v_and_b32 v161, 0xffff0000, v20
    v_pk_add_f32 v[152:153], v[152:153], v[160:161]
    v_lshlrev_b32 v162, 16, v21
    v_and_b32 v163, 0xffff0000, v21
    v_pk_add_f32 v[154:155], v[154:155], v[162:163]
    v_lshlrev_b32 v160, 16, v22
    v_and_b32 v161, 0xffff0000, v22
    v_pk_add_f32 v[156:157], v[156:157], v[160:161]
    v_lshlrev_b32 v162, 16, v23
    v_and_b32 v163, 0xffff0000, v23
    v_pk_add_f32 v[158:159], v[158:159], v[162:163]
    v_lshlrev_b32 v160, 16, v32
    v_and_b32 v161, 0xffff0000, v32
    v_pk_add_f32 v[152:153], v[152:153], v[160:161]
    v_lshlrev_b32 v162, 16, v33
    v_and_b32 v163, 0xffff0000, v33
    v_pk_add_f32 v[154:155], v[154:155], v[162:163]
    v_lshlrev_b32 v160, 16, v34
    v_and_b32 v161, 0xffff0000, v34
    v_pk_add_f32 v[156:157], v[156:157], v[160:161]
    v_lshlrev_b32 v162, 16, v35
    v_and_b32 v163, 0xffff0000, v35
    v_pk_add_f32 v[158:159], v[158:159], v[162:163]
    v_lshlrev_b32 v160, 16, v44
    v_and_b32 v161, 0xffff0000, v44
    v_pk_add_f32 v[152:153], v[152:153], v[160:161]
    v_lshlrev_b32 v162, 16, v45
    v_and_b32 v163, 0xffff0000, v45
    v_pk_add_f32 v[154:155], v[154:155], v[162:163]
    v_lshlrev_b32 v160, 16, v46
    v_and_b32 v161, 0xffff0000, v46
    v_pk_add_f32 v[156:157], v[156:157], v[160:161]
    v_lshlrev_b32 v162, 16, v47
    v_and_b32 v163, 0xffff0000, v47
    v_pk_add_f32 v[158:159], v[158:159], v[162:163]
    v_lshlrev_b32 v160, 16, v56
    v_and_b32 v161, 0xffff0000, v56
    v_pk_add_f32 v[152:153], v[152:153], v[160:161]
    v_lshlrev_b32 v162, 16, v57
    v_and_b32 v163, 0xffff0000, v57
    v_pk_add_f32 v[154:155], v[154:155], v[162:163]
    v_lshlrev_b32 v160, 16, v58
    v_and_b32 v161, 0xffff0000, v58
    v_pk_add_f32 v[156:157], v[156:157], v[160:161]
    v_lshlrev_b32 v162, 16, v59
    v_and_b32 v163, 0xffff0000, v59
    v_pk_add_f32 v[158:159], v[158:159], v[162:163]
    v_lshlrev_b32 v160, 16, v68
    v_and_b32 v161, 0xffff0000, v68
    v_pk_add_f32 v[152:153], v[152:153], v[160:161]
    v_lshlrev_b32 v162, 16, v69
    v_and_b32 v163, 0xffff0000, v69
    v_pk_add_f32 v[154:155], v[154:155], v[162:163]
    v_lshlrev_b32 v160, 16, v70
    v_and_b32 v161, 0xffff0000, v70
    v_pk_add_f32 v[156:157], v[156:157], v[160:161]
    v_lshlrev_b32 v162, 16, v71
    v_and_b32 v163, 0xffff0000, v71
    v_pk_add_f32 v[158:159], v[158:159], v[162:163]
    v_lshlrev_b32 v160, 16, v80
    v_and_b32 v161, 0xffff0000, v80
    v_pk_add_f32 v[152:153], v[152:153], v[160:161]
    v_lshlrev_b32 v162, 16, v81
    v_and_b32 v163, 0xffff0000, v81
    v_pk_add_f32 v[154:155], v[154:155], v[162:163]
    v_lshlrev_b32 v160, 16, v82
    v_and_b32 v161, 0xffff0000, v82
    v_pk_add_f32 v[156:157], v[156:157], v[160:161]
    v_lshlrev_b32 v162, 16, v83
    v_and_b32 v163, 0xffff0000, v83
    v_pk_add_f32 v[158:159], v[158:159], v[162:163]
    v_lshlrev_b32 v160, 16, v92
    v_and_b32 v161, 0xffff0000, v92
    v_pk_add_f32 v[152:153], v[152:153], v[160:161]
    v_lshlrev_b32 v162, 16, v93
    v_and_b32 v163, 0xffff0000, v93
    v_pk_add_f32 v[154:155], v[154:155], v[162:163]
    v_lshlrev_b32 v160, 16, v94
    v_and_b32 v161, 0xffff0000, v94
    v_pk_add_f32 v[156:157], v[156:157], v[160:161]
    v_lshlrev_b32 v162, 16, v95
    v_and_b32 v163, 0xffff0000, v95
    v_pk_add_f32 v[158:159], v[158:159], v[162:163]
    v_lshlrev_b32 v160, 16, v104
    v_and_b32 v161, 0xffff0000, v104
    v_pk_add_f32 v[152:153], v[152:153], v[160:161]
    v_lshlrev_b32 v162, 16, v105
    v_and_b32 v163, 0xffff0000, v105
    v_pk_add_f32 v[154:155], v[154:155], v[162:163]
    v_lshlrev_b32 v160, 16, v106
    v_and_b32 v161, 0xffff0000, v106
    v_pk_add_f32 v[156:157], v[156:157], v[160:161]
    v_lshlrev_b32 v162, 16, v107
    v_and_b32 v163, 0xffff0000, v107
    v_pk_add_f32 v[158:159], v[158:159], v[162:163]
    v_cvt_pk_bf16_f32 v164, v152, v153
    v_cvt_pk_bf16_f32 v165, v154, v155
    v_cvt_pk_bf16_f32 v166, v156, v157
    v_cvt_pk_bf16_f32 v167, v158, v159
    buffer_store_dwordx2 v[164:165], v4, s[52:55], s13 offen offset:128
    buffer_store_dwordx2 v[166:167], v4, s[52:55], s14 offen offset:128
    s_cmp_lg_u32 s7, 0
    s_cbranch_scc1 LM_red8_80
    v_lshlrev_b32 v168, 16, v124
    v_and_b32 v169, 0xffff0000, v124
    v_lshlrev_b32 v176, 16, v126
    v_and_b32 v177, 0xffff0000, v126
    v_pk_add_f32 v[168:169], v[168:169], v[176:177]
    v_lshlrev_b32 v170, 16, v125
    v_and_b32 v171, 0xffff0000, v125
    v_lshlrev_b32 v176, 16, v127
    v_and_b32 v177, 0xffff0000, v127
    v_pk_add_f32 v[170:171], v[170:171], v[176:177]
    v_lshlrev_b32 v172, 16, v124
    v_and_b32 v173, 0xffff0000, v124
    v_lshlrev_b32 v176, 16, v128
    v_and_b32 v177, 0xffff0000, v128
    v_pk_add_f32 v[172:173], v[172:173], v[176:177]
    v_lshlrev_b32 v174, 16, v125
    v_and_b32 v175, 0xffff0000, v125
    v_lshlrev_b32 v176, 16, v129
    v_and_b32 v177, 0xffff0000, v129
    v_pk_add_f32 v[174:175], v[174:175], v[176:177]
    v_lshlrev_b32 v176, 16, v24
    v_and_b32 v177, 0xffff0000, v24
    v_pk_add_f32 v[168:169], v[168:169], v[176:177]
    v_lshlrev_b32 v178, 16, v25
    v_and_b32 v179, 0xffff0000, v25
    v_pk_add_f32 v[170:171], v[170:171], v[178:179]
    v_lshlrev_b32 v176, 16, v26
    v_and_b32 v177, 0xffff0000, v26
    v_pk_add_f32 v[172:173], v[172:173], v[176:177]
    v_lshlrev_b32 v178, 16, v27
    v_and_b32 v179, 0xffff0000, v27
    v_pk_add_f32 v[174:175], v[174:175], v[178:179]
    v_lshlrev_b32 v176, 16, v36
    v_and_b32 v177, 0xffff0000, v36
    v_pk_add_f32 v[168:169], v[168:169], v[176:177]
    v_lshlrev_b32 v178, 16, v37
    v_and_b32 v179, 0xffff0000, v37
    v_pk_add_f32 v[170:171], v[170:171], v[178:179]
    v_lshlrev_b32 v176, 16, v38
    v_and_b32 v177, 0xffff0000, v38
    v_pk_add_f32 v[172:173], v[172:173], v[176:177]
    v_lshlrev_b32 v178, 16, v39
    v_and_b32 v179, 0xffff0000, v39
    v_pk_add_f32 v[174:175], v[174:175], v[178:179]
    v_lshlrev_b32 v176, 16, v48
    v_and_b32 v177, 0xffff0000, v48
    v_pk_add_f32 v[168:169], v[168:169], v[176:177]
    v_lshlrev_b32 v178, 16, v49
    v_and_b32 v179, 0xffff0000, v49
    v_pk_add_f32 v[170:171], v[170:171], v[178:179]
    v_lshlrev_b32 v176, 16, v50
    v_and_b32 v177, 0xffff0000, v50
    v_pk_add_f32 v[172:173], v[172:173], v[176:177]
    v_lshlrev_b32 v178, 16, v51
    v_and_b32 v179, 0xffff0000, v51
    v_pk_add_f32 v[174:175], v[174:175], v[178:179]
    v_lshlrev_b32 v176, 16, v60
    v_and_b32 v177, 0xffff0000, v60
    v_pk_add_f32 v[168:169], v[168:169], v[176:177]
    v_lshlrev_b32 v178, 16, v61
    v_and_b32 v179, 0xffff0000, v61
    v_pk_add_f32 v[170:171], v[170:171], v[178:179]
    v_lshlrev_b32 v176, 16, v62
    v_and_b32 v177, 0xffff0000, v62
    v_pk_add_f32 v[172:173], v[172:173], v[176:177]
    v_lshlrev_b32 v178, 16, v63
    v_and_b32 v179, 0xffff0000, v63
    v_pk_add_f32 v[174:175], v[174:175], v[178:179]
    v_lshlrev_b32 v176, 16, v72
    v_and_b32 v177, 0xffff0000, v72
    v_pk_add_f32 v[168:169], v[168:169], v[176:177]
    v_lshlrev_b32 v178, 16, v73
    v_and_b32 v179, 0xffff0000, v73
    v_pk_add_f32 v[170:171], v[170:171], v[178:179]
    v_lshlrev_b32 v176, 16, v74
    v_and_b32 v177, 0xffff0000, v74
    v_pk_add_f32 v[172:173], v[172:173], v[176:177]
    v_lshlrev_b32 v178, 16, v75
    v_and_b32 v179, 0xffff0000, v75
    v_pk_add_f32 v[174:175], v[174:175], v[178:179]
    v_lshlrev_b32 v176, 16, v84
    v_and_b32 v177, 0xffff0000, v84
    v_pk_add_f32 v[168:169], v[168:169], v[176:177]
    v_lshlrev_b32 v178, 16, v85
    v_and_b32 v179, 0xffff0000, v85
    v_pk_add_f32 v[170:171], v[170:171], v[178:179]
    v_lshlrev_b32 v176, 16, v86
    v_and_b32 v177, 0xffff0000, v86
    v_pk_add_f32 v[172:173], v[172:173], v[176:177]
    v_lshlrev_b32 v178, 16, v87
    v_and_b32 v179, 0xffff0000, v87
    v_pk_add_f32 v[174:175], v[174:175], v[178:179]
    v_lshlrev_b32 v176, 16, v96
    v_and_b32 v177, 0xffff0000, v96
    v_pk_add_f32 v[168:169], v[168:169], v[176:177]
    v_lshlrev_b32 v178, 16, v97
    v_and_b32 v179, 0xffff0000, v97
    v_pk_add_f32 v[170:171], v[170:171], v[178:179]
    v_lshlrev_b32 v176, 16, v98
    v_and_b32 v177, 0xffff0000, v98
    v_pk_add_f32 v[172:173], v[172:173], v[176:177]
    v_lshlrev_b32 v178, 16, v99
    v_and_b32 v179, 0xffff0000, v99
    v_pk_add_f32 v[174:175], v[174:175], v[178:179]
    v_lshlrev_b32 v176, 16, v108
    v_and_b32 v177, 0xffff0000, v108
    v_pk_add_f32 v[168:169], v[168:169], v[176:177]
    v_lshlrev_b32 v178, 16, v109
    v_and_b32 v179, 0xffff0000, v109
    v_pk_add_f32 v[170:171], v[170:171], v[178:179]
    v_lshlrev_b32 v176, 16, v110
    v_and_b32 v177, 0xffff0000, v110
    v_pk_add_f32 v[172:173], v[172:173], v[176:177]
    v_lshlrev_b32 v178, 16, v111
    v_and_b32 v179, 0xffff0000, v111
    v_pk_add_f32 v[174:175], v[174:175], v[178:179]
    v_cvt_pk_bf16_f32 v180, v168, v169
    v_cvt_pk_bf16_f32 v181, v170, v171
    v_cvt_pk_bf16_f32 v182, v172, v173
    v_cvt_pk_bf16_f32 v183, v174, v175
    buffer_store_dwordx2 v[180:181], v4, s[52:55], s13 offen offset:256
    buffer_store_dwordx2 v[182:183], v4, s[52:55], s14 offen offset:256
LM_red8_80:
    s_waitcnt vmcnt(0)
    s_branch LM_end
LM_fwaves_2:
    s_setprio 3
    s_mov_b32 s48, s18
    s_and_b32 s49, s19, 0xffff
    s_mov_b32 s50, 663552
    s_mov_b32 s51, 0x00020000
    s_cmp_ge_u32 s7, 2
    s_cbranch_scc1 LM_fstage_81
    v_lshrrev_b32 v2, 3, v1
    v_and_b32 v3, 7, v1
    v_mul_u32_u24 v4, 1152, v2
    v_lshl_add_u32 v4, v3, 4, v4
    s_lshr_b32 s13, s5, 1
    s_lshl_b32 s11, s13, 4
    s_lshl_b32 s12, s7, 3
    s_add_u32 s11, s11, s12
    s_lshl_b32 s8, s4, 6
    s_add_u32 s8, s8, s11
    s_mul_i32 s8, s8, 1152
    buffer_load_dwordx4 v[8:11], v4, s[44:47], s8 offen offset:0
    buffer_load_dwordx4 v[12:15], v4, s[44:47], s8 offen offset:128
    buffer_load_dwordx4 v[16:19], v4, s[44:47], s8 offen offset:256
    buffer_load_dwordx4 v[20:23], v4, s[44:47], s8 offen offset:384
    buffer_load_dwordx4 v[24:27], v4, s[44:47], s8 offen offset:512
    buffer_load_dwordx4 v[28:31], v4, s[44:47], s8 offen offset:640
    buffer_load_dwordx4 v[32:35], v4, s[44:47], s8 offen offset:768
    buffer_load_dwordx4 v[36:39], v4, s[44:47], s8 offen offset:896
    buffer_load_dwordx4 v[40:43], v4, s[44:47], s8 offen offset:1024
    v_add_u32 v5, s11, v2
    v_bfe_u32 v6, v5, 1, 3
    v_lshrrev_b32 v7, 2, v3
    v_lshlrev_b32 v7, 2, v7
    v_and_b32 v44, 1, v3
    v_lshl_add_u32 v7, v44, 1, v7
    v_xor_b32 v7, v7, v6
    v_mul_u32_u24 v44, 1152, v5
    v_lshl_add_u32 v44, v7, 4, v44
    v_bfe_u32 v7, v3, 1, 1
    v_lshl_add_u32 v44, v7, 3, v44
    v_xor_b32 v45, 16, v44
    v_and_b32 v48, 3, v1
    v_lshlrev_b32 v48, 2, v48
    v_add_u32 v48, 163776, v48
    s_lshl_b32 s9, s7, 2
    s_add_u32 s9, s9, 163776
    v_mov_b32 v47, s9
    v_and_b32 v5, 15, v1
    v_lshrrev_b32 v6, 4, v1
    v_bfe_u32 v7, v5, 1, 3
    v_xor_b32 v7, v7, v6
    v_mul_u32_u24 v70, 1152, v5
    s_mul_i32 s9, s13, 18432
    v_add_u32 v70, s9, v70
    v_xor_b32 v71, 4, v7
    v_lshl_add_u32 v71, v71, 4, v70
    v_lshl_add_u32 v70, v7, 4, v70
    v_lshrrev_b32 v7, 2, v1
    v_mul_u32_u24 v72, 48, v7
    v_and_b32 v7, 3, v1
    v_lshlrev_b32 v7, 3, v7
    s_cmp_lg_u32 s7, 0
    s_cselect_b64 vcc, -1, 0
    v_cndmask_b32 v7, v7, 40, vcc
    v_add_u32 v72, v72, v7
    s_cmp_lt_u32 s13, 2
    s_cselect_b32 s9, 36864, 0
    v_add_u32 v72, s9, v72
    s_waitcnt vmcnt(0)
    v_mov_b32 v52, 0
    v_mov_b32 v53, 0
    v_mov_b32 v54, 0
    v_mov_b32 v55, 0
    s_mov_b32 s9, 0x3f803f80
    v_dot2c_f32_bf16 v52, s9, v8
    v_dot2c_f32_bf16 v54, v8, v8
    v_dot2c_f32_bf16 v53, s9, v9
    v_dot2c_f32_bf16 v55, v9, v9
    v_dot2c_f32_bf16 v52, s9, v10
    v_dot2c_f32_bf16 v54, v10, v10
    v_dot2c_f32_bf16 v53, s9, v11
    v_dot2c_f32_bf16 v55, v11, v11
    v_dot2c_f32_bf16 v52, s9, v12
    v_dot2c_f32_bf16 v54, v12, v12
    v_dot2c_f32_bf16 v53, s9, v13
    v_dot2c_f32_bf16 v55, v13, v13
    v_dot2c_f32_bf16 v52, s9, v14
    v_dot2c_f32_bf16 v54, v14, v14
    v_dot2c_f32_bf16 v53, s9, v15
    v_dot2c_f32_bf16 v55, v15, v15
    v_dot2c_f32_bf16 v52, s9, v16
    v_dot2c_f32_bf16 v54, v16, v16
    v_dot2c_f32_bf16 v53, s9, v17
    v_dot2c_f32_bf16 v55, v17, v17
    v_dot2c_f32_bf16 v52, s9, v18
    v_dot2c_f32_bf16 v54, v18, v18
    v_dot2c_f32_bf16 v53, s9, v19
    v_dot2c_f32_bf16 v55, v19, v19
    v_dot2c_f32_bf16 v52, s9, v20
    v_dot2c_f32_bf16 v54, v20, v20
    v_dot2c_f32_bf16 v53, s9, v21
    v_dot2c_f32_bf16 v55, v21, v21
    v_dot2c_f32_bf16 v52, s9, v22
    v_dot2c_f32_bf16 v54, v22, v22
    v_dot2c_f32_bf16 v53, s9, v23
    v_dot2c_f32_bf16 v55, v23, v23
    v_dot2c_f32_bf16 v52, s9, v24
    v_dot2c_f32_bf16 v54, v24, v24
    v_dot2c_f32_bf16 v53, s9, v25
    v_dot2c_f32_bf16 v55, v25, v25
    v_dot2c_f32_bf16 v52, s9, v26
    v_dot2c_f32_bf16 v54, v26, v26
    v_dot2c_f32_bf16 v53, s9, v27
    v_dot2c_f32_bf16 v55, v27, v27
    v_dot2c_f32_bf16 v52, s9, v28
    v_dot2c_f32_bf16 v54, v28, v28
    v_dot2c_f32_bf16 v53, s9, v29
    v_dot2c_f32_bf16 v55, v29, v29
    v_dot2c_f32_bf16 v52, s9, v30
    v_dot2c_f32_bf16 v54, v30, v30
    v_dot2c_f32_bf16 v53, s9, v31
    v_dot2c_f32_bf16 v55, v31, v31
    v_dot2c_f32_bf16 v52, s9, v32
    v_dot2c_f32_bf16 v54, v32, v32
    v_dot2c_f32_bf16 v53, s9, v33
    v_dot2c_f32_bf16 v55, v33, v33
    v_dot2c_f32_bf16 v52, s9, v34
    v_dot2c_f32_bf16 v54, v34, v34
    v_dot2c_f32_bf16 v53, s9, v35
    v_dot2c_f32_bf16 v55, v35, v35
    v_dot2c_f32_bf16 v52, s9, v36
    v_dot2c_f32_bf16 v54, v36, v36
    v_dot2c_f32_bf16 v53, s9, v37
    v_dot2c_f32_bf16 v55, v37, v37
    v_dot2c_f32_bf16 v52, s9, v38
    v_dot2c_f32_bf16 v54, v38, v38
    v_dot2c_f32_bf16 v53, s9, v39
    v_dot2c_f32_bf16 v55, v39, v39
    v_dot2c_f32_bf16 v52, s9, v40
    v_dot2c_f32_bf16 v54, v40, v40
    v_dot2c_f32_bf16 v53, s9, v41
    v_dot2c_f32_bf16 v55, v41, v41
    v_dot2c_f32_bf16 v52, s9, v42
    v_dot2c_f32_bf16 v54, v42, v42
    v_dot2c_f32_bf16 v53, s9, v43
    v_dot2c_f32_bf16 v55, v43, v43
    s_nop 3
    v_add_f32 v52, v52, v53
    v_add_f32 v54, v54, v55
    s_nop 1
    v_add_f32_dpp v52, v52, v52 quad_perm:[1,0,3,2] row_mask:0xf bank_mask:0xf
    v_add_f32_dpp v54, v54, v54 quad_perm:[1,0,3,2] row_mask:0xf bank_mask:0xf
    s_nop 1
    v_add_f32_dpp v52, v52, v52 quad_perm:[2,3,0,1] row_mask:0xf bank_mask:0xf
    v_add_f32_dpp v54, v54, v54 quad_perm:[2,3,0,1] row_mask:0xf bank_mask:0xf
    s_nop 1
    v_add_f32_dpp v52, v52, v52 row_half_mirror row_mask:0xf bank_mask:0xf
    v_add_f32_dpp v54, v54, v54 row_half_mirror row_mask:0xf bank_mask:0xf
    s_mov_b32 s9, 987991609
    v_mul_f32 v52, s9, v52
    v_mul_f32 v54, s9, v54
    v_fma_f32 v54, -v52, v52, v54
    v_max_f32 v54, 0, v54
    v_add_f32 v54, 925353388, v54
    v_rsq_f32 v56, v54
    s_nop 0
    v_mov_b32 v57, v56
    v_mul_f32 v58, v52, v56
    v_sub_f32 v58, 0, v58
    v_mov_b32 v59, v58
    v_lshlrev_b32 v60, 16, v8
    v_and_b32 v61, 0xffff0000, v8
    v_pk_fma_f32 v[60:61], v[60:61], v[56:57], v[58:59]
    v_cvt_pk_bf16_f32 v8, v60, v61
    v_lshlrev_b32 v62, 16, v9
    v_and_b32 v63, 0xffff0000, v9
    v_pk_fma_f32 v[62:63], v[62:63], v[56:57], v[58:59]
    v_cvt_pk_bf16_f32 v9, v62, v63
    v_lshlrev_b32 v64, 16, v10
    v_and_b32 v65, 0xffff0000, v10
    v_pk_fma_f32 v[64:65], v[64:65], v[56:57], v[58:59]
    v_cvt_pk_bf16_f32 v10, v64, v65
    v_lshlrev_b32 v66, 16, v11
    v_and_b32 v67, 0xffff0000, v11
    v_pk_fma_f32 v[66:67], v[66:67], v[56:57], v[58:59]
    v_cvt_pk_bf16_f32 v11, v66, v67
    v_lshlrev_b32 v60, 16, v12
    v_and_b32 v61, 0xffff0000, v12
    v_pk_fma_f32 v[60:61], v[60:61], v[56:57], v[58:59]
    v_cvt_pk_bf16_f32 v12, v60, v61
    v_lshlrev_b32 v62, 16, v13
    v_and_b32 v63, 0xffff0000, v13
    v_pk_fma_f32 v[62:63], v[62:63], v[56:57], v[58:59]
    v_cvt_pk_bf16_f32 v13, v62, v63
    v_lshlrev_b32 v64, 16, v14
    v_and_b32 v65, 0xffff0000, v14
    v_pk_fma_f32 v[64:65], v[64:65], v[56:57], v[58:59]
    v_cvt_pk_bf16_f32 v14, v64, v65
    v_lshlrev_b32 v66, 16, v15
    v_and_b32 v67, 0xffff0000, v15
    v_pk_fma_f32 v[66:67], v[66:67], v[56:57], v[58:59]
    v_cvt_pk_bf16_f32 v15, v66, v67
    v_lshlrev_b32 v60, 16, v16
    v_and_b32 v61, 0xffff0000, v16
    v_pk_fma_f32 v[60:61], v[60:61], v[56:57], v[58:59]
    v_cvt_pk_bf16_f32 v16, v60, v61
    v_lshlrev_b32 v62, 16, v17
    v_and_b32 v63, 0xffff0000, v17
    v_pk_fma_f32 v[62:63], v[62:63], v[56:57], v[58:59]
    v_cvt_pk_bf16_f32 v17, v62, v63
    v_lshlrev_b32 v64, 16, v18
    v_and_b32 v65, 0xffff0000, v18
    v_pk_fma_f32 v[64:65], v[64:65], v[56:57], v[58:59]
    v_cvt_pk_bf16_f32 v18, v64, v65
    v_lshlrev_b32 v66, 16, v19
    v_and_b32 v67, 0xffff0000, v19
    v_pk_fma_f32 v[66:67], v[66:67], v[56:57], v[58:59]
    v_cvt_pk_bf16_f32 v19, v66, v67
    v_lshlrev_b32 v60, 16, v20
    v_and_b32 v61, 0xffff0000, v20
    v_pk_fma_f32 v[60:61], v[60:61], v[56:57], v[58:59]
    v_cvt_pk_bf16_f32 v20, v60, v61
    v_lshlrev_b32 v62, 16, v21
    v_and_b32 v63, 0xffff0000, v21
    v_pk_fma_f32 v[62:63], v[62:63], v[56:57], v[58:59]
    v_cvt_pk_bf16_f32 v21, v62, v63
    v_lshlrev_b32 v64, 16, v22
    v_and_b32 v65, 0xffff0000, v22
    v_pk_fma_f32 v[64:65], v[64:65], v[56:57], v[58:59]
    v_cvt_pk_bf16_f32 v22, v64, v65
    v_lshlrev_b32 v66, 16, v23
    v_and_b32 v67, 0xffff0000, v23
    v_pk_fma_f32 v[66:67], v[66:67], v[56:57], v[58:59]
    v_cvt_pk_bf16_f32 v23, v66, v67
    v_lshlrev_b32 v60, 16, v24
    v_and_b32 v61, 0xffff0000, v24
    v_pk_fma_f32 v[60:61], v[60:61], v[56:57], v[58:59]
    v_cvt_pk_bf16_f32 v24, v60, v61
    v_lshlrev_b32 v62, 16, v25
    v_and_b32 v63, 0xffff0000, v25
    v_pk_fma_f32 v[62:63], v[62:63], v[56:57], v[58:59]
    v_cvt_pk_bf16_f32 v25, v62, v63
    v_lshlrev_b32 v64, 16, v26
    v_and_b32 v65, 0xffff0000, v26
    v_pk_fma_f32 v[64:65], v[64:65], v[56:57], v[58:59]
    v_cvt_pk_bf16_f32 v26, v64, v65
    v_lshlrev_b32 v66, 16, v27
    v_and_b32 v67, 0xffff0000, v27
    v_pk_fma_f32 v[66:67], v[66:67], v[56:57], v[58:59]
    v_cvt_pk_bf16_f32 v27, v66, v67
    v_lshlrev_b32 v60, 16, v28
    v_and_b32 v61, 0xffff0000, v28
    v_pk_fma_f32 v[60:61], v[60:61], v[56:57], v[58:59]
    v_cvt_pk_bf16_f32 v28, v60, v61
    v_lshlrev_b32 v62, 16, v29
    v_and_b32 v63, 0xffff0000, v29
    v_pk_fma_f32 v[62:63], v[62:63], v[56:57], v[58:59]
    v_cvt_pk_bf16_f32 v29, v62, v63
    v_lshlrev_b32 v64, 16, v30
    v_and_b32 v65, 0xffff0000, v30
    v_pk_fma_f32 v[64:65], v[64:65], v[56:57], v[58:59]
    v_cvt_pk_bf16_f32 v30, v64, v65
    v_lshlrev_b32 v66, 16, v31
    v_and_b32 v67, 0xffff0000, v31
    v_pk_fma_f32 v[66:67], v[66:67], v[56:57], v[58:59]
    v_cvt_pk_bf16_f32 v31, v66, v67
    v_lshlrev_b32 v60, 16, v32
    v_and_b32 v61, 0xffff0000, v32
    v_pk_fma_f32 v[60:61], v[60:61], v[56:57], v[58:59]
    v_cvt_pk_bf16_f32 v32, v60, v61
    v_lshlrev_b32 v62, 16, v33
    v_and_b32 v63, 0xffff0000, v33
    v_pk_fma_f32 v[62:63], v[62:63], v[56:57], v[58:59]
    v_cvt_pk_bf16_f32 v33, v62, v63
    v_lshlrev_b32 v64, 16, v34
    v_and_b32 v65, 0xffff0000, v34
    v_pk_fma_f32 v[64:65], v[64:65], v[56:57], v[58:59]
    v_cvt_pk_bf16_f32 v34, v64, v65
    v_lshlrev_b32 v66, 16, v35
    v_and_b32 v67, 0xffff0000, v35
    v_pk_fma_f32 v[66:67], v[66:67], v[56:57], v[58:59]
    v_cvt_pk_bf16_f32 v35, v66, v67
    v_lshlrev_b32 v60, 16, v36
    v_and_b32 v61, 0xffff0000, v36
    v_pk_fma_f32 v[60:61], v[60:61], v[56:57], v[58:59]
    v_cvt_pk_bf16_f32 v36, v60, v61
    v_lshlrev_b32 v62, 16, v37
    v_and_b32 v63, 0xffff0000, v37
    v_pk_fma_f32 v[62:63], v[62:63], v[56:57], v[58:59]
    v_cvt_pk_bf16_f32 v37, v62, v63
    v_lshlrev_b32 v64, 16, v38
    v_and_b32 v65, 0xffff0000, v38
    v_pk_fma_f32 v[64:65], v[64:65], v[56:57], v[58:59]
    v_cvt_pk_bf16_f32 v38, v64, v65
    v_lshlrev_b32 v66, 16, v39
    v_and_b32 v67, 0xffff0000, v39
    v_pk_fma_f32 v[66:67], v[66:67], v[56:57], v[58:59]
    v_cvt_pk_bf16_f32 v39, v66, v67
    v_lshlrev_b32 v60, 16, v40
    v_and_b32 v61, 0xffff0000, v40
    v_pk_fma_f32 v[60:61], v[60:61], v[56:57], v[58:59]
    v_cvt_pk_bf16_f32 v40, v60, v61
    v_lshlrev_b32 v62, 16, v41
    v_and_b32 v63, 0xffff0000, v41
    v_pk_fma_f32 v[62:63], v[62:63], v[56:57], v[58:59]
    v_cvt_pk_bf16_f32 v41, v62, v63
    v_lshlrev_b32 v64, 16, v42
    v_and_b32 v65, 0xffff0000, v42
    v_pk_fma_f32 v[64:65], v[64:65], v[56:57], v[58:59]
    v_cvt_pk_bf16_f32 v42, v64, v65
    v_lshlrev_b32 v66, 16, v43
    v_and_b32 v67, 0xffff0000, v43
    v_pk_fma_f32 v[66:67], v[66:67], v[56:57], v[58:59]
    v_cvt_pk_bf16_f32 v43, v66, v67
    ds_write_b64 v44, v[8:9] offset:0
    ds_write_b64 v45, v[10:11] offset:0
    ds_write_b64 v44, v[12:13] offset:128
    ds_write_b64 v45, v[14:15] offset:128
    ds_write_b64 v44, v[16:17] offset:256
    ds_write_b64 v45, v[18:19] offset:256
    ds_write_b64 v44, v[20:21] offset:384
    ds_write_b64 v45, v[22:23] offset:384
    ds_write_b64 v44, v[24:25] offset:512
    ds_write_b64 v45, v[26:27] offset:512
    ds_write_b64 v44, v[28:29] offset:640
    ds_write_b64 v45, v[30:31] offset:640
    ds_write_b64 v44, v[32:33] offset:768
    ds_write_b64 v45, v[34:35] offset:768
    ds_write_b64 v44, v[36:37] offset:896
    ds_write_b64 v45, v[38:39] offset:896
    ds_write_b64 v44, v[40:41] offset:1024
    ds_write_b64 v45, v[42:43] offset:1024
    v_mov_b32 v46, 1
    s_waitcnt lgkmcnt(0)
    ds_write_b32 v47, v46
LM_kvr_83:
    ds_read_b32 v49, v48
    s_waitcnt lgkmcnt(0)
    v_cmp_gt_u32 vcc, 1, v49
    s_nop 4
    s_cbranch_vccz LM_kvrd_84
    s_sleep 1
    s_branch LM_kvr_83
LM_kvrd_84:
    s_bitcmp1_b32 s5, 0
    s_cbranch_scc1 LM_kv_v_85
    ds_read_b64_tr_b16 v[80:81], v72 offset:0
    ds_read_b64_tr_b16 v[82:83], v72 offset:768
    ds_read_b128 v[84:87], v70 offset:0
    ds_read_b64_tr_b16 v[88:89], v72 offset:1536
    ds_read_b64_tr_b16 v[90:91], v72 offset:2304
    ds_read_b128 v[92:95], v71 offset:0
    ds_read_b64_tr_b16 v[96:97], v72 offset:3072
    ds_read_b64_tr_b16 v[98:99], v72 offset:3840
    ds_read_b128 v[100:103], v70 offset:128
    s_waitcnt lgkmcnt(6)
    v_mfma_f32_16x16x32_bf16 v[76:79], v[80:83], v[84:87], 0
    ds_read_b64_tr_b16 v[80:81], v72 offset:4608
    ds_read_b64_tr_b16 v[82:83], v72 offset:5376
    ds_read_b128 v[84:87], v71 offset:128
    s_waitcnt lgkmcnt(6)
    v_mfma_f32_16x16x32_bf16 v[76:79], v[88:91], v[92:95], v[76:79]
    ds_read_b64_tr_b16 v[88:89], v72 offset:6144
    ds_read_b64_tr_b16 v[90:91], v72 offset:6912
    ds_read_b128 v[92:95], v70 offset:256
    s_waitcnt lgkmcnt(6)
    v_mfma_f32_16x16x32_bf16 v[76:79], v[96:99], v[100:103], v[76:79]
    ds_read_b64_tr_b16 v[96:97], v72 offset:7680
    ds_read_b64_tr_b16 v[98:99], v72 offset:8448
    ds_read_b128 v[100:103], v71 offset:256
    s_waitcnt lgkmcnt(6)
    v_mfma_f32_16x16x32_bf16 v[76:79], v[80:83], v[84:87], v[76:79]
    ds_read_b64_tr_b16 v[80:81], v72 offset:9216
    ds_read_b64_tr_b16 v[82:83], v72 offset:9984
    ds_read_b128 v[84:87], v70 offset:384
    s_waitcnt lgkmcnt(6)
    v_mfma_f32_16x16x32_bf16 v[76:79], v[88:91], v[92:95], v[76:79]
    ds_read_b64_tr_b16 v[88:89], v72 offset:10752
    ds_read_b64_tr_b16 v[90:91], v72 offset:11520
    ds_read_b128 v[92:95], v71 offset:384
    s_waitcnt lgkmcnt(6)
    v_mfma_f32_16x16x32_bf16 v[76:79], v[96:99], v[100:103], v[76:79]
    ds_read_b64_tr_b16 v[96:97], v72 offset:12288
    ds_read_b64_tr_b16 v[98:99], v72 offset:13056
    ds_read_b128 v[100:103], v70 offset:512
    s_waitcnt lgkmcnt(6)
    v_mfma_f32_16x16x32_bf16 v[76:79], v[80:83], v[84:87], v[76:79]
    ds_read_b64_tr_b16 v[80:81], v72 offset:13824
    ds_read_b64_tr_b16 v[82:83], v72 offset:14592
    ds_read_b128 v[84:87], v71 offset:512
    s_waitcnt lgkmcnt(6)
    v_mfma_f32_16x16x32_bf16 v[76:79], v[88:91], v[92:95], v[76:79]
    ds_read_b64_tr_b16 v[88:89], v72 offset:15360
    ds_read_b64_tr_b16 v[90:91], v72 offset:16128
    ds_read_b128 v[92:95], v70 offset:640
    s_waitcnt lgkmcnt(6)
    v_mfma_f32_16x16x32_bf16 v[76:79], v[96:99], v[100:103], v[76:79]
    ds_read_b64_tr_b16 v[96:97], v72 offset:16896
    ds_read_b64_tr_b16 v[98:99], v72 offset:17664
    ds_read_b128 v[100:103], v71 offset:640
    s_waitcnt lgkmcnt(6)
    v_mfma_f32_16x16x32_bf16 v[76:79], v[80:83], v[84:87], v[76:79]
    ds_read_b64_tr_b16 v[80:81], v72 offset:18432
    ds_read_b64_tr_b16 v[82:83], v72 offset:19200
    ds_read_b128 v[84:87], v70 offset:768
    s_waitcnt lgkmcnt(6)
    v_mfma_f32_16x16x32_bf16 v[76:79], v[88:91], v[92:95], v[76:79]
    ds_read_b64_tr_b16 v[88:89], v72 offset:19968
    ds_read_b64_tr_b16 v[90:91], v72 offset:20736
    ds_read_b128 v[92:95], v71 offset:768
    s_waitcnt lgkmcnt(6)
    v_mfma_f32_16x16x32_bf16 v[76:79], v[96:99], v[100:103], v[76:79]
    ds_read_b64_tr_b16 v[96:97], v72 offset:21504
    ds_read_b64_tr_b16 v[98:99], v72 offset:22272
    ds_read_b128 v[100:103], v70 offset:896
    s_waitcnt lgkmcnt(6)
    v_mfma_f32_16x16x32_bf16 v[76:79], v[80:83], v[84:87], v[76:79]
    ds_read_b64_tr_b16 v[80:81], v72 offset:23040
    ds_read_b64_tr_b16 v[82:83], v72 offset:23808
    ds_read_b128 v[84:87], v71 offset:896
    s_waitcnt lgkmcnt(6)
    v_mfma_f32_16x16x32_bf16 v[76:79], v[88:91], v[92:95], v[76:79]
    ds_read_b64_tr_b16 v[88:89], v72 offset:24576
    ds_read_b64_tr_b16 v[90:91], v72 offset:25344
    ds_read_b128 v[92:95], v70 offset:1024
    s_waitcnt lgkmcnt(6)
    v_mfma_f32_16x16x32_bf16 v[76:79], v[96:99], v[100:103], v[76:79]
    ds_read_b64_tr_b16 v[96:97], v72 offset:26112
    ds_read_b64_tr_b16 v[98:99], v72 offset:26880
    ds_read_b128 v[100:103], v71 offset:1024
    s_waitcnt lgkmcnt(6)
    v_mfma_f32_16x16x32_bf16 v[76:79], v[80:83], v[84:87], v[76:79]
    s_waitcnt lgkmcnt(3)
    v_mfma_f32_16x16x32_bf16 v[76:79], v[88:91], v[92:95], v[76:79]
    s_waitcnt lgkmcnt(0)
    v_mfma_f32_16x16x32_bf16 v[76:79], v[96:99], v[100:103], v[76:79]
    s_branch LM_kv_j_86
LM_kv_v_85:
    ds_read_b64_tr_b16 v[80:81], v72 offset:0
    ds_read_b64_tr_b16 v[82:83], v72 offset:768
    ds_read_b128 v[84:87], v70 offset:0
    ds_read_b64_tr_b16 v[88:89], v72 offset:1536
    ds_read_b64_tr_b16 v[90:91], v72 offset:2304
    ds_read_b128 v[92:95], v71 offset:0
    ds_read_b64_tr_b16 v[96:97], v72 offset:3072
    ds_read_b64_tr_b16 v[98:99], v72 offset:3840
    ds_read_b128 v[100:103], v70 offset:128
    s_waitcnt lgkmcnt(6)
    v_mfma_f32_16x16x32_bf16 v[76:79], v[84:87], v[80:83], 0
    ds_read_b64_tr_b16 v[80:81], v72 offset:4608
    ds_read_b64_tr_b16 v[82:83], v72 offset:5376
    ds_read_b128 v[84:87], v71 offset:128
    s_waitcnt lgkmcnt(6)
    v_mfma_f32_16x16x32_bf16 v[76:79], v[92:95], v[88:91], v[76:79]
    ds_read_b64_tr_b16 v[88:89], v72 offset:6144
    ds_read_b64_tr_b16 v[90:91], v72 offset:6912
    ds_read_b128 v[92:95], v70 offset:256
    s_waitcnt lgkmcnt(6)
    v_mfma_f32_16x16x32_bf16 v[76:79], v[100:103], v[96:99], v[76:79]
    ds_read_b64_tr_b16 v[96:97], v72 offset:7680
    ds_read_b64_tr_b16 v[98:99], v72 offset:8448
    ds_read_b128 v[100:103], v71 offset:256
    s_waitcnt lgkmcnt(6)
    v_mfma_f32_16x16x32_bf16 v[76:79], v[84:87], v[80:83], v[76:79]
    ds_read_b64_tr_b16 v[80:81], v72 offset:9216
    ds_read_b64_tr_b16 v[82:83], v72 offset:9984
    ds_read_b128 v[84:87], v70 offset:384
    s_waitcnt lgkmcnt(6)
    v_mfma_f32_16x16x32_bf16 v[76:79], v[92:95], v[88:91], v[76:79]
    ds_read_b64_tr_b16 v[88:89], v72 offset:10752
    ds_read_b64_tr_b16 v[90:91], v72 offset:11520
    ds_read_b128 v[92:95], v71 offset:384
    s_waitcnt lgkmcnt(6)
    v_mfma_f32_16x16x32_bf16 v[76:79], v[100:103], v[96:99], v[76:79]
    ds_read_b64_tr_b16 v[96:97], v72 offset:12288
    ds_read_b64_tr_b16 v[98:99], v72 offset:13056
    ds_read_b128 v[100:103], v70 offset:512
    s_waitcnt lgkmcnt(6)
    v_mfma_f32_16x16x32_bf16 v[76:79], v[84:87], v[80:83], v[76:79]
    ds_read_b64_tr_b16 v[80:81], v72 offset:13824
    ds_read_b64_tr_b16 v[82:83], v72 offset:14592
    ds_read_b128 v[84:87], v71 offset:512
    s_waitcnt lgkmcnt(6)
    v_mfma_f32_16x16x32_bf16 v[76:79], v[92:95], v[88:91], v[76:79]
    ds_read_b64_tr_b16 v[88:89], v72 offset:15360
    ds_read_b64_tr_b16 v[90:91], v72 offset:16128
    ds_read_b128 v[92:95], v70 offset:640
    s_waitcnt lgkmcnt(6)
    v_mfma_f32_16x16x32_bf16 v[76:79], v[100:103], v[96:99], v[76:79]
    ds_read_b64_tr_b16 v[96:97], v72 offset:16896
    ds_read_b64_tr_b16 v[98:99], v72 offset:17664
    ds_read_b128 v[100:103], v71 offset:640
    s_waitcnt lgkmcnt(6)
    v_mfma_f32_16x16x32_bf16 v[76:79], v[84:87], v[80:83], v[76:79]
    ds_read_b64_tr_b16 v[80:81], v72 offset:18432
    ds_read_b64_tr_b16 v[82:83], v72 offset:19200
    ds_read_b128 v[84:87], v70 offset:768
    s_waitcnt lgkmcnt(6)
    v_mfma_f32_16x16x32_bf16 v[76:79], v[92:95], v[88:91], v[76:79]
    ds_read_b64_tr_b16 v[88:89], v72 offset:19968
    ds_read_b64_tr_b16 v[90:91], v72 offset:20736
    ds_read_b128 v[92:95], v71 offset:768
    s_waitcnt lgkmcnt(6)
    v_mfma_f32_16x16x32_bf16 v[76:79], v[100:103], v[96:99], v[76:79]
    ds_read_b64_tr_b16 v[96:97], v72 offset:21504
    ds_read_b64_tr_b16 v[98:99], v72 offset:22272
    ds_read_b128 v[100:103], v70 offset:896
    s_waitcnt lgkmcnt(6)
    v_mfma_f32_16x16x32_bf16 v[76:79], v[84:87], v[80:83], v[76:79]
    ds_read_b64_tr_b16 v[80:81], v72 offset:23040
    ds_read_b64_tr_b16 v[82:83], v72 offset:23808
    ds_read_b128 v[84:87], v71 offset:896
    s_waitcnt lgkmcnt(6)
    v_mfma_f32_16x16x32_bf16 v[76:79], v[92:95], v[88:91], v[76:79]
    ds_read_b64_tr_b16 v[88:89], v72 offset:24576
    ds_read_b64_tr_b16 v[90:91], v72 offset:25344
    ds_read_b128 v[92:95], v70 offset:1024
    s_waitcnt lgkmcnt(6)
    v_mfma_f32_16x16x32_bf16 v[76:79], v[100:103], v[96:99], v[76:79]
    ds_read_b64_tr_b16 v[96:97], v72 offset:26112
    ds_read_b64_tr_b16 v[98:99], v72 offset:26880
    ds_read_b128 v[100:103], v71 offset:1024
    s_waitcnt lgkmcnt(6)
    v_mfma_f32_16x16x32_bf16 v[76:79], v[84:87], v[80:83], v[76:79]
    s_waitcnt lgkmcnt(3)
    v_mfma_f32_16x16x32_bf16 v[76:79], v[92:95], v[88:91], v[76:79]
    s_waitcnt lgkmcnt(0)
    v_mfma_f32_16x16x32_bf16 v[76:79], v[100:103], v[96:99], v[76:79]
LM_kv_j_86:
    v_mov_b32 v46, 2
    ds_write_b32 v47, v46
    s_lshl_b32 s9, s4, 1
    s_lshr_b32 s10, s13, 1
    s_add_u32 s9, s9, s10
    s_mul_i32 s9, s9, 2432
    s_add_u32 s9, s9, 0
    s_and_b32 s12, s13, 1
    s_nop 4
    v_cvt_pk_bf16_f32 v76, v76, v77
    v_cvt_pk_bf16_f32 v77, v78, v79
    s_bitcmp1_b32 s5, 0
    s_cbranch_scc1 LM_kvp_88
    s_lshl_b32 s10, s12, 4
    v_add_u32 v7, s10, v5
    s_cmp_lg_u32 s7, 0
    s_cbranch_scc1 LM_kvp_87
    v_lshrrev_b32 v2, 1, v6
    v_lshl_add_u32 v7, v2, 5, v7
    v_lshlrev_b32 v7, 4, v7
    v_and_b32 v2, 1, v6
    v_lshl_add_u32 v7, v2, 3, v7
    buffer_store_dwordx2 v[76:77], v7, s[68:71], s9 offen sc1
    s_branch LM_kvp_90
LM_kvp_87:
    v_lshlrev_b32 v7, 2, v7
    s_mov_b64 exec, 0xffff
    buffer_store_dword v77, v7, s[68:71], s9 offen offset:1024 sc1
    s_mov_b64 exec, -1
    s_branch LM_kvp_90
LM_kvp_88:
    s_mul_i32 s10, s12, 640
    s_add_u32 s9, s9, s10
    v_and_b32 v2, 1, v6
    v_mul_u32_u24 v7, 320, v2
    v_lshl_add_u32 v7, v5, 4, v7
    v_lshrrev_b32 v2, 1, v6
    v_lshl_add_u32 v7, v2, 3, v7
    s_cmp_lg_u32 s7, 0
    s_cbranch_scc1 LM_kvp_89
    buffer_store_dwordx2 v[76:77], v7, s[68:71], s9 offen offset:1152 sc1
    s_branch LM_kvp_90
LM_kvp_89:
    v_mov_b32 v2, 0x3f803f80
    v_cmp_eq_u32 vcc, 4, v5
    s_nop 1
    v_cndmask_b32 v76, v76, v2, vcc
    v_cndmask_b32 v77, v77, v2, vcc
    v_cmp_eq_u32 vcc, 5, v5
    s_nop 1
    v_cndmask_b32 v76, v76, 0, vcc
    v_cndmask_b32 v77, v77, 0, vcc
    s_mov_b32 exec_lo, 0x003c003c
    s_mov_b32 exec_hi, 0x003c003c
    buffer_store_dwordx2 v[76:77], v7, s[68:71], s9 offen offset:1376 sc1
    s_mov_b64 exec, -1
LM_kvp_90:
    s_and_b32 s9, s5, 1
    s_add_u32 s9, s9, s7
    s_cmp_lg_u32 s9, 0
    s_cbranch_scc1 LM_kvz_91
    s_lshl_b32 s9, s4, 2
    s_lshr_b32 s10, s5, 1
    s_add_u32 s9, s9, s10
    s_lshl_b32 s9, s9, 7
    s_add_u32 s9, s9, 524288
    v_mov_b32 v2, 0
    v_lshlrev_b32 v3, 2, v1
    s_mov_b64 exec, 0xff
    buffer_store_dword v2, v3, s[68:71], s9 offen sc1
    s_mov_b64 exec, -1
LM_kvz_91:
    s_waitcnt vmcnt(0)
    s_cmp_lg_u32 s7, 0
    s_cbranch_scc1 LM_arr1_92
    v_mov_b32 v48, 163780
LM_arr_94:
    ds_read_b32 v49, v48
    s_waitcnt lgkmcnt(0)
    v_cmp_gt_u32 vcc, 3, v49
    s_nop 4
    s_cbranch_vccz LM_arrd_95
    s_sleep 1
    s_branch LM_arr_94
LM_arrd_95:
    s_mov_b32 s12, s38
    s_and_b32 s13, s39, 0xffff
    s_mov_b32 s14, 256
    s_mov_b32 s15, 0x00020000
    s_and_b32 s9, s2, 15
    s_lshl_b32 s9, s9, 4
    v_mov_b32 v3, s9
    v_mov_b32 v4, 1
    s_mov_b64 exec, 1
    buffer_atomic_add v4, v3, s[12:15], 0 offen sc1
    s_branch LM_arrd_93
    s_and_b32 s9, s2, 7
    s_mul_i32 s9, s9, 16
    v_mov_b32 v3, s9
    v_mov_b32 v4, 1
    s_mov_b64 exec, 1
    buffer_atomic_add v4, v3, s[12:15], 0 offen sc0 sc1
    s_waitcnt vmcnt(0)
    v_readfirstlane_b32 s9, v4
    s_cmp_lg_u32 s9, 31
    s_cbranch_scc1 LM_arrd_93
    v_mov_b32 v4, 1
    v_mov_b32 v3, 0
    buffer_atomic_add v4, v3, s[12:15], 0 offen offset:4 sc0 sc1
    s_waitcnt vmcnt(0)
    v_readfirstlane_b32 s9, v4
    s_cmp_lg_u32 s9, 7
    s_cbranch_scc1 LM_arrd_93
    v_mov_b32 v4, 1
    buffer_store_dword v4, v3, s[12:15], 0 offen offset:128 sc1
    s_branch LM_arrd_93
LM_arr1_92:
    v_mov_b32 v46, 3
    ds_write_b32 v47, v46
LM_arrd_93:
    s_mov_b64 exec, -1
    s_branch LM_fjoin_82
LM_fstage_81:
    s_bitcmp1_b32 s5, 0
    s_cselect_b32 s72, s22, s20
    s_cselect_b32 s73, s23, s21
    s_and_b32 s73, s73, 0xffff
    s_mov_b32 s74, 20736
    s_mov_b32 s75, 0x00020000
    v_add_u32 v5, 0, v1
    v_mul_u32_u24 v6, 21846, v5
    v_lshrrev_b32 v6, 16, v6
    v_mul_u32_u24 v7, 3, v6
    v_sub_u32 v7, v5, v7
    v_lshlrev_b32 v7, 4, v7
    v_min_u32 v7, 20, v7
    v_mad_u32_u24 v44, v6, 36, v7
    v_add_u32 v5, 64, v1
    v_mul_u32_u24 v6, 21846, v5
    v_lshrrev_b32 v6, 16, v6
    v_mul_u32_u24 v7, 3, v6
    v_sub_u32 v7, v5, v7
    v_lshlrev_b32 v7, 4, v7
    v_min_u32 v7, 20, v7
    v_mad_u32_u24 v45, v6, 36, v7
    v_add_u32 v5, 128, v1
    v_mul_u32_u24 v6, 21846, v5
    v_lshrrev_b32 v6, 16, v6
    v_mul_u32_u24 v7, 3, v6
    v_sub_u32 v7, v5, v7
    v_lshlrev_b32 v7, 4, v7
    v_min_u32 v7, 20, v7
    v_mad_u32_u24 v46, v6, 36, v7
    s_lshr_b32 s13, s5, 1
    s_cmp_lt_u32 s13, 2
    s_cselect_b32 s12, 36864, 0
    s_and_b32 s11, s7, 1
    s_add_u32 s14, s11, 0
    s_mul_i32 s9, s14, 2304
    s_mul_i32 s10, s14, 3072
    s_add_u32 s10, s10, s12
    s_add_u32 m0, s10, 0
    s_nop 0
    buffer_load_dwordx4 v44, s[72:75], s9 offen lds
    s_add_u32 m0, s10, 1024
    s_nop 0
    buffer_load_dwordx4 v45, s[72:75], s9 offen lds
    s_add_u32 m0, s10, 2048
    s_nop 0
    buffer_load_dwordx4 v46, s[72:75], s9 offen lds
LM_kws_96:
    s_add_u32 s14, s11, 2
    s_mul_i32 s9, s14, 2304
    s_mul_i32 s10, s14, 3072
    s_add_u32 s10, s10, s12
    s_add_u32 m0, s10, 0
    s_nop 0
    buffer_load_dwordx4 v44, s[72:75], s9 offen lds
    s_add_u32 m0, s10, 1024
    s_nop 0
    buffer_load_dwordx4 v45, s[72:75], s9 offen lds
    s_add_u32 m0, s10, 2048
    s_nop 0
    buffer_load_dwordx4 v46, s[72:75], s9 offen lds
LM_kws_97:
    s_add_u32 s14, s11, 4
    s_mul_i32 s9, s14, 2304
    s_mul_i32 s10, s14, 3072
    s_add_u32 s10, s10, s12
    s_add_u32 m0, s10, 0
    s_nop 0
    buffer_load_dwordx4 v44, s[72:75], s9 offen lds
    s_add_u32 m0, s10, 1024
    s_nop 0
    buffer_load_dwordx4 v45, s[72:75], s9 offen lds
    s_add_u32 m0, s10, 2048
    s_nop 0
    buffer_load_dwordx4 v46, s[72:75], s9 offen lds
LM_kws_98:
    s_add_u32 s14, s11, 6
    s_mul_i32 s9, s14, 2304
    s_mul_i32 s10, s14, 3072
    s_add_u32 s10, s10, s12
    s_add_u32 m0, s10, 0
    s_nop 0
    buffer_load_dwordx4 v44, s[72:75], s9 offen lds
    s_add_u32 m0, s10, 1024
    s_nop 0
    buffer_load_dwordx4 v45, s[72:75], s9 offen lds
    s_add_u32 m0, s10, 2048
    s_nop 0
    buffer_load_dwordx4 v46, s[72:75], s9 offen lds
LM_kws_99:
    s_cmp_lg_u32 s11, 0
    s_cbranch_scc1 LM_kws_100
    s_add_u32 s14, s11, 8
    s_mul_i32 s9, s14, 2304
    s_mul_i32 s10, s14, 3072
    s_add_u32 s10, s10, s12
    s_add_u32 m0, s10, 0
    s_nop 0
    buffer_load_dwordx4 v44, s[72:75], s9 offen lds
    s_add_u32 m0, s10, 1024
    s_nop 0
    buffer_load_dwordx4 v45, s[72:75], s9 offen lds
    s_add_u32 m0, s10, 2048
    s_nop 0
    buffer_load_dwordx4 v46, s[72:75], s9 offen lds
LM_kws_100:
    v_add_u32 v5, 0, v1
    v_mul_u32_u24 v6, 7282, v5
    v_lshrrev_b32 v6, 16, v6
    v_mul_u32_u24 v7, 9, v6
    v_sub_u32 v7, v5, v7
    v_mul_u32_u24 v6, 1152, v6
    v_lshl_add_u32 v50, v7, 4, v6
    v_add_u32 v5, 64, v1
    v_mul_u32_u24 v6, 7282, v5
    v_lshrrev_b32 v6, 16, v6
    v_mul_u32_u24 v7, 9, v6
    v_sub_u32 v7, v5, v7
    v_mul_u32_u24 v6, 1152, v6
    v_lshl_add_u32 v51, v7, 4, v6
    v_subrev_u32 v51, 1024, v51
    v_add_u32 v5, 128, v1
    v_mul_u32_u24 v6, 7282, v5
    v_lshrrev_b32 v6, 16, v6
    v_mul_u32_u24 v7, 9, v6
    v_sub_u32 v7, v5, v7
    v_mul_u32_u24 v6, 1152, v6
    v_lshl_add_u32 v52, v7, 4, v6
    v_subrev_u32 v52, 2048, v52
    v_add_u32 v5, 192, v1
    v_mul_u32_u24 v6, 7282, v5
    v_lshrrev_b32 v6, 16, v6
    v_mul_u32_u24 v7, 9, v6
    v_sub_u32 v7, v5, v7
    v_mul_u32_u24 v6, 1152, v6
    v_lshl_add_u32 v53, v7, 4, v6
    v_subrev_u32 v53, 3072, v53
    v_add_u32 v5, 256, v1
    v_mul_u32_u24 v6, 7282, v5
    v_lshrrev_b32 v6, 16, v6
    v_mul_u32_u24 v7, 9, v6
    v_sub_u32 v7, v5, v7
    v_mul_u32_u24 v6, 1152, v6
    v_lshl_add_u32 v54, v7, 4, v6
    v_add_u32 v5, 320, v1
    v_mul_u32_u24 v6, 7282, v5
    v_lshrrev_b32 v6, 16, v6
    v_mul_u32_u24 v7, 9, v6
    v_sub_u32 v7, v5, v7
    v_mul_u32_u24 v6, 1152, v6
    v_lshl_add_u32 v55, v7, 4, v6
    v_subrev_u32 v55, 1024, v55
    v_add_u32 v5, 384, v1
    v_mul_u32_u24 v6, 7282, v5
    v_lshrrev_b32 v6, 16, v6
    v_mul_u32_u24 v7, 9, v6
    v_sub_u32 v7, v5, v7
    v_mul_u32_u24 v6, 1152, v6
    v_lshl_add_u32 v56, v7, 4, v6
    v_subrev_u32 v56, 2048, v56
    v_add_u32 v5, 448, v1
    v_mul_u32_u24 v6, 7282, v5
    v_lshrrev_b32 v6, 16, v6
    v_mul_u32_u24 v7, 9, v6
    v_sub_u32 v7, v5, v7
    v_mul_u32_u24 v6, 1152, v6
    v_lshl_add_u32 v57, v7, 4, v6
    v_subrev_u32 v57, 3072, v57
    v_add_u32 v5, 512, v1
    v_mul_u32_u24 v6, 7282, v5
    v_lshrrev_b32 v6, 16, v6
    v_mul_u32_u24 v7, 9, v6
    v_sub_u32 v7, v5, v7
    v_mul_u32_u24 v6, 1152, v6
    v_lshl_add_u32 v58, v7, 4, v6
    s_lshl_b32 s9, s7, 2
    s_add_u32 s9, s9, 163776
    v_mov_b32 v47, s9
    v_mov_b32 v46, 2
    s_mul_i32 s12, s5, 144
    s_waitcnt vmcnt(0)
    ds_write_b32 v47, v46
    s_add_u32 s14, s11, 0
    s_mul_i32 s9, s14, 73728
    s_add_u32 s9, s9, s12
    s_add_u32 s10, s14, 8
    s_cmp_ge_u32 s10, 9
    s_cselect_b32 s13, 9, 0
    s_sub_u32 s10, s10, s13
    s_mul_i32 s10, s10, 9216
    s_add_u32 s10, s10, 73728
    s_add_u32 m0, s10, 0
    s_nop 0
    buffer_load_dwordx4 v50, s[48:51], s9 offen offset:0 lds
    buffer_load_dwordx4 v51, s[48:51], s9 offen offset:1024 lds
    buffer_load_dwordx4 v52, s[48:51], s9 offen offset:2048 lds
    buffer_load_dwordx4 v53, s[48:51], s9 offen offset:3072 lds
    s_add_u32 m0, s10, 4096
    s_nop 0
    buffer_load_dwordx4 v54, s[48:51], s9 offen offset:0 lds
    buffer_load_dwordx4 v55, s[48:51], s9 offen offset:1024 lds
    buffer_load_dwordx4 v56, s[48:51], s9 offen offset:2048 lds
    buffer_load_dwordx4 v57, s[48:51], s9 offen offset:3072 lds
    s_add_u32 m0, s10, 8192
    s_nop 0
    buffer_load_dwordx4 v58, s[48:51], s9 offen offset:0 lds
LM_qs_101:
    s_add_u32 s14, s11, 2
    s_mul_i32 s9, s14, 73728
    s_add_u32 s9, s9, s12
    s_add_u32 s10, s14, 8
    s_cmp_ge_u32 s10, 9
    s_cselect_b32 s13, 9, 0
    s_sub_u32 s10, s10, s13
    s_mul_i32 s10, s10, 9216
    s_add_u32 s10, s10, 73728
    s_add_u32 m0, s10, 0
    s_nop 0
    buffer_load_dwordx4 v50, s[48:51], s9 offen offset:0 lds
    buffer_load_dwordx4 v51, s[48:51], s9 offen offset:1024 lds
    buffer_load_dwordx4 v52, s[48:51], s9 offen offset:2048 lds
    buffer_load_dwordx4 v53, s[48:51], s9 offen offset:3072 lds
    s_add_u32 m0, s10, 4096
    s_nop 0
    buffer_load_dwordx4 v54, s[48:51], s9 offen offset:0 lds
    buffer_load_dwordx4 v55, s[48:51], s9 offen offset:1024 lds
    buffer_load_dwordx4 v56, s[48:51], s9 offen offset:2048 lds
    buffer_load_dwordx4 v57, s[48:51], s9 offen offset:3072 lds
    s_add_u32 m0, s10, 8192
    s_nop 0
    buffer_load_dwordx4 v58, s[48:51], s9 offen offset:0 lds
LM_qs_102:
    s_add_u32 s14, s11, 4
    s_mul_i32 s9, s14, 73728
    s_add_u32 s9, s9, s12
    s_add_u32 s10, s14, 8
    s_cmp_ge_u32 s10, 9
    s_cselect_b32 s13, 9, 0
    s_sub_u32 s10, s10, s13
    s_mul_i32 s10, s10, 9216
    s_add_u32 s10, s10, 73728
    s_add_u32 m0, s10, 0
    s_nop 0
    buffer_load_dwordx4 v50, s[48:51], s9 offen offset:0 lds
    buffer_load_dwordx4 v51, s[48:51], s9 offen offset:1024 lds
    buffer_load_dwordx4 v52, s[48:51], s9 offen offset:2048 lds
    buffer_load_dwordx4 v53, s[48:51], s9 offen offset:3072 lds
    s_add_u32 m0, s10, 4096
    s_nop 0
    buffer_load_dwordx4 v54, s[48:51], s9 offen offset:0 lds
    buffer_load_dwordx4 v55, s[48:51], s9 offen offset:1024 lds
    buffer_load_dwordx4 v56, s[48:51], s9 offen offset:2048 lds
    buffer_load_dwordx4 v57, s[48:51], s9 offen offset:3072 lds
    s_add_u32 m0, s10, 8192
    s_nop 0
    buffer_load_dwordx4 v58, s[48:51], s9 offen offset:0 lds
LM_qs_103:
    s_add_u32 s14, s11, 6
    s_mul_i32 s9, s14, 73728
    s_add_u32 s9, s9, s12
    s_add_u32 s10, s14, 8
    s_cmp_ge_u32 s10, 9
    s_cselect_b32 s13, 9, 0
    s_sub_u32 s10, s10, s13
    s_mul_i32 s10, s10, 9216
    s_add_u32 s10, s10, 73728
    s_add_u32 m0, s10, 0
    s_nop 0
    buffer_load_dwordx4 v50, s[48:51], s9 offen offset:0 lds
    buffer_load_dwordx4 v51, s[48:51], s9 offen offset:1024 lds
    buffer_load_dwordx4 v52, s[48:51], s9 offen offset:2048 lds
    buffer_load_dwordx4 v53, s[48:51], s9 offen offset:3072 lds
    s_add_u32 m0, s10, 4096
    s_nop 0
    buffer_load_dwordx4 v54, s[48:51], s9 offen offset:0 lds
    buffer_load_dwordx4 v55, s[48:51], s9 offen offset:1024 lds
    buffer_load_dwordx4 v56, s[48:51], s9 offen offset:2048 lds
    buffer_load_dwordx4 v57, s[48:51], s9 offen offset:3072 lds
    s_add_u32 m0, s10, 8192
    s_nop 0
    buffer_load_dwordx4 v58, s[48:51], s9 offen offset:0 lds
LM_qs_104:
    s_cmp_lg_u32 s11, 0
    s_cbranch_scc1 LM_qs_105
    s_add_u32 s14, s11, 8
    s_mul_i32 s9, s14, 73728
    s_add_u32 s9, s9, s12
    s_add_u32 s10, s14, 8
    s_cmp_ge_u32 s10, 9
    s_cselect_b32 s13, 9, 0
    s_sub_u32 s10, s10, s13
    s_mul_i32 s10, s10, 9216
    s_add_u32 s10, s10, 73728
    s_add_u32 m0, s10, 0
    s_nop 0
    buffer_load_dwordx4 v50, s[48:51], s9 offen offset:0 lds
    buffer_load_dwordx4 v51, s[48:51], s9 offen offset:1024 lds
    buffer_load_dwordx4 v52, s[48:51], s9 offen offset:2048 lds
    buffer_load_dwordx4 v53, s[48:51], s9 offen offset:3072 lds
    s_add_u32 m0, s10, 4096
    s_nop 0
    buffer_load_dwordx4 v54, s[48:51], s9 offen offset:0 lds
    buffer_load_dwordx4 v55, s[48:51], s9 offen offset:1024 lds
    buffer_load_dwordx4 v56, s[48:51], s9 offen offset:2048 lds
    buffer_load_dwordx4 v57, s[48:51], s9 offen offset:3072 lds
    s_add_u32 m0, s10, 8192
    s_nop 0
    buffer_load_dwordx4 v58, s[48:51], s9 offen offset:0 lds
LM_qs_105:
LM_fjoin_82:
    s_setprio 0
    s_mov_b32 s60, s24
    s_and_b32 s61, s25, 0xffff
    s_mov_b32 s62, 663552
    s_mov_b32 s63, 0x00020000
    s_mov_b32 s52, s28
    s_and_b32 s53, s29, 0xffff
    s_mov_b32 s54, 5308416
    s_mov_b32 s55, 0x00020000
    s_mov_b32 s56, s32
    s_and_b32 s57, s33, 0xffff
    s_mov_b32 s58, 5308416
    s_mov_b32 s59, 0x00020000
    s_mov_b32 s64, s30
    s_and_b32 s65, s31, 0xffff
    s_mov_b32 s66, 9216
    s_mov_b32 s67, 0x00020000
    s_mul_i32 s9, s7, 288
    s_mul_i32 s10, s5, 1152
    s_add_u32 s9, s9, s10
    v_lshrrev_b32 v5, 4, v1
    v_lshlrev_b32 v5, 3, v5
    buffer_load_dwordx2 v[160:161], v5, s[64:67], s9 offen offset:0
    buffer_load_dwordx2 v[162:163], v5, s[64:67], s9 offen offset:32
    buffer_load_dwordx2 v[164:165], v5, s[64:67], s9 offen offset:64
    buffer_load_dwordx2 v[166:167], v5, s[64:67], s9 offen offset:96
    buffer_load_dwordx2 v[168:169], v5, s[64:67], s9 offen offset:128
    buffer_load_dwordx2 v[170:171], v5, s[64:67], s9 offen offset:160
    buffer_load_dwordx2 v[172:173], v5, s[64:67], s9 offen offset:192
    buffer_load_dwordx2 v[174:175], v5, s[64:67], s9 offen offset:224
    buffer_load_dwordx2 v[176:177], v5, s[64:67], s9 offen offset:256
    v_min_u32 v5, 53, v1
    v_mul_u32_u24 v6, 7282, v5
    v_lshrrev_b32 v6, 16, v6
    v_mul_u32_u24 v7, 9, v6
    v_sub_u32 v7, v5, v7
    s_mov_b32 s10, 294912
    v_mul_lo_u32 v6, v6, s10
    v_lshl_add_u32 v5, v7, 7, v6
    s_min_u32 s9, s7, 2
    s_mul_i32 s9, s9, 192
    s_add_u32 s9, s9, s4
    s_mul_i32 s9, s9, 9216
    s_mul_i32 s10, s5, 1152
    s_add_u32 s9, s9, s10
    buffer_load_dword v251, v5, s[52:55], s9 offen
    s_xor_b32 s11, s4, 16
    s_sub_u32 s11, s11, s4
    s_mul_i32 s11, s11, 9216
    s_add_u32 s9, s9, s11
    buffer_load_dword v251, v5, s[52:55], s9 offen
    v_add_u32 v5, 0, v1
    v_mul_u32_u24 v6, 3641, v5
    v_lshrrev_b32 v6, 16, v6
    v_mul_u32_u24 v7, 18, v6
    v_sub_u32 v7, v5, v7
    v_lshlrev_b32 v7, 4, v7
    v_mul_u32_u24 v5, 9216, v6
    v_add_u32 v216, v5, v7
    v_mul_u32_u24 v5, 1152, v6
    v_add_u32 v225, v5, v7
    v_add_u32 v5, 64, v1
    v_mul_u32_u24 v6, 3641, v5
    v_lshrrev_b32 v6, 16, v6
    v_mul_u32_u24 v7, 18, v6
    v_sub_u32 v7, v5, v7
    v_lshlrev_b32 v7, 4, v7
    v_subrev_u32 v7, 1024, v7
    v_mul_u32_u24 v5, 9216, v6
    v_add_u32 v217, v5, v7
    v_mul_u32_u24 v5, 1152, v6
    v_add_u32 v226, v5, v7
    v_add_u32 v5, 128, v1
    v_mul_u32_u24 v6, 3641, v5
    v_lshrrev_b32 v6, 16, v6
    v_mul_u32_u24 v7, 18, v6
    v_sub_u32 v7, v5, v7
    v_lshlrev_b32 v7, 4, v7
    v_subrev_u32 v7, 2048, v7
    v_mul_u32_u24 v5, 9216, v6
    v_add_u32 v218, v5, v7
    v_mul_u32_u24 v5, 1152, v6
    v_add_u32 v227, v5, v7
    v_add_u32 v5, 192, v1
    v_mul_u32_u24 v6, 3641, v5
    v_lshrrev_b32 v6, 16, v6
    v_mul_u32_u24 v7, 18, v6
    v_sub_u32 v7, v5, v7
    v_lshlrev_b32 v7, 4, v7
    v_subrev_u32 v7, 3072, v7
    v_mul_u32_u24 v5, 9216, v6
    v_add_u32 v219, v5, v7
    v_mul_u32_u24 v5, 1152, v6
    v_add_u32 v228, v5, v7
    v_add_u32 v5, 256, v1
    v_mul_u32_u24 v6, 3641, v5
    v_lshrrev_b32 v6, 16, v6
    v_mul_u32_u24 v7, 18, v6
    v_sub_u32 v7, v5, v7
    v_lshlrev_b32 v7, 4, v7
    v_mul_u32_u24 v5, 9216, v6
    v_add_u32 v220, v5, v7
    v_mul_u32_u24 v5, 1152, v6
    v_add_u32 v229, v5, v7
    v_add_u32 v5, 320, v1
    v_mul_u32_u24 v6, 3641, v5
    v_lshrrev_b32 v6, 16, v6
    v_mul_u32_u24 v7, 18, v6
    v_sub_u32 v7, v5, v7
    v_lshlrev_b32 v7, 4, v7
    v_subrev_u32 v7, 1024, v7
    v_mul_u32_u24 v5, 9216, v6
    v_add_u32 v221, v5, v7
    v_mul_u32_u24 v5, 1152, v6
    v_add_u32 v230, v5, v7
    v_add_u32 v5, 384, v1
    v_mul_u32_u24 v6, 3641, v5
    v_lshrrev_b32 v6, 16, v6
    v_mul_u32_u24 v7, 18, v6
    v_sub_u32 v7, v5, v7
    v_lshlrev_b32 v7, 4, v7
    v_subrev_u32 v7, 2048, v7
    v_mul_u32_u24 v5, 9216, v6
    v_add_u32 v222, v5, v7
    v_mul_u32_u24 v5, 1152, v6
    v_add_u32 v231, v5, v7
    v_add_u32 v5, 448, v1
    v_mul_u32_u24 v6, 3641, v5
    v_lshrrev_b32 v6, 16, v6
    v_mul_u32_u24 v7, 18, v6
    v_sub_u32 v7, v5, v7
    v_lshlrev_b32 v7, 4, v7
    v_subrev_u32 v7, 3072, v7
    v_mul_u32_u24 v5, 9216, v6
    v_add_u32 v223, v5, v7
    v_mul_u32_u24 v5, 1152, v6
    v_add_u32 v232, v5, v7
    v_add_u32 v5, 512, v1
    v_mul_u32_u24 v6, 3641, v5
    v_lshrrev_b32 v6, 16, v6
    v_mul_u32_u24 v7, 18, v6
    v_sub_u32 v7, v5, v7
    v_lshlrev_b32 v7, 4, v7
    v_mul_u32_u24 v5, 9216, v6
    v_add_u32 v224, v5, v7
    v_mul_u32_u24 v5, 1152, v6
    v_add_u32 v233, v5, v7
    s_mul_i32 s84, s7, 18432
    s_add_u32 s84, s84, 73728
    s_mul_i32 s9, s7, 288
    s_mul_i32 s85, s5, 1152
    s_add_u32 s85, s85, s9
    s_mul_i32 s86, s5, 663552
    s_add_u32 s86, s86, s9
    s_mul_i32 s87, s5, 82944
    s_add_u32 s87, s87, s9
    v_and_b32 v2, 15, v1
    v_lshrrev_b32 v3, 4, v1
    v_bfe_u32 v4, v2, 1, 3
    v_xor_b32 v5, v4, v3
    v_mul_u32_u24 v6, 1152, v2
    v_lshl_add_u32 v234, v5, 4, v6
    v_xor_b32 v5, 4, v5
    v_lshl_add_u32 v235, v5, 4, v6
    v_mul_u32_u24 v5, 224, v2
    v_lshl_add_u32 v5, v3, 4, v5
    v_add_u32 v237, 147456, v5
    v_lshrrev_b32 v5, 2, v1
    v_mul_u32_u24 v5, 288, v5
    v_and_b32 v7, 3, v1
    v_lshl_add_u32 v5, v7, 3, v5
    v_add_u32 v236, s84, v5
    v_lshlrev_b32 v5, 2, v7
    v_add_u32 v238, 163728, v5
    s_lshl_b32 s9, s7, 2
    s_add_u32 s9, s9, 163728
    v_mov_b32 v239, s9
    s_mul_i32 s9, s7, 9
    s_add_u32 s9, s9, 0
    s_lshr_b32 s10, s9, 2
    s_lshl_b32 s10, s10, 7
    s_and_b32 s11, s9, 1
    s_lshl_b32 s11, s11, 3
    s_add_u32 s10, s10, s11
    s_and_b32 s11, s9, 2
    s_lshl_b32 s11, s11, 1
    v_xor_b32 v5, v4, v3
    v_xor_b32 v5, s11, v5
    v_lshl_add_u32 v5, v5, 4, v6
    v_add_u32 v240, s10, v5
    s_mul_i32 s9, s7, 9
    s_add_u32 s9, s9, 1
    s_lshr_b32 s10, s9, 2
    s_lshl_b32 s10, s10, 7
    s_and_b32 s11, s9, 1
    s_lshl_b32 s11, s11, 3
    s_add_u32 s10, s10, s11
    s_and_b32 s11, s9, 2
    s_lshl_b32 s11, s11, 1
    v_xor_b32 v5, v4, v3
    v_xor_b32 v5, s11, v5
    v_lshl_add_u32 v5, v5, 4, v6
    v_add_u32 v241, s10, v5
    s_mul_i32 s9, s7, 9
    s_add_u32 s9, s9, 2
    s_lshr_b32 s10, s9, 2
    s_lshl_b32 s10, s10, 7
    s_and_b32 s11, s9, 1
    s_lshl_b32 s11, s11, 3
    s_add_u32 s10, s10, s11
    s_and_b32 s11, s9, 2
    s_lshl_b32 s11, s11, 1
    v_xor_b32 v5, v4, v3
    v_xor_b32 v5, s11, v5
    v_lshl_add_u32 v5, v5, 4, v6
    v_add_u32 v242, s10, v5
    s_mul_i32 s9, s7, 9
    s_add_u32 s9, s9, 3
    s_lshr_b32 s10, s9, 2
    s_lshl_b32 s10, s10, 7
    s_and_b32 s11, s9, 1
    s_lshl_b32 s11, s11, 3
    s_add_u32 s10, s10, s11
    s_and_b32 s11, s9, 2
    s_lshl_b32 s11, s11, 1
    v_xor_b32 v5, v4, v3
    v_xor_b32 v5, s11, v5
    v_lshl_add_u32 v5, v5, 4, v6
    v_add_u32 v243, s10, v5
    s_cmp_lt_u32 s7, 2
    s_cbranch_scc1 LM_fnw_106
    s_lshl_b32 s9, s7, 2
    s_add_u32 s9, s9, 163776
    v_mov_b32 v5, s9
    v_mov_b32 v6, 4
    s_waitcnt vmcnt(11)
    ds_write_b32 v5, v6
LM_fnw_106:
    v_and_b32 v5, 3, v1
    v_lshlrev_b32 v5, 2, v5
    v_add_u32 v5, 163712, v5
LM_ring_107:
    ds_read_b32 v6, v5
    s_waitcnt lgkmcnt(0)
    v_cmp_gt_u32 vcc, 1, v6
    s_nop 4
    s_cbranch_vccz LM_ringd_108
    s_sleep 1
    s_branch LM_ring_107
LM_ringd_108:
    s_add_u32 s88, s85, 0
    s_add_u32 m0, s84, 0
    s_nop 0
    buffer_load_dwordx4 v216, s[52:55], s88 offen offset:0 lds
    buffer_load_dwordx4 v217, s[52:55], s88 offen offset:1024 lds
    buffer_load_dwordx4 v218, s[52:55], s88 offen offset:2048 lds
    buffer_load_dwordx4 v219, s[52:55], s88 offen offset:3072 lds
    s_add_u32 m0, s84, 4096
    s_nop 0
    buffer_load_dwordx4 v220, s[52:55], s88 offen offset:0 lds
    buffer_load_dwordx4 v221, s[52:55], s88 offen offset:1024 lds
    buffer_load_dwordx4 v222, s[52:55], s88 offen offset:2048 lds
    buffer_load_dwordx4 v223, s[52:55], s88 offen offset:3072 lds
    s_add_u32 m0, s84, 8192
    s_nop 0
    buffer_load_dwordx4 v224, s[52:55], s88 offen offset:0 lds
    s_add_u32 s88, s85, 294912
    s_add_u32 m0, s84, 9216
    s_nop 0
    buffer_load_dwordx4 v216, s[52:55], s88 offen offset:0 lds
    buffer_load_dwordx4 v217, s[52:55], s88 offen offset:1024 lds
    buffer_load_dwordx4 v218, s[52:55], s88 offen offset:2048 lds
    buffer_load_dwordx4 v219, s[52:55], s88 offen offset:3072 lds
    s_add_u32 m0, s84, 13312
    s_nop 0
    buffer_load_dwordx4 v220, s[52:55], s88 offen offset:0 lds
    buffer_load_dwordx4 v221, s[52:55], s88 offen offset:1024 lds
    buffer_load_dwordx4 v222, s[52:55], s88 offen offset:2048 lds
    buffer_load_dwordx4 v223, s[52:55], s88 offen offset:3072 lds
    s_add_u32 m0, s84, 17408
    s_nop 0
    buffer_load_dwordx4 v224, s[52:55], s88 offen offset:0 lds
    s_waitcnt vmcnt(18)
    v_lshlrev_b32 v16, 16, v160
    v_and_b32 v17, 0xffff0000, v160
    v_lshlrev_b32 v18, 16, v161
    v_and_b32 v19, 0xffff0000, v161
    v_lshlrev_b32 v32, 16, v162
    v_and_b32 v33, 0xffff0000, v162
    v_lshlrev_b32 v34, 16, v163
    v_and_b32 v35, 0xffff0000, v163
    v_lshlrev_b32 v48, 16, v164
    v_and_b32 v49, 0xffff0000, v164
    v_lshlrev_b32 v50, 16, v165
    v_and_b32 v51, 0xffff0000, v165
    v_lshlrev_b32 v64, 16, v166
    v_and_b32 v65, 0xffff0000, v166
    v_lshlrev_b32 v66, 16, v167
    v_and_b32 v67, 0xffff0000, v167
    v_lshlrev_b32 v80, 16, v168
    v_and_b32 v81, 0xffff0000, v168
    v_lshlrev_b32 v82, 16, v169
    v_and_b32 v83, 0xffff0000, v169
    v_lshlrev_b32 v96, 16, v170
    v_and_b32 v97, 0xffff0000, v170
    v_lshlrev_b32 v98, 16, v171
    v_and_b32 v99, 0xffff0000, v171
    v_lshlrev_b32 v112, 16, v172
    v_and_b32 v113, 0xffff0000, v172
    v_lshlrev_b32 v114, 16, v173
    v_and_b32 v115, 0xffff0000, v173
    v_lshlrev_b32 v128, 16, v174
    v_and_b32 v129, 0xffff0000, v174
    v_lshlrev_b32 v130, 16, v175
    v_and_b32 v131, 0xffff0000, v175
    v_lshlrev_b32 v144, 16, v176
    v_and_b32 v145, 0xffff0000, v176
    v_lshlrev_b32 v146, 16, v177
    v_and_b32 v147, 0xffff0000, v177
    ds_read_b128 v[184:187], v234 offset:0
    ds_read_b128 v[188:191], v234 offset:18432
    ds_read_b128 v[192:195], v234 offset:36864
    ds_read_b128 v[196:199], v234 offset:55296
    s_waitcnt vmcnt(9)
    ds_read_b64_tr_b16 v[160:161], v236 offset:0
    ds_read_b64_tr_b16 v[162:163], v236 offset:4608
    ds_read_b64_tr_b16 v[164:165], v236 offset:32
    ds_read_b64_tr_b16 v[166:167], v236 offset:4640
    ds_read_b64_tr_b16 v[168:169], v236 offset:64
    ds_read_b64_tr_b16 v[170:171], v236 offset:4672
    s_waitcnt lgkmcnt(0)
    v_mfma_f32_16x16x32_bf16 v[20:23], v[160:163], v[188:191], v[16:19]
    ds_read_b64_tr_b16 v[172:173], v236 offset:96
    v_mfma_f32_16x16x32_bf16 v[24:27], v[160:163], v[192:195], v[16:19]
    v_mfma_f32_16x16x32_bf16 v[28:31], v[160:163], v[196:199], v[16:19]
    ds_read_b64_tr_b16 v[174:175], v236 offset:4704
    v_mfma_f32_16x16x32_bf16 v[16:19], v[160:163], v[184:187], v[16:19]
    v_mfma_f32_16x16x32_bf16 v[36:39], v[164:167], v[188:191], v[32:35]
    ds_read_b64_tr_b16 v[176:177], v236 offset:128
    v_mfma_f32_16x16x32_bf16 v[40:43], v[164:167], v[192:195], v[32:35]
    v_mfma_f32_16x16x32_bf16 v[44:47], v[164:167], v[196:199], v[32:35]
    ds_read_b64_tr_b16 v[178:179], v236 offset:4736
    v_mfma_f32_16x16x32_bf16 v[32:35], v[164:167], v[184:187], v[32:35]
    v_mfma_f32_16x16x32_bf16 v[52:55], v[168:171], v[188:191], v[48:51]
    ds_read_b64_tr_b16 v[180:181], v236 offset:160
    v_mfma_f32_16x16x32_bf16 v[56:59], v[168:171], v[192:195], v[48:51]
    v_mfma_f32_16x16x32_bf16 v[60:63], v[168:171], v[196:199], v[48:51]
    ds_read_b64_tr_b16 v[182:183], v236 offset:4768
    v_mfma_f32_16x16x32_bf16 v[48:51], v[168:171], v[184:187], v[48:51]
    s_waitcnt lgkmcnt(0)
    v_mfma_f32_16x16x32_bf16 v[68:71], v[172:175], v[188:191], v[64:67]
    ds_read_b64_tr_b16 v[160:161], v236 offset:192
    v_mfma_f32_16x16x32_bf16 v[72:75], v[172:175], v[192:195], v[64:67]
    ds_read_b64_tr_b16 v[162:163], v236 offset:4800
    v_mfma_f32_16x16x32_bf16 v[76:79], v[172:175], v[196:199], v[64:67]
    ds_read_b64_tr_b16 v[164:165], v236 offset:224
    v_mfma_f32_16x16x32_bf16 v[64:67], v[172:175], v[184:187], v[64:67]
    ds_read_b64_tr_b16 v[166:167], v236 offset:4832
    v_mfma_f32_16x16x32_bf16 v[84:87], v[176:179], v[188:191], v[80:83]
    ds_read_b64_tr_b16 v[168:169], v236 offset:256
    v_mfma_f32_16x16x32_bf16 v[88:91], v[176:179], v[192:195], v[80:83]
    v_mfma_f32_16x16x32_bf16 v[92:95], v[176:179], v[196:199], v[80:83]
    ds_read_b64_tr_b16 v[170:171], v236 offset:4864
    v_mfma_f32_16x16x32_bf16 v[80:83], v[176:179], v[184:187], v[80:83]
    ds_read_b128 v[200:203], v235 offset:0
    v_mfma_f32_16x16x32_bf16 v[100:103], v[180:183], v[188:191], v[96:99]
    ds_read_b128 v[204:207], v235 offset:18432
    v_mfma_f32_16x16x32_bf16 v[104:107], v[180:183], v[192:195], v[96:99]
    ds_read_b128 v[208:211], v235 offset:36864
    v_mfma_f32_16x16x32_bf16 v[108:111], v[180:183], v[196:199], v[96:99]
    ds_read_b128 v[212:215], v235 offset:55296
    v_mfma_f32_16x16x32_bf16 v[96:99], v[180:183], v[184:187], v[96:99]
    s_waitcnt lgkmcnt(4)
    s_waitcnt vmcnt(0)
    v_mfma_f32_16x16x32_bf16 v[116:119], v[160:163], v[188:191], v[112:115]
    ds_read_b64_tr_b16 v[172:173], v236 offset:9216
    v_mfma_f32_16x16x32_bf16 v[120:123], v[160:163], v[192:195], v[112:115]
    ds_read_b64_tr_b16 v[174:175], v236 offset:13824
    v_mfma_f32_16x16x32_bf16 v[124:127], v[160:163], v[196:199], v[112:115]
    ds_read_b64_tr_b16 v[176:177], v236 offset:9248
    v_mfma_f32_16x16x32_bf16 v[112:115], v[160:163], v[184:187], v[112:115]
    ds_read_b64_tr_b16 v[178:179], v236 offset:13856
    v_mfma_f32_16x16x32_bf16 v[132:135], v[164:167], v[188:191], v[128:131]
    ds_read_b64_tr_b16 v[180:181], v236 offset:9280
    v_mfma_f32_16x16x32_bf16 v[136:139], v[164:167], v[192:195], v[128:131]
    v_mfma_f32_16x16x32_bf16 v[140:143], v[164:167], v[196:199], v[128:131]
    ds_read_b64_tr_b16 v[182:183], v236 offset:13888
    v_mfma_f32_16x16x32_bf16 v[128:131], v[164:167], v[184:187], v[128:131]
    s_add_u32 s88, s85, 589824
    s_add_u32 m0, s84, 0
    s_nop 0
    buffer_load_dwordx4 v216, s[52:55], s88 offen offset:0 lds
    v_mfma_f32_16x16x32_bf16 v[148:151], v[168:171], v[188:191], v[144:147]
    buffer_load_dwordx4 v217, s[52:55], s88 offen offset:1024 lds
    v_mfma_f32_16x16x32_bf16 v[152:155], v[168:171], v[192:195], v[144:147]
    buffer_load_dwordx4 v218, s[52:55], s88 offen offset:2048 lds
    v_mfma_f32_16x16x32_bf16 v[156:159], v[168:171], v[196:199], v[144:147]
    buffer_load_dwordx4 v219, s[52:55], s88 offen offset:3072 lds
    v_mfma_f32_16x16x32_bf16 v[144:147], v[168:171], v[184:187], v[144:147]
    s_waitcnt lgkmcnt(0)
    v_mfma_f32_16x16x32_bf16 v[16:19], v[172:175], v[200:203], v[16:19]
    ds_read_b64_tr_b16 v[160:161], v236 offset:9312
    v_mfma_f32_16x16x32_bf16 v[20:23], v[172:175], v[204:207], v[20:23]
    ds_read_b64_tr_b16 v[162:163], v236 offset:13920
    v_mfma_f32_16x16x32_bf16 v[24:27], v[172:175], v[208:211], v[24:27]
    ds_read_b64_tr_b16 v[164:165], v236 offset:9344
    v_mfma_f32_16x16x32_bf16 v[28:31], v[172:175], v[212:215], v[28:31]
    ds_read_b64_tr_b16 v[166:167], v236 offset:13952
    v_mfma_f32_16x16x32_bf16 v[32:35], v[176:179], v[200:203], v[32:35]
    ds_read_b64_tr_b16 v[168:169], v236 offset:9376
    v_mfma_f32_16x16x32_bf16 v[36:39], v[176:179], v[204:207], v[36:39]
    ds_read_b64_tr_b16 v[170:171], v236 offset:13984
    v_mfma_f32_16x16x32_bf16 v[40:43], v[176:179], v[208:211], v[40:43]
    s_add_u32 m0, s84, 4096
    s_nop 0
    buffer_load_dwordx4 v220, s[52:55], s88 offen offset:0 lds
    v_mfma_f32_16x16x32_bf16 v[44:47], v[176:179], v[212:215], v[44:47]
    buffer_load_dwordx4 v221, s[52:55], s88 offen offset:1024 lds
    v_mfma_f32_16x16x32_bf16 v[48:51], v[180:183], v[200:203], v[48:51]
    buffer_load_dwordx4 v222, s[52:55], s88 offen offset:2048 lds
    v_mfma_f32_16x16x32_bf16 v[52:55], v[180:183], v[204:207], v[52:55]
    buffer_load_dwordx4 v223, s[52:55], s88 offen offset:3072 lds
    v_mfma_f32_16x16x32_bf16 v[56:59], v[180:183], v[208:211], v[56:59]
    s_add_u32 m0, s84, 8192
    s_nop 0
    buffer_load_dwordx4 v224, s[52:55], s88 offen offset:0 lds
    v_mfma_f32_16x16x32_bf16 v[60:63], v[180:183], v[212:215], v[60:63]
    s_waitcnt lgkmcnt(0)
    v_mfma_f32_16x16x32_bf16 v[64:67], v[160:163], v[200:203], v[64:67]
    ds_read_b64_tr_b16 v[172:173], v236 offset:9408
    v_mfma_f32_16x16x32_bf16 v[68:71], v[160:163], v[204:207], v[68:71]
    ds_read_b64_tr_b16 v[174:175], v236 offset:14016
    v_mfma_f32_16x16x32_bf16 v[72:75], v[160:163], v[208:211], v[72:75]
    ds_read_b64_tr_b16 v[176:177], v236 offset:9440
    v_mfma_f32_16x16x32_bf16 v[76:79], v[160:163], v[212:215], v[76:79]
    ds_read_b64_tr_b16 v[178:179], v236 offset:14048
    v_mfma_f32_16x16x32_bf16 v[80:83], v[164:167], v[200:203], v[80:83]
    ds_read_b64_tr_b16 v[180:181], v236 offset:9472
    v_mfma_f32_16x16x32_bf16 v[84:87], v[164:167], v[204:207], v[84:87]
    v_mfma_f32_16x16x32_bf16 v[88:91], v[164:167], v[208:211], v[88:91]
    ds_read_b64_tr_b16 v[182:183], v236 offset:14080
    v_mfma_f32_16x16x32_bf16 v[92:95], v[164:167], v[212:215], v[92:95]
    ds_read_b128 v[184:187], v234 offset:128
    v_mfma_f32_16x16x32_bf16 v[96:99], v[168:171], v[200:203], v[96:99]
    ds_read_b128 v[188:191], v234 offset:18560
    v_mfma_f32_16x16x32_bf16 v[100:103], v[168:171], v[204:207], v[100:103]
    ds_read_b128 v[192:195], v234 offset:36992
    v_mfma_f32_16x16x32_bf16 v[104:107], v[168:171], v[208:211], v[104:107]
    ds_read_b128 v[196:199], v234 offset:55424
    v_mfma_f32_16x16x32_bf16 v[108:111], v[168:171], v[212:215], v[108:111]
    s_waitcnt lgkmcnt(4)
    s_waitcnt vmcnt(0)
    v_mfma_f32_16x16x32_bf16 v[112:115], v[172:175], v[200:203], v[112:115]
    ds_read_b64_tr_b16 v[160:161], v236 offset:0
    v_mfma_f32_16x16x32_bf16 v[116:119], v[172:175], v[204:207], v[116:119]
    ds_read_b64_tr_b16 v[162:163], v236 offset:4608
    v_mfma_f32_16x16x32_bf16 v[120:123], v[172:175], v[208:211], v[120:123]
    ds_read_b64_tr_b16 v[164:165], v236 offset:32
    v_mfma_f32_16x16x32_bf16 v[124:127], v[172:175], v[212:215], v[124:127]
    ds_read_b64_tr_b16 v[166:167], v236 offset:4640
    v_mfma_f32_16x16x32_bf16 v[128:131], v[176:179], v[200:203], v[128:131]
    ds_read_b64_tr_b16 v[168:169], v236 offset:64
    v_mfma_f32_16x16x32_bf16 v[132:135], v[176:179], v[204:207], v[132:135]
    v_mfma_f32_16x16x32_bf16 v[136:139], v[176:179], v[208:211], v[136:139]
    ds_read_b64_tr_b16 v[170:171], v236 offset:4672
    v_mfma_f32_16x16x32_bf16 v[140:143], v[176:179], v[212:215], v[140:143]
    s_add_u32 s88, s85, 884736
    s_add_u32 m0, s84, 9216
    s_nop 0
    buffer_load_dwordx4 v216, s[52:55], s88 offen offset:0 lds
    v_mfma_f32_16x16x32_bf16 v[144:147], v[180:183], v[200:203], v[144:147]
    buffer_load_dwordx4 v217, s[52:55], s88 offen offset:1024 lds
    v_mfma_f32_16x16x32_bf16 v[148:151], v[180:183], v[204:207], v[148:151]
    buffer_load_dwordx4 v218, s[52:55], s88 offen offset:2048 lds
    v_mfma_f32_16x16x32_bf16 v[152:155], v[180:183], v[208:211], v[152:155]
    buffer_load_dwordx4 v219, s[52:55], s88 offen offset:3072 lds
    v_mfma_f32_16x16x32_bf16 v[156:159], v[180:183], v[212:215], v[156:159]
    s_waitcnt lgkmcnt(0)
    v_mfma_f32_16x16x32_bf16 v[16:19], v[160:163], v[184:187], v[16:19]
    ds_read_b64_tr_b16 v[172:173], v236 offset:96
    ds_read_b64_tr_b16 v[174:175], v236 offset:4704
    v_mfma_f32_16x16x32_bf16 v[20:23], v[160:163], v[188:191], v[20:23]
    ds_read_b64_tr_b16 v[176:177], v236 offset:128
    v_mfma_f32_16x16x32_bf16 v[24:27], v[160:163], v[192:195], v[24:27]
    ds_read_b64_tr_b16 v[178:179], v236 offset:4736
    v_mfma_f32_16x16x32_bf16 v[28:31], v[160:163], v[196:199], v[28:31]
    ds_read_b64_tr_b16 v[180:181], v236 offset:160
    v_mfma_f32_16x16x32_bf16 v[32:35], v[164:167], v[184:187], v[32:35]
    ds_read_b64_tr_b16 v[182:183], v236 offset:4768
    s_min_u32 s9, s7, 2
    s_mul_i32 s9, s9, 6912
    s_mul_i32 s10, s4, 20736
    s_add_u32 s9, s9, s10
    s_mul_i32 s10, s5, 663552
    s_add_u32 s9, s9, s10
    v_mfma_f32_16x16x32_bf16 v[36:39], v[164:167], v[188:191], v[36:39]
    v_min_u32 v246, 53, v1
    v_lshlrev_b32 v246, 7, v246
    v_mfma_f32_16x16x32_bf16 v[40:43], v[164:167], v[192:195], v[40:43]
    buffer_load_dword v247, v246, s[56:59], s9 offen
    v_mfma_f32_16x16x32_bf16 v[44:47], v[164:167], v[196:199], v[44:47]
    s_xor_b32 s10, s4, 16
    s_sub_u32 s10, s10, s4
    s_mul_i32 s10, s10, 20736
    s_add_u32 s9, s9, s10
    buffer_load_dword v247, v246, s[56:59], s9 offen
    v_mfma_f32_16x16x32_bf16 v[48:51], v[168:171], v[184:187], v[48:51]
    s_add_u32 m0, s84, 13312
    s_nop 0
    buffer_load_dwordx4 v220, s[52:55], s88 offen offset:0 lds
    buffer_load_dwordx4 v221, s[52:55], s88 offen offset:1024 lds
    v_mfma_f32_16x16x32_bf16 v[52:55], v[168:171], v[188:191], v[52:55]
    buffer_load_dwordx4 v222, s[52:55], s88 offen offset:2048 lds
    v_mfma_f32_16x16x32_bf16 v[56:59], v[168:171], v[192:195], v[56:59]
    buffer_load_dwordx4 v223, s[52:55], s88 offen offset:3072 lds
    v_mfma_f32_16x16x32_bf16 v[60:63], v[168:171], v[196:199], v[60:63]
    s_add_u32 m0, s84, 17408
    s_nop 0
    buffer_load_dwordx4 v224, s[52:55], s88 offen offset:0 lds
    s_waitcnt lgkmcnt(0)
    v_mfma_f32_16x16x32_bf16 v[64:67], v[172:175], v[184:187], v[64:67]
    ds_read_b64_tr_b16 v[160:161], v236 offset:192
    v_mfma_f32_16x16x32_bf16 v[68:71], v[172:175], v[188:191], v[68:71]
    ds_read_b64_tr_b16 v[162:163], v236 offset:4800
    v_mfma_f32_16x16x32_bf16 v[72:75], v[172:175], v[192:195], v[72:75]
    ds_read_b64_tr_b16 v[164:165], v236 offset:224
    v_mfma_f32_16x16x32_bf16 v[76:79], v[172:175], v[196:199], v[76:79]
    ds_read_b64_tr_b16 v[166:167], v236 offset:4832
    v_mfma_f32_16x16x32_bf16 v[80:83], v[176:179], v[184:187], v[80:83]
    ds_read_b64_tr_b16 v[168:169], v236 offset:256
    v_mfma_f32_16x16x32_bf16 v[84:87], v[176:179], v[188:191], v[84:87]
    v_mfma_f32_16x16x32_bf16 v[88:91], v[176:179], v[192:195], v[88:91]
    ds_read_b64_tr_b16 v[170:171], v236 offset:4864
    v_mfma_f32_16x16x32_bf16 v[92:95], v[176:179], v[196:199], v[92:95]
    ds_read_b128 v[200:203], v235 offset:128
    v_mfma_f32_16x16x32_bf16 v[96:99], v[180:183], v[184:187], v[96:99]
    ds_read_b128 v[204:207], v235 offset:18560
    v_mfma_f32_16x16x32_bf16 v[100:103], v[180:183], v[188:191], v[100:103]
    ds_read_b128 v[208:211], v235 offset:36992
    v_mfma_f32_16x16x32_bf16 v[104:107], v[180:183], v[192:195], v[104:107]
    ds_read_b128 v[212:215], v235 offset:55424
    v_mfma_f32_16x16x32_bf16 v[108:111], v[180:183], v[196:199], v[108:111]
    s_waitcnt lgkmcnt(4)
    s_waitcnt vmcnt(0)
    v_mfma_f32_16x16x32_bf16 v[112:115], v[160:163], v[184:187], v[112:115]
    ds_read_b64_tr_b16 v[172:173], v236 offset:9216
    v_mfma_f32_16x16x32_bf16 v[116:119], v[160:163], v[188:191], v[116:119]
    ds_read_b64_tr_b16 v[174:175], v236 offset:13824
    v_mfma_f32_16x16x32_bf16 v[120:123], v[160:163], v[192:195], v[120:123]
    ds_read_b64_tr_b16 v[176:177], v236 offset:9248
    v_mfma_f32_16x16x32_bf16 v[124:127], v[160:163], v[196:199], v[124:127]
    ds_read_b64_tr_b16 v[178:179], v236 offset:13856
    v_mfma_f32_16x16x32_bf16 v[128:131], v[164:167], v[184:187], v[128:131]
    ds_read_b64_tr_b16 v[180:181], v236 offset:9280
    v_mfma_f32_16x16x32_bf16 v[132:135], v[164:167], v[188:191], v[132:135]
    v_mfma_f32_16x16x32_bf16 v[136:139], v[164:167], v[192:195], v[136:139]
    ds_read_b64_tr_b16 v[182:183], v236 offset:13888
    v_mfma_f32_16x16x32_bf16 v[140:143], v[164:167], v[196:199], v[140:143]
    s_add_u32 s88, s85, 1179648
    s_add_u32 m0, s84, 0
    s_nop 0
    buffer_load_dwordx4 v216, s[52:55], s88 offen offset:0 lds
    v_mfma_f32_16x16x32_bf16 v[144:147], v[168:171], v[184:187], v[144:147]
    buffer_load_dwordx4 v217, s[52:55], s88 offen offset:1024 lds
    v_mfma_f32_16x16x32_bf16 v[148:151], v[168:171], v[188:191], v[148:151]
    buffer_load_dwordx4 v218, s[52:55], s88 offen offset:2048 lds
    v_mfma_f32_16x16x32_bf16 v[152:155], v[168:171], v[192:195], v[152:155]
    buffer_load_dwordx4 v219, s[52:55], s88 offen offset:3072 lds
    v_mfma_f32_16x16x32_bf16 v[156:159], v[168:171], v[196:199], v[156:159]
    s_waitcnt lgkmcnt(0)
    v_mfma_f32_16x16x32_bf16 v[16:19], v[172:175], v[200:203], v[16:19]
    ds_read_b64_tr_b16 v[160:161], v236 offset:9312
    v_mfma_f32_16x16x32_bf16 v[20:23], v[172:175], v[204:207], v[20:23]
    ds_read_b64_tr_b16 v[162:163], v236 offset:13920
    v_mfma_f32_16x16x32_bf16 v[24:27], v[172:175], v[208:211], v[24:27]
    ds_read_b64_tr_b16 v[164:165], v236 offset:9344
    v_mfma_f32_16x16x32_bf16 v[28:31], v[172:175], v[212:215], v[28:31]
    ds_read_b64_tr_b16 v[166:167], v236 offset:13952
    v_mfma_f32_16x16x32_bf16 v[32:35], v[176:179], v[200:203], v[32:35]
    ds_read_b64_tr_b16 v[168:169], v236 offset:9376
    v_mfma_f32_16x16x32_bf16 v[36:39], v[176:179], v[204:207], v[36:39]
    ds_read_b64_tr_b16 v[170:171], v236 offset:13984
    v_mfma_f32_16x16x32_bf16 v[40:43], v[176:179], v[208:211], v[40:43]
    s_add_u32 m0, s84, 4096
    s_nop 0
    buffer_load_dwordx4 v220, s[52:55], s88 offen offset:0 lds
    v_mfma_f32_16x16x32_bf16 v[44:47], v[176:179], v[212:215], v[44:47]
    buffer_load_dwordx4 v221, s[52:55], s88 offen offset:1024 lds
    v_mfma_f32_16x16x32_bf16 v[48:51], v[180:183], v[200:203], v[48:51]
    buffer_load_dwordx4 v222, s[52:55], s88 offen offset:2048 lds
    v_mfma_f32_16x16x32_bf16 v[52:55], v[180:183], v[204:207], v[52:55]
    buffer_load_dwordx4 v223, s[52:55], s88 offen offset:3072 lds
    v_mfma_f32_16x16x32_bf16 v[56:59], v[180:183], v[208:211], v[56:59]
    s_add_u32 m0, s84, 8192
    s_nop 0
    buffer_load_dwordx4 v224, s[52:55], s88 offen offset:0 lds
    v_mfma_f32_16x16x32_bf16 v[60:63], v[180:183], v[212:215], v[60:63]
    s_waitcnt lgkmcnt(0)
    v_mfma_f32_16x16x32_bf16 v[64:67], v[160:163], v[200:203], v[64:67]
    ds_read_b64_tr_b16 v[172:173], v236 offset:9408
    v_mfma_f32_16x16x32_bf16 v[68:71], v[160:163], v[204:207], v[68:71]
    ds_read_b64_tr_b16 v[174:175], v236 offset:14016
    v_mfma_f32_16x16x32_bf16 v[72:75], v[160:163], v[208:211], v[72:75]
    ds_read_b64_tr_b16 v[176:177], v236 offset:9440
    v_mfma_f32_16x16x32_bf16 v[76:79], v[160:163], v[212:215], v[76:79]
    ds_read_b64_tr_b16 v[178:179], v236 offset:14048
    v_mfma_f32_16x16x32_bf16 v[80:83], v[164:167], v[200:203], v[80:83]
    ds_read_b64_tr_b16 v[180:181], v236 offset:9472
    v_mfma_f32_16x16x32_bf16 v[84:87], v[164:167], v[204:207], v[84:87]
    v_mfma_f32_16x16x32_bf16 v[88:91], v[164:167], v[208:211], v[88:91]
    ds_read_b64_tr_b16 v[182:183], v236 offset:14080
    v_mfma_f32_16x16x32_bf16 v[92:95], v[164:167], v[212:215], v[92:95]
    ds_read_b128 v[184:187], v234 offset:256
    v_mfma_f32_16x16x32_bf16 v[96:99], v[168:171], v[200:203], v[96:99]
    ds_read_b128 v[188:191], v234 offset:18688
    v_mfma_f32_16x16x32_bf16 v[100:103], v[168:171], v[204:207], v[100:103]
    ds_read_b128 v[192:195], v234 offset:37120
    v_mfma_f32_16x16x32_bf16 v[104:107], v[168:171], v[208:211], v[104:107]
    ds_read_b128 v[196:199], v234 offset:55552
    v_mfma_f32_16x16x32_bf16 v[108:111], v[168:171], v[212:215], v[108:111]
    s_waitcnt lgkmcnt(4)
    s_waitcnt vmcnt(0)
    v_mfma_f32_16x16x32_bf16 v[112:115], v[172:175], v[200:203], v[112:115]
    ds_read_b64_tr_b16 v[160:161], v236 offset:0
    v_mfma_f32_16x16x32_bf16 v[116:119], v[172:175], v[204:207], v[116:119]
    ds_read_b64_tr_b16 v[162:163], v236 offset:4608
    v_mfma_f32_16x16x32_bf16 v[120:123], v[172:175], v[208:211], v[120:123]
    ds_read_b64_tr_b16 v[164:165], v236 offset:32
    v_mfma_f32_16x16x32_bf16 v[124:127], v[172:175], v[212:215], v[124:127]
    ds_read_b64_tr_b16 v[166:167], v236 offset:4640
    v_mfma_f32_16x16x32_bf16 v[128:131], v[176:179], v[200:203], v[128:131]
    ds_read_b64_tr_b16 v[168:169], v236 offset:64
    v_mfma_f32_16x16x32_bf16 v[132:135], v[176:179], v[204:207], v[132:135]
    v_mfma_f32_16x16x32_bf16 v[136:139], v[176:179], v[208:211], v[136:139]
    ds_read_b64_tr_b16 v[170:171], v236 offset:4672
    v_mfma_f32_16x16x32_bf16 v[140:143], v[176:179], v[212:215], v[140:143]
    s_add_u32 s88, s85, 1474560
    s_add_u32 m0, s84, 9216
    s_nop 0
    buffer_load_dwordx4 v216, s[52:55], s88 offen offset:0 lds
    v_mfma_f32_16x16x32_bf16 v[144:147], v[180:183], v[200:203], v[144:147]
    buffer_load_dwordx4 v217, s[52:55], s88 offen offset:1024 lds
    v_mfma_f32_16x16x32_bf16 v[148:151], v[180:183], v[204:207], v[148:151]
    buffer_load_dwordx4 v218, s[52:55], s88 offen offset:2048 lds
    v_mfma_f32_16x16x32_bf16 v[152:155], v[180:183], v[208:211], v[152:155]
    buffer_load_dwordx4 v219, s[52:55], s88 offen offset:3072 lds
    v_mfma_f32_16x16x32_bf16 v[156:159], v[180:183], v[212:215], v[156:159]
    s_waitcnt lgkmcnt(0)
    v_mfma_f32_16x16x32_bf16 v[16:19], v[160:163], v[184:187], v[16:19]
    ds_read_b64_tr_b16 v[172:173], v236 offset:96
    v_mfma_f32_16x16x32_bf16 v[20:23], v[160:163], v[188:191], v[20:23]
    ds_read_b64_tr_b16 v[174:175], v236 offset:4704
    v_mfma_f32_16x16x32_bf16 v[24:27], v[160:163], v[192:195], v[24:27]
    ds_read_b64_tr_b16 v[176:177], v236 offset:128
    v_mfma_f32_16x16x32_bf16 v[28:31], v[160:163], v[196:199], v[28:31]
    ds_read_b64_tr_b16 v[178:179], v236 offset:4736
    v_mfma_f32_16x16x32_bf16 v[32:35], v[164:167], v[184:187], v[32:35]
    ds_read_b64_tr_b16 v[180:181], v236 offset:160
    v_mfma_f32_16x16x32_bf16 v[36:39], v[164:167], v[188:191], v[36:39]
    ds_read_b64_tr_b16 v[182:183], v236 offset:4768
    v_mfma_f32_16x16x32_bf16 v[40:43], v[164:167], v[192:195], v[40:43]
    s_add_u32 m0, s84, 13312
    s_nop 0
    buffer_load_dwordx4 v220, s[52:55], s88 offen offset:0 lds
    v_mfma_f32_16x16x32_bf16 v[44:47], v[164:167], v[196:199], v[44:47]
    buffer_load_dwordx4 v221, s[52:55], s88 offen offset:1024 lds
    v_mfma_f32_16x16x32_bf16 v[48:51], v[168:171], v[184:187], v[48:51]
    buffer_load_dwordx4 v222, s[52:55], s88 offen offset:2048 lds
    v_mfma_f32_16x16x32_bf16 v[52:55], v[168:171], v[188:191], v[52:55]
    buffer_load_dwordx4 v223, s[52:55], s88 offen offset:3072 lds
    v_mfma_f32_16x16x32_bf16 v[56:59], v[168:171], v[192:195], v[56:59]
    s_add_u32 m0, s84, 17408
    s_nop 0
    buffer_load_dwordx4 v224, s[52:55], s88 offen offset:0 lds
    v_mfma_f32_16x16x32_bf16 v[60:63], v[168:171], v[196:199], v[60:63]
    s_waitcnt lgkmcnt(0)
    v_mfma_f32_16x16x32_bf16 v[64:67], v[172:175], v[184:187], v[64:67]
    ds_read_b64_tr_b16 v[160:161], v236 offset:192
    v_mfma_f32_16x16x32_bf16 v[68:71], v[172:175], v[188:191], v[68:71]
    ds_read_b64_tr_b16 v[162:163], v236 offset:4800
    v_mfma_f32_16x16x32_bf16 v[72:75], v[172:175], v[192:195], v[72:75]
    ds_read_b64_tr_b16 v[164:165], v236 offset:224
    v_mfma_f32_16x16x32_bf16 v[76:79], v[172:175], v[196:199], v[76:79]
    ds_read_b64_tr_b16 v[166:167], v236 offset:4832
    v_mfma_f32_16x16x32_bf16 v[80:83], v[176:179], v[184:187], v[80:83]
    ds_read_b64_tr_b16 v[168:169], v236 offset:256
    v_mfma_f32_16x16x32_bf16 v[84:87], v[176:179], v[188:191], v[84:87]
    v_mfma_f32_16x16x32_bf16 v[88:91], v[176:179], v[192:195], v[88:91]
    ds_read_b64_tr_b16 v[170:171], v236 offset:4864
    v_mfma_f32_16x16x32_bf16 v[92:95], v[176:179], v[196:199], v[92:95]
    ds_read_b128 v[200:203], v235 offset:256
    v_mfma_f32_16x16x32_bf16 v[96:99], v[180:183], v[184:187], v[96:99]
    ds_read_b128 v[204:207], v235 offset:18688
    v_mfma_f32_16x16x32_bf16 v[100:103], v[180:183], v[188:191], v[100:103]
    ds_read_b128 v[208:211], v235 offset:37120
    v_mfma_f32_16x16x32_bf16 v[104:107], v[180:183], v[192:195], v[104:107]
    ds_read_b128 v[212:215], v235 offset:55552
    v_mfma_f32_16x16x32_bf16 v[108:111], v[180:183], v[196:199], v[108:111]
    s_waitcnt lgkmcnt(4)
    s_waitcnt vmcnt(0)
    v_mfma_f32_16x16x32_bf16 v[112:115], v[160:163], v[184:187], v[112:115]
    ds_read_b64_tr_b16 v[172:173], v236 offset:9216
    v_mfma_f32_16x16x32_bf16 v[116:119], v[160:163], v[188:191], v[116:119]
    ds_read_b64_tr_b16 v[174:175], v236 offset:13824
    v_mfma_f32_16x16x32_bf16 v[120:123], v[160:163], v[192:195], v[120:123]
    ds_read_b64_tr_b16 v[176:177], v236 offset:9248
    v_mfma_f32_16x16x32_bf16 v[124:127], v[160:163], v[196:199], v[124:127]
    ds_read_b64_tr_b16 v[178:179], v236 offset:13856
    v_mfma_f32_16x16x32_bf16 v[128:131], v[164:167], v[184:187], v[128:131]
    ds_read_b64_tr_b16 v[180:181], v236 offset:9280
    v_mfma_f32_16x16x32_bf16 v[132:135], v[164:167], v[188:191], v[132:135]
    v_mfma_f32_16x16x32_bf16 v[136:139], v[164:167], v[192:195], v[136:139]
    ds_read_b64_tr_b16 v[182:183], v236 offset:13888
    v_mfma_f32_16x16x32_bf16 v[140:143], v[164:167], v[196:199], v[140:143]
    s_add_u32 s88, s85, 1769472
    s_add_u32 m0, s84, 0
    s_nop 0
    buffer_load_dwordx4 v216, s[52:55], s88 offen offset:0 lds
    v_mfma_f32_16x16x32_bf16 v[144:147], v[168:171], v[184:187], v[144:147]
    buffer_load_dwordx4 v217, s[52:55], s88 offen offset:1024 lds
    v_mfma_f32_16x16x32_bf16 v[148:151], v[168:171], v[188:191], v[148:151]
    buffer_load_dwordx4 v218, s[52:55], s88 offen offset:2048 lds
    v_mfma_f32_16x16x32_bf16 v[152:155], v[168:171], v[192:195], v[152:155]
    buffer_load_dwordx4 v219, s[52:55], s88 offen offset:3072 lds
    v_mfma_f32_16x16x32_bf16 v[156:159], v[168:171], v[196:199], v[156:159]
    s_waitcnt lgkmcnt(0)
    v_mfma_f32_16x16x32_bf16 v[16:19], v[172:175], v[200:203], v[16:19]
    ds_read_b64_tr_b16 v[160:161], v236 offset:9312
    v_mfma_f32_16x16x32_bf16 v[20:23], v[172:175], v[204:207], v[20:23]
    ds_read_b64_tr_b16 v[162:163], v236 offset:13920
    v_mfma_f32_16x16x32_bf16 v[24:27], v[172:175], v[208:211], v[24:27]
    ds_read_b64_tr_b16 v[164:165], v236 offset:9344
    v_mfma_f32_16x16x32_bf16 v[28:31], v[172:175], v[212:215], v[28:31]
    ds_read_b64_tr_b16 v[166:167], v236 offset:13952
    v_mfma_f32_16x16x32_bf16 v[32:35], v[176:179], v[200:203], v[32:35]
    ds_read_b64_tr_b16 v[168:169], v236 offset:9376
    v_mfma_f32_16x16x32_bf16 v[36:39], v[176:179], v[204:207], v[36:39]
    ds_read_b64_tr_b16 v[170:171], v236 offset:13984
    v_mfma_f32_16x16x32_bf16 v[40:43], v[176:179], v[208:211], v[40:43]
    s_add_u32 m0, s84, 4096
    s_nop 0
    buffer_load_dwordx4 v220, s[52:55], s88 offen offset:0 lds
    v_mfma_f32_16x16x32_bf16 v[44:47], v[176:179], v[212:215], v[44:47]
    buffer_load_dwordx4 v221, s[52:55], s88 offen offset:1024 lds
    v_mfma_f32_16x16x32_bf16 v[48:51], v[180:183], v[200:203], v[48:51]
    buffer_load_dwordx4 v222, s[52:55], s88 offen offset:2048 lds
    v_mfma_f32_16x16x32_bf16 v[52:55], v[180:183], v[204:207], v[52:55]
    buffer_load_dwordx4 v223, s[52:55], s88 offen offset:3072 lds
    v_mfma_f32_16x16x32_bf16 v[56:59], v[180:183], v[208:211], v[56:59]
    s_add_u32 m0, s84, 8192
    s_nop 0
    buffer_load_dwordx4 v224, s[52:55], s88 offen offset:0 lds
    v_mfma_f32_16x16x32_bf16 v[60:63], v[180:183], v[212:215], v[60:63]
    s_waitcnt lgkmcnt(0)
    v_mfma_f32_16x16x32_bf16 v[64:67], v[160:163], v[200:203], v[64:67]
    ds_read_b64_tr_b16 v[172:173], v236 offset:9408
    v_mfma_f32_16x16x32_bf16 v[68:71], v[160:163], v[204:207], v[68:71]
    ds_read_b64_tr_b16 v[174:175], v236 offset:14016
    v_mfma_f32_16x16x32_bf16 v[72:75], v[160:163], v[208:211], v[72:75]
    ds_read_b64_tr_b16 v[176:177], v236 offset:9440
    v_mfma_f32_16x16x32_bf16 v[76:79], v[160:163], v[212:215], v[76:79]
    ds_read_b64_tr_b16 v[178:179], v236 offset:14048
    v_mfma_f32_16x16x32_bf16 v[80:83], v[164:167], v[200:203], v[80:83]
    ds_read_b64_tr_b16 v[180:181], v236 offset:9472
    v_mfma_f32_16x16x32_bf16 v[84:87], v[164:167], v[204:207], v[84:87]
    v_mfma_f32_16x16x32_bf16 v[88:91], v[164:167], v[208:211], v[88:91]
    ds_read_b64_tr_b16 v[182:183], v236 offset:14080
    v_mfma_f32_16x16x32_bf16 v[92:95], v[164:167], v[212:215], v[92:95]
    ds_read_b128 v[184:187], v234 offset:384
    v_mfma_f32_16x16x32_bf16 v[96:99], v[168:171], v[200:203], v[96:99]
    ds_read_b128 v[188:191], v234 offset:18816
    v_mfma_f32_16x16x32_bf16 v[100:103], v[168:171], v[204:207], v[100:103]
    ds_read_b128 v[192:195], v234 offset:37248
    v_mfma_f32_16x16x32_bf16 v[104:107], v[168:171], v[208:211], v[104:107]
    ds_read_b128 v[196:199], v234 offset:55680
    v_mfma_f32_16x16x32_bf16 v[108:111], v[168:171], v[212:215], v[108:111]
    s_waitcnt lgkmcnt(4)
    s_waitcnt vmcnt(0)
    v_mfma_f32_16x16x32_bf16 v[112:115], v[172:175], v[200:203], v[112:115]
    ds_read_b64_tr_b16 v[160:161], v236 offset:0
    v_mfma_f32_16x16x32_bf16 v[116:119], v[172:175], v[204:207], v[116:119]
    ds_read_b64_tr_b16 v[162:163], v236 offset:4608
    v_mfma_f32_16x16x32_bf16 v[120:123], v[172:175], v[208:211], v[120:123]
    ds_read_b64_tr_b16 v[164:165], v236 offset:32
    v_mfma_f32_16x16x32_bf16 v[124:127], v[172:175], v[212:215], v[124:127]
    ds_read_b64_tr_b16 v[166:167], v236 offset:4640
    v_mfma_f32_16x16x32_bf16 v[128:131], v[176:179], v[200:203], v[128:131]
    ds_read_b64_tr_b16 v[168:169], v236 offset:64
    v_mfma_f32_16x16x32_bf16 v[132:135], v[176:179], v[204:207], v[132:135]
    v_mfma_f32_16x16x32_bf16 v[136:139], v[176:179], v[208:211], v[136:139]
    ds_read_b64_tr_b16 v[170:171], v236 offset:4672
    v_mfma_f32_16x16x32_bf16 v[140:143], v[176:179], v[212:215], v[140:143]
    s_add_u32 s88, s85, 2064384
    s_add_u32 m0, s84, 9216
    s_nop 0
    buffer_load_dwordx4 v216, s[52:55], s88 offen offset:0 lds
    v_mfma_f32_16x16x32_bf16 v[144:147], v[180:183], v[200:203], v[144:147]
    buffer_load_dwordx4 v217, s[52:55], s88 offen offset:1024 lds
    v_mfma_f32_16x16x32_bf16 v[148:151], v[180:183], v[204:207], v[148:151]
    buffer_load_dwordx4 v218, s[52:55], s88 offen offset:2048 lds
    v_mfma_f32_16x16x32_bf16 v[152:155], v[180:183], v[208:211], v[152:155]
    buffer_load_dwordx4 v219, s[52:55], s88 offen offset:3072 lds
    v_mfma_f32_16x16x32_bf16 v[156:159], v[180:183], v[212:215], v[156:159]
    s_waitcnt lgkmcnt(0)
    v_mfma_f32_16x16x32_bf16 v[16:19], v[160:163], v[184:187], v[16:19]
    ds_read_b64_tr_b16 v[172:173], v236 offset:96
    v_mfma_f32_16x16x32_bf16 v[20:23], v[160:163], v[188:191], v[20:23]
    ds_read_b64_tr_b16 v[174:175], v236 offset:4704
    v_mfma_f32_16x16x32_bf16 v[24:27], v[160:163], v[192:195], v[24:27]
    ds_read_b64_tr_b16 v[176:177], v236 offset:128
    v_mfma_f32_16x16x32_bf16 v[28:31], v[160:163], v[196:199], v[28:31]
    ds_read_b64_tr_b16 v[178:179], v236 offset:4736
    v_mfma_f32_16x16x32_bf16 v[32:35], v[164:167], v[184:187], v[32:35]
    ds_read_b64_tr_b16 v[180:181], v236 offset:160
    v_mfma_f32_16x16x32_bf16 v[36:39], v[164:167], v[188:191], v[36:39]
    ds_read_b64_tr_b16 v[182:183], v236 offset:4768
    v_mfma_f32_16x16x32_bf16 v[40:43], v[164:167], v[192:195], v[40:43]
    s_add_u32 m0, s84, 13312
    s_nop 0
    buffer_load_dwordx4 v220, s[52:55], s88 offen offset:0 lds
    v_mfma_f32_16x16x32_bf16 v[44:47], v[164:167], v[196:199], v[44:47]
    buffer_load_dwordx4 v221, s[52:55], s88 offen offset:1024 lds
    v_mfma_f32_16x16x32_bf16 v[48:51], v[168:171], v[184:187], v[48:51]
    buffer_load_dwordx4 v222, s[52:55], s88 offen offset:2048 lds
    v_mfma_f32_16x16x32_bf16 v[52:55], v[168:171], v[188:191], v[52:55]
    buffer_load_dwordx4 v223, s[52:55], s88 offen offset:3072 lds
    v_mfma_f32_16x16x32_bf16 v[56:59], v[168:171], v[192:195], v[56:59]
    s_add_u32 m0, s84, 17408
    s_nop 0
    buffer_load_dwordx4 v224, s[52:55], s88 offen offset:0 lds
    v_mfma_f32_16x16x32_bf16 v[60:63], v[168:171], v[196:199], v[60:63]
    s_waitcnt lgkmcnt(0)
    v_mfma_f32_16x16x32_bf16 v[64:67], v[172:175], v[184:187], v[64:67]
    ds_read_b64_tr_b16 v[160:161], v236 offset:192
    v_mfma_f32_16x16x32_bf16 v[68:71], v[172:175], v[188:191], v[68:71]
    ds_read_b64_tr_b16 v[162:163], v236 offset:4800
    v_mfma_f32_16x16x32_bf16 v[72:75], v[172:175], v[192:195], v[72:75]
    ds_read_b64_tr_b16 v[164:165], v236 offset:224
    v_mfma_f32_16x16x32_bf16 v[76:79], v[172:175], v[196:199], v[76:79]
    ds_read_b64_tr_b16 v[166:167], v236 offset:4832
    v_mfma_f32_16x16x32_bf16 v[80:83], v[176:179], v[184:187], v[80:83]
    ds_read_b64_tr_b16 v[168:169], v236 offset:256
    v_mfma_f32_16x16x32_bf16 v[84:87], v[176:179], v[188:191], v[84:87]
    v_mfma_f32_16x16x32_bf16 v[88:91], v[176:179], v[192:195], v[88:91]
    ds_read_b64_tr_b16 v[170:171], v236 offset:4864
    v_mfma_f32_16x16x32_bf16 v[92:95], v[176:179], v[196:199], v[92:95]
    ds_read_b128 v[200:203], v235 offset:384
    v_mfma_f32_16x16x32_bf16 v[96:99], v[180:183], v[184:187], v[96:99]
    ds_read_b128 v[204:207], v235 offset:18816
    v_mfma_f32_16x16x32_bf16 v[100:103], v[180:183], v[188:191], v[100:103]
    ds_read_b128 v[208:211], v235 offset:37248
    v_mfma_f32_16x16x32_bf16 v[104:107], v[180:183], v[192:195], v[104:107]
    ds_read_b128 v[212:215], v235 offset:55680
    v_mfma_f32_16x16x32_bf16 v[108:111], v[180:183], v[196:199], v[108:111]
    s_waitcnt lgkmcnt(4)
    s_waitcnt vmcnt(0)
    v_mfma_f32_16x16x32_bf16 v[112:115], v[160:163], v[184:187], v[112:115]
    ds_read_b64_tr_b16 v[172:173], v236 offset:9216
    v_mfma_f32_16x16x32_bf16 v[116:119], v[160:163], v[188:191], v[116:119]
    ds_read_b64_tr_b16 v[174:175], v236 offset:13824
    v_mfma_f32_16x16x32_bf16 v[120:123], v[160:163], v[192:195], v[120:123]
    ds_read_b64_tr_b16 v[176:177], v236 offset:9248
    v_mfma_f32_16x16x32_bf16 v[124:127], v[160:163], v[196:199], v[124:127]
    ds_read_b64_tr_b16 v[178:179], v236 offset:13856
    v_mfma_f32_16x16x32_bf16 v[128:131], v[164:167], v[184:187], v[128:131]
    ds_read_b64_tr_b16 v[180:181], v236 offset:9280
    v_mfma_f32_16x16x32_bf16 v[132:135], v[164:167], v[188:191], v[132:135]
    v_mfma_f32_16x16x32_bf16 v[136:139], v[164:167], v[192:195], v[136:139]
    ds_read_b64_tr_b16 v[182:183], v236 offset:13888
    v_mfma_f32_16x16x32_bf16 v[140:143], v[164:167], v[196:199], v[140:143]
    s_add_u32 s88, s85, 2359296
    s_add_u32 m0, s84, 0
    s_nop 0
    buffer_load_dwordx4 v216, s[52:55], s88 offen offset:0 lds
    v_mfma_f32_16x16x32_bf16 v[144:147], v[168:171], v[184:187], v[144:147]
    buffer_load_dwordx4 v217, s[52:55], s88 offen offset:1024 lds
    v_mfma_f32_16x16x32_bf16 v[148:151], v[168:171], v[188:191], v[148:151]
    buffer_load_dwordx4 v218, s[52:55], s88 offen offset:2048 lds
    v_mfma_f32_16x16x32_bf16 v[152:155], v[168:171], v[192:195], v[152:155]
    buffer_load_dwordx4 v219, s[52:55], s88 offen offset:3072 lds
    v_mfma_f32_16x16x32_bf16 v[156:159], v[168:171], v[196:199], v[156:159]
    s_waitcnt lgkmcnt(0)
    v_mfma_f32_16x16x32_bf16 v[16:19], v[172:175], v[200:203], v[16:19]
    ds_read_b64_tr_b16 v[160:161], v236 offset:9312
    v_mfma_f32_16x16x32_bf16 v[20:23], v[172:175], v[204:207], v[20:23]
    ds_read_b64_tr_b16 v[162:163], v236 offset:13920
    v_mfma_f32_16x16x32_bf16 v[24:27], v[172:175], v[208:211], v[24:27]
    ds_read_b64_tr_b16 v[164:165], v236 offset:9344
    v_mfma_f32_16x16x32_bf16 v[28:31], v[172:175], v[212:215], v[28:31]
    ds_read_b64_tr_b16 v[166:167], v236 offset:13952
    v_mfma_f32_16x16x32_bf16 v[32:35], v[176:179], v[200:203], v[32:35]
    ds_read_b64_tr_b16 v[168:169], v236 offset:9376
    v_mfma_f32_16x16x32_bf16 v[36:39], v[176:179], v[204:207], v[36:39]
    ds_read_b64_tr_b16 v[170:171], v236 offset:13984
    v_mfma_f32_16x16x32_bf16 v[40:43], v[176:179], v[208:211], v[40:43]
    s_add_u32 m0, s84, 4096
    s_nop 0
    buffer_load_dwordx4 v220, s[52:55], s88 offen offset:0 lds
    v_mfma_f32_16x16x32_bf16 v[44:47], v[176:179], v[212:215], v[44:47]
    buffer_load_dwordx4 v221, s[52:55], s88 offen offset:1024 lds
    v_mfma_f32_16x16x32_bf16 v[48:51], v[180:183], v[200:203], v[48:51]
    buffer_load_dwordx4 v222, s[52:55], s88 offen offset:2048 lds
    v_mfma_f32_16x16x32_bf16 v[52:55], v[180:183], v[204:207], v[52:55]
    buffer_load_dwordx4 v223, s[52:55], s88 offen offset:3072 lds
    v_mfma_f32_16x16x32_bf16 v[56:59], v[180:183], v[208:211], v[56:59]
    s_add_u32 m0, s84, 8192
    s_nop 0
    buffer_load_dwordx4 v224, s[52:55], s88 offen offset:0 lds
    v_mfma_f32_16x16x32_bf16 v[60:63], v[180:183], v[212:215], v[60:63]
    s_waitcnt lgkmcnt(0)
    v_mfma_f32_16x16x32_bf16 v[64:67], v[160:163], v[200:203], v[64:67]
    ds_read_b64_tr_b16 v[172:173], v236 offset:9408
    v_mfma_f32_16x16x32_bf16 v[68:71], v[160:163], v[204:207], v[68:71]
    ds_read_b64_tr_b16 v[174:175], v236 offset:14016
    v_mfma_f32_16x16x32_bf16 v[72:75], v[160:163], v[208:211], v[72:75]
    ds_read_b64_tr_b16 v[176:177], v236 offset:9440
    v_mfma_f32_16x16x32_bf16 v[76:79], v[160:163], v[212:215], v[76:79]
    ds_read_b64_tr_b16 v[178:179], v236 offset:14048
    v_mfma_f32_16x16x32_bf16 v[80:83], v[164:167], v[200:203], v[80:83]
    ds_read_b64_tr_b16 v[180:181], v236 offset:9472
    v_mfma_f32_16x16x32_bf16 v[84:87], v[164:167], v[204:207], v[84:87]
    v_mfma_f32_16x16x32_bf16 v[88:91], v[164:167], v[208:211], v[88:91]
    ds_read_b64_tr_b16 v[182:183], v236 offset:14080
    v_mfma_f32_16x16x32_bf16 v[92:95], v[164:167], v[212:215], v[92:95]
    ds_read_b128 v[184:187], v234 offset:512
    v_mfma_f32_16x16x32_bf16 v[96:99], v[168:171], v[200:203], v[96:99]
    ds_read_b128 v[188:191], v234 offset:18944
    v_mfma_f32_16x16x32_bf16 v[100:103], v[168:171], v[204:207], v[100:103]
    ds_read_b128 v[192:195], v234 offset:37376
    v_mfma_f32_16x16x32_bf16 v[104:107], v[168:171], v[208:211], v[104:107]
    ds_read_b128 v[196:199], v234 offset:55808
    v_mfma_f32_16x16x32_bf16 v[108:111], v[168:171], v[212:215], v[108:111]
    s_waitcnt lgkmcnt(4)
    s_waitcnt vmcnt(0)
    v_mfma_f32_16x16x32_bf16 v[112:115], v[172:175], v[200:203], v[112:115]
    ds_read_b64_tr_b16 v[160:161], v236 offset:0
    v_mfma_f32_16x16x32_bf16 v[116:119], v[172:175], v[204:207], v[116:119]
    ds_read_b64_tr_b16 v[162:163], v236 offset:4608
    v_mfma_f32_16x16x32_bf16 v[120:123], v[172:175], v[208:211], v[120:123]
    ds_read_b64_tr_b16 v[164:165], v236 offset:32
    v_mfma_f32_16x16x32_bf16 v[124:127], v[172:175], v[212:215], v[124:127]
    ds_read_b64_tr_b16 v[166:167], v236 offset:4640
    v_mfma_f32_16x16x32_bf16 v[128:131], v[176:179], v[200:203], v[128:131]
    ds_read_b64_tr_b16 v[168:169], v236 offset:64
    v_mfma_f32_16x16x32_bf16 v[132:135], v[176:179], v[204:207], v[132:135]
    v_mfma_f32_16x16x32_bf16 v[136:139], v[176:179], v[208:211], v[136:139]
    ds_read_b64_tr_b16 v[170:171], v236 offset:4672
    v_mfma_f32_16x16x32_bf16 v[140:143], v[176:179], v[212:215], v[140:143]
    s_add_u32 s88, s85, 2654208
    s_add_u32 m0, s84, 9216
    s_nop 0
    buffer_load_dwordx4 v216, s[52:55], s88 offen offset:0 lds
    v_mfma_f32_16x16x32_bf16 v[144:147], v[180:183], v[200:203], v[144:147]
    buffer_load_dwordx4 v217, s[52:55], s88 offen offset:1024 lds
    v_mfma_f32_16x16x32_bf16 v[148:151], v[180:183], v[204:207], v[148:151]
    buffer_load_dwordx4 v218, s[52:55], s88 offen offset:2048 lds
    v_mfma_f32_16x16x32_bf16 v[152:155], v[180:183], v[208:211], v[152:155]
    buffer_load_dwordx4 v219, s[52:55], s88 offen offset:3072 lds
    v_mfma_f32_16x16x32_bf16 v[156:159], v[180:183], v[212:215], v[156:159]
    s_waitcnt lgkmcnt(0)
    v_mfma_f32_16x16x32_bf16 v[16:19], v[160:163], v[184:187], v[16:19]
    ds_read_b64_tr_b16 v[172:173], v236 offset:96
    v_mfma_f32_16x16x32_bf16 v[20:23], v[160:163], v[188:191], v[20:23]
    ds_read_b64_tr_b16 v[174:175], v236 offset:4704
    v_mfma_f32_16x16x32_bf16 v[24:27], v[160:163], v[192:195], v[24:27]
    ds_read_b64_tr_b16 v[176:177], v236 offset:128
    v_mfma_f32_16x16x32_bf16 v[28:31], v[160:163], v[196:199], v[28:31]
    ds_read_b64_tr_b16 v[178:179], v236 offset:4736
    v_mfma_f32_16x16x32_bf16 v[32:35], v[164:167], v[184:187], v[32:35]
    ds_read_b64_tr_b16 v[180:181], v236 offset:160
    v_mfma_f32_16x16x32_bf16 v[36:39], v[164:167], v[188:191], v[36:39]
    ds_read_b64_tr_b16 v[182:183], v236 offset:4768
    v_mfma_f32_16x16x32_bf16 v[40:43], v[164:167], v[192:195], v[40:43]
    s_add_u32 m0, s84, 13312
    s_nop 0
    buffer_load_dwordx4 v220, s[52:55], s88 offen offset:0 lds
    v_mfma_f32_16x16x32_bf16 v[44:47], v[164:167], v[196:199], v[44:47]
    buffer_load_dwordx4 v221, s[52:55], s88 offen offset:1024 lds
    v_mfma_f32_16x16x32_bf16 v[48:51], v[168:171], v[184:187], v[48:51]
    buffer_load_dwordx4 v222, s[52:55], s88 offen offset:2048 lds
    v_mfma_f32_16x16x32_bf16 v[52:55], v[168:171], v[188:191], v[52:55]
    buffer_load_dwordx4 v223, s[52:55], s88 offen offset:3072 lds
    v_mfma_f32_16x16x32_bf16 v[56:59], v[168:171], v[192:195], v[56:59]
    s_add_u32 m0, s84, 17408
    s_nop 0
    buffer_load_dwordx4 v224, s[52:55], s88 offen offset:0 lds
    v_mfma_f32_16x16x32_bf16 v[60:63], v[168:171], v[196:199], v[60:63]
    s_waitcnt lgkmcnt(0)
    v_mfma_f32_16x16x32_bf16 v[64:67], v[172:175], v[184:187], v[64:67]
    ds_read_b64_tr_b16 v[160:161], v236 offset:192
    v_mfma_f32_16x16x32_bf16 v[68:71], v[172:175], v[188:191], v[68:71]
    ds_read_b64_tr_b16 v[162:163], v236 offset:4800
    v_mfma_f32_16x16x32_bf16 v[72:75], v[172:175], v[192:195], v[72:75]
    ds_read_b64_tr_b16 v[164:165], v236 offset:224
    v_mfma_f32_16x16x32_bf16 v[76:79], v[172:175], v[196:199], v[76:79]
    ds_read_b64_tr_b16 v[166:167], v236 offset:4832
    v_mfma_f32_16x16x32_bf16 v[80:83], v[176:179], v[184:187], v[80:83]
    ds_read_b64_tr_b16 v[168:169], v236 offset:256
    v_mfma_f32_16x16x32_bf16 v[84:87], v[176:179], v[188:191], v[84:87]
    v_mfma_f32_16x16x32_bf16 v[88:91], v[176:179], v[192:195], v[88:91]
    ds_read_b64_tr_b16 v[170:171], v236 offset:4864
    v_mfma_f32_16x16x32_bf16 v[92:95], v[176:179], v[196:199], v[92:95]
    ds_read_b128 v[200:203], v235 offset:512
    v_mfma_f32_16x16x32_bf16 v[96:99], v[180:183], v[184:187], v[96:99]
    ds_read_b128 v[204:207], v235 offset:18944
    v_mfma_f32_16x16x32_bf16 v[100:103], v[180:183], v[188:191], v[100:103]
    ds_read_b128 v[208:211], v235 offset:37376
    v_mfma_f32_16x16x32_bf16 v[104:107], v[180:183], v[192:195], v[104:107]
    ds_read_b128 v[212:215], v235 offset:55808
    v_mfma_f32_16x16x32_bf16 v[108:111], v[180:183], v[196:199], v[108:111]
    s_waitcnt lgkmcnt(4)
    s_waitcnt vmcnt(0)
    v_mfma_f32_16x16x32_bf16 v[112:115], v[160:163], v[184:187], v[112:115]
    ds_read_b64_tr_b16 v[172:173], v236 offset:9216
    v_mfma_f32_16x16x32_bf16 v[116:119], v[160:163], v[188:191], v[116:119]
    ds_read_b64_tr_b16 v[174:175], v236 offset:13824
    v_mfma_f32_16x16x32_bf16 v[120:123], v[160:163], v[192:195], v[120:123]
    ds_read_b64_tr_b16 v[176:177], v236 offset:9248
    v_mfma_f32_16x16x32_bf16 v[124:127], v[160:163], v[196:199], v[124:127]
    ds_read_b64_tr_b16 v[178:179], v236 offset:13856
    v_mfma_f32_16x16x32_bf16 v[128:131], v[164:167], v[184:187], v[128:131]
    ds_read_b64_tr_b16 v[180:181], v236 offset:9280
    v_mfma_f32_16x16x32_bf16 v[132:135], v[164:167], v[188:191], v[132:135]
    v_mfma_f32_16x16x32_bf16 v[136:139], v[164:167], v[192:195], v[136:139]
    ds_read_b64_tr_b16 v[182:183], v236 offset:13888
    v_mfma_f32_16x16x32_bf16 v[140:143], v[164:167], v[196:199], v[140:143]
    s_add_u32 s88, s85, 2949120
    s_add_u32 m0, s84, 0
    s_nop 0
    buffer_load_dwordx4 v216, s[52:55], s88 offen offset:0 lds
    v_mfma_f32_16x16x32_bf16 v[144:147], v[168:171], v[184:187], v[144:147]
    buffer_load_dwordx4 v217, s[52:55], s88 offen offset:1024 lds
    v_mfma_f32_16x16x32_bf16 v[148:151], v[168:171], v[188:191], v[148:151]
    buffer_load_dwordx4 v218, s[52:55], s88 offen offset:2048 lds
    v_mfma_f32_16x16x32_bf16 v[152:155], v[168:171], v[192:195], v[152:155]
    buffer_load_dwordx4 v219, s[52:55], s88 offen offset:3072 lds
    v_mfma_f32_16x16x32_bf16 v[156:159], v[168:171], v[196:199], v[156:159]
    s_waitcnt lgkmcnt(0)
    v_mfma_f32_16x16x32_bf16 v[16:19], v[172:175], v[200:203], v[16:19]
    ds_read_b64_tr_b16 v[160:161], v236 offset:9312
    v_mfma_f32_16x16x32_bf16 v[20:23], v[172:175], v[204:207], v[20:23]
    ds_read_b64_tr_b16 v[162:163], v236 offset:13920
    v_mfma_f32_16x16x32_bf16 v[24:27], v[172:175], v[208:211], v[24:27]
    ds_read_b64_tr_b16 v[164:165], v236 offset:9344
    v_mfma_f32_16x16x32_bf16 v[28:31], v[172:175], v[212:215], v[28:31]
    ds_read_b64_tr_b16 v[166:167], v236 offset:13952
    v_mfma_f32_16x16x32_bf16 v[32:35], v[176:179], v[200:203], v[32:35]
    ds_read_b64_tr_b16 v[168:169], v236 offset:9376
    v_mfma_f32_16x16x32_bf16 v[36:39], v[176:179], v[204:207], v[36:39]
    ds_read_b64_tr_b16 v[170:171], v236 offset:13984
    v_mfma_f32_16x16x32_bf16 v[40:43], v[176:179], v[208:211], v[40:43]
    s_add_u32 m0, s84, 4096
    s_nop 0
    buffer_load_dwordx4 v220, s[52:55], s88 offen offset:0 lds
    v_mfma_f32_16x16x32_bf16 v[44:47], v[176:179], v[212:215], v[44:47]
    buffer_load_dwordx4 v221, s[52:55], s88 offen offset:1024 lds
    v_mfma_f32_16x16x32_bf16 v[48:51], v[180:183], v[200:203], v[48:51]
    buffer_load_dwordx4 v222, s[52:55], s88 offen offset:2048 lds
    v_mfma_f32_16x16x32_bf16 v[52:55], v[180:183], v[204:207], v[52:55]
    buffer_load_dwordx4 v223, s[52:55], s88 offen offset:3072 lds
    v_mfma_f32_16x16x32_bf16 v[56:59], v[180:183], v[208:211], v[56:59]
    s_add_u32 m0, s84, 8192
    s_nop 0
    buffer_load_dwordx4 v224, s[52:55], s88 offen offset:0 lds
    v_mfma_f32_16x16x32_bf16 v[60:63], v[180:183], v[212:215], v[60:63]
    s_waitcnt lgkmcnt(0)
    v_mfma_f32_16x16x32_bf16 v[64:67], v[160:163], v[200:203], v[64:67]
    ds_read_b64_tr_b16 v[172:173], v236 offset:9408
    v_mfma_f32_16x16x32_bf16 v[68:71], v[160:163], v[204:207], v[68:71]
    ds_read_b64_tr_b16 v[174:175], v236 offset:14016
    v_mfma_f32_16x16x32_bf16 v[72:75], v[160:163], v[208:211], v[72:75]
    ds_read_b64_tr_b16 v[176:177], v236 offset:9440
    v_mfma_f32_16x16x32_bf16 v[76:79], v[160:163], v[212:215], v[76:79]
    ds_read_b64_tr_b16 v[178:179], v236 offset:14048
    v_mfma_f32_16x16x32_bf16 v[80:83], v[164:167], v[200:203], v[80:83]
    ds_read_b64_tr_b16 v[180:181], v236 offset:9472
    v_mfma_f32_16x16x32_bf16 v[84:87], v[164:167], v[204:207], v[84:87]
    v_mfma_f32_16x16x32_bf16 v[88:91], v[164:167], v[208:211], v[88:91]
    ds_read_b64_tr_b16 v[182:183], v236 offset:14080
    v_mfma_f32_16x16x32_bf16 v[92:95], v[164:167], v[212:215], v[92:95]
    ds_read_b128 v[184:187], v234 offset:640
    v_mfma_f32_16x16x32_bf16 v[96:99], v[168:171], v[200:203], v[96:99]
    ds_read_b128 v[188:191], v234 offset:19072
    v_mfma_f32_16x16x32_bf16 v[100:103], v[168:171], v[204:207], v[100:103]
    ds_read_b128 v[192:195], v234 offset:37504
    v_mfma_f32_16x16x32_bf16 v[104:107], v[168:171], v[208:211], v[104:107]
    ds_read_b128 v[196:199], v234 offset:55936
    v_mfma_f32_16x16x32_bf16 v[108:111], v[168:171], v[212:215], v[108:111]
    s_waitcnt lgkmcnt(4)
    s_waitcnt vmcnt(0)
    v_mfma_f32_16x16x32_bf16 v[112:115], v[172:175], v[200:203], v[112:115]
    ds_read_b64_tr_b16 v[160:161], v236 offset:0
    v_mfma_f32_16x16x32_bf16 v[116:119], v[172:175], v[204:207], v[116:119]
    ds_read_b64_tr_b16 v[162:163], v236 offset:4608
    v_mfma_f32_16x16x32_bf16 v[120:123], v[172:175], v[208:211], v[120:123]
    ds_read_b64_tr_b16 v[164:165], v236 offset:32
    v_mfma_f32_16x16x32_bf16 v[124:127], v[172:175], v[212:215], v[124:127]
    ds_read_b64_tr_b16 v[166:167], v236 offset:4640
    v_mfma_f32_16x16x32_bf16 v[128:131], v[176:179], v[200:203], v[128:131]
    ds_read_b64_tr_b16 v[168:169], v236 offset:64
    v_mfma_f32_16x16x32_bf16 v[132:135], v[176:179], v[204:207], v[132:135]
    v_mfma_f32_16x16x32_bf16 v[136:139], v[176:179], v[208:211], v[136:139]
    ds_read_b64_tr_b16 v[170:171], v236 offset:4672
    v_mfma_f32_16x16x32_bf16 v[140:143], v[176:179], v[212:215], v[140:143]
    s_add_u32 s88, s85, 3244032
    s_add_u32 m0, s84, 9216
    s_nop 0
    buffer_load_dwordx4 v216, s[52:55], s88 offen offset:0 lds
    v_mfma_f32_16x16x32_bf16 v[144:147], v[180:183], v[200:203], v[144:147]
    buffer_load_dwordx4 v217, s[52:55], s88 offen offset:1024 lds
    v_mfma_f32_16x16x32_bf16 v[148:151], v[180:183], v[204:207], v[148:151]
    buffer_load_dwordx4 v218, s[52:55], s88 offen offset:2048 lds
    v_mfma_f32_16x16x32_bf16 v[152:155], v[180:183], v[208:211], v[152:155]
    buffer_load_dwordx4 v219, s[52:55], s88 offen offset:3072 lds
    v_mfma_f32_16x16x32_bf16 v[156:159], v[180:183], v[212:215], v[156:159]
    s_waitcnt lgkmcnt(0)
    v_mfma_f32_16x16x32_bf16 v[16:19], v[160:163], v[184:187], v[16:19]
    ds_read_b64_tr_b16 v[172:173], v236 offset:96
    v_mfma_f32_16x16x32_bf16 v[20:23], v[160:163], v[188:191], v[20:23]
    ds_read_b64_tr_b16 v[174:175], v236 offset:4704
    v_mfma_f32_16x16x32_bf16 v[24:27], v[160:163], v[192:195], v[24:27]
    ds_read_b64_tr_b16 v[176:177], v236 offset:128
    v_mfma_f32_16x16x32_bf16 v[28:31], v[160:163], v[196:199], v[28:31]
    ds_read_b64_tr_b16 v[178:179], v236 offset:4736
    v_mfma_f32_16x16x32_bf16 v[32:35], v[164:167], v[184:187], v[32:35]
    ds_read_b64_tr_b16 v[180:181], v236 offset:160
    v_mfma_f32_16x16x32_bf16 v[36:39], v[164:167], v[188:191], v[36:39]
    ds_read_b64_tr_b16 v[182:183], v236 offset:4768
    v_mfma_f32_16x16x32_bf16 v[40:43], v[164:167], v[192:195], v[40:43]
    s_add_u32 m0, s84, 13312
    s_nop 0
    buffer_load_dwordx4 v220, s[52:55], s88 offen offset:0 lds
    v_mfma_f32_16x16x32_bf16 v[44:47], v[164:167], v[196:199], v[44:47]
    buffer_load_dwordx4 v221, s[52:55], s88 offen offset:1024 lds
    v_mfma_f32_16x16x32_bf16 v[48:51], v[168:171], v[184:187], v[48:51]
    buffer_load_dwordx4 v222, s[52:55], s88 offen offset:2048 lds
    v_mfma_f32_16x16x32_bf16 v[52:55], v[168:171], v[188:191], v[52:55]
    buffer_load_dwordx4 v223, s[52:55], s88 offen offset:3072 lds
    v_mfma_f32_16x16x32_bf16 v[56:59], v[168:171], v[192:195], v[56:59]
    s_add_u32 m0, s84, 17408
    s_nop 0
    buffer_load_dwordx4 v224, s[52:55], s88 offen offset:0 lds
    v_mfma_f32_16x16x32_bf16 v[60:63], v[168:171], v[196:199], v[60:63]
    s_waitcnt lgkmcnt(0)
    v_mfma_f32_16x16x32_bf16 v[64:67], v[172:175], v[184:187], v[64:67]
    ds_read_b64_tr_b16 v[160:161], v236 offset:192
    v_mfma_f32_16x16x32_bf16 v[68:71], v[172:175], v[188:191], v[68:71]
    ds_read_b64_tr_b16 v[162:163], v236 offset:4800
    v_mfma_f32_16x16x32_bf16 v[72:75], v[172:175], v[192:195], v[72:75]
    ds_read_b64_tr_b16 v[164:165], v236 offset:224
    v_mfma_f32_16x16x32_bf16 v[76:79], v[172:175], v[196:199], v[76:79]
    ds_read_b64_tr_b16 v[166:167], v236 offset:4832
    v_mfma_f32_16x16x32_bf16 v[80:83], v[176:179], v[184:187], v[80:83]
    ds_read_b64_tr_b16 v[168:169], v236 offset:256
    v_mfma_f32_16x16x32_bf16 v[84:87], v[176:179], v[188:191], v[84:87]
    v_mfma_f32_16x16x32_bf16 v[88:91], v[176:179], v[192:195], v[88:91]
    ds_read_b64_tr_b16 v[170:171], v236 offset:4864
    v_mfma_f32_16x16x32_bf16 v[92:95], v[176:179], v[196:199], v[92:95]
    ds_read_b128 v[200:203], v235 offset:640
    v_mfma_f32_16x16x32_bf16 v[96:99], v[180:183], v[184:187], v[96:99]
    ds_read_b128 v[204:207], v235 offset:19072
    v_mfma_f32_16x16x32_bf16 v[100:103], v[180:183], v[188:191], v[100:103]
    ds_read_b128 v[208:211], v235 offset:37504
    v_mfma_f32_16x16x32_bf16 v[104:107], v[180:183], v[192:195], v[104:107]
    ds_read_b128 v[212:215], v235 offset:55936
    v_mfma_f32_16x16x32_bf16 v[108:111], v[180:183], v[196:199], v[108:111]
    s_waitcnt lgkmcnt(4)
    s_waitcnt vmcnt(0)
    v_mfma_f32_16x16x32_bf16 v[112:115], v[160:163], v[184:187], v[112:115]
    ds_read_b64_tr_b16 v[172:173], v236 offset:9216
    v_mfma_f32_16x16x32_bf16 v[116:119], v[160:163], v[188:191], v[116:119]
    ds_read_b64_tr_b16 v[174:175], v236 offset:13824
    v_mfma_f32_16x16x32_bf16 v[120:123], v[160:163], v[192:195], v[120:123]
    ds_read_b64_tr_b16 v[176:177], v236 offset:9248
    v_mfma_f32_16x16x32_bf16 v[124:127], v[160:163], v[196:199], v[124:127]
    ds_read_b64_tr_b16 v[178:179], v236 offset:13856
    v_mfma_f32_16x16x32_bf16 v[128:131], v[164:167], v[184:187], v[128:131]
    ds_read_b64_tr_b16 v[180:181], v236 offset:9280
    v_mfma_f32_16x16x32_bf16 v[132:135], v[164:167], v[188:191], v[132:135]
    v_mfma_f32_16x16x32_bf16 v[136:139], v[164:167], v[192:195], v[136:139]
    ds_read_b64_tr_b16 v[182:183], v236 offset:13888
    v_mfma_f32_16x16x32_bf16 v[140:143], v[164:167], v[196:199], v[140:143]
    s_add_u32 s88, s85, 3538944
    s_add_u32 m0, s84, 0
    s_nop 0
    buffer_load_dwordx4 v216, s[52:55], s88 offen offset:0 lds
    v_mfma_f32_16x16x32_bf16 v[144:147], v[168:171], v[184:187], v[144:147]
    buffer_load_dwordx4 v217, s[52:55], s88 offen offset:1024 lds
    v_mfma_f32_16x16x32_bf16 v[148:151], v[168:171], v[188:191], v[148:151]
    buffer_load_dwordx4 v218, s[52:55], s88 offen offset:2048 lds
    v_mfma_f32_16x16x32_bf16 v[152:155], v[168:171], v[192:195], v[152:155]
    buffer_load_dwordx4 v219, s[52:55], s88 offen offset:3072 lds
    v_mfma_f32_16x16x32_bf16 v[156:159], v[168:171], v[196:199], v[156:159]
    s_waitcnt lgkmcnt(0)
    v_mfma_f32_16x16x32_bf16 v[16:19], v[172:175], v[200:203], v[16:19]
    ds_read_b64_tr_b16 v[160:161], v236 offset:9312
    v_mfma_f32_16x16x32_bf16 v[20:23], v[172:175], v[204:207], v[20:23]
    ds_read_b64_tr_b16 v[162:163], v236 offset:13920
    v_mfma_f32_16x16x32_bf16 v[24:27], v[172:175], v[208:211], v[24:27]
    ds_read_b64_tr_b16 v[164:165], v236 offset:9344
    v_mfma_f32_16x16x32_bf16 v[28:31], v[172:175], v[212:215], v[28:31]
    ds_read_b64_tr_b16 v[166:167], v236 offset:13952
    v_mfma_f32_16x16x32_bf16 v[32:35], v[176:179], v[200:203], v[32:35]
    ds_read_b64_tr_b16 v[168:169], v236 offset:9376
    v_mfma_f32_16x16x32_bf16 v[36:39], v[176:179], v[204:207], v[36:39]
    ds_read_b64_tr_b16 v[170:171], v236 offset:13984
    v_mfma_f32_16x16x32_bf16 v[40:43], v[176:179], v[208:211], v[40:43]
    s_add_u32 m0, s84, 4096
    s_nop 0
    buffer_load_dwordx4 v220, s[52:55], s88 offen offset:0 lds
    v_mfma_f32_16x16x32_bf16 v[44:47], v[176:179], v[212:215], v[44:47]
    buffer_load_dwordx4 v221, s[52:55], s88 offen offset:1024 lds
    v_mfma_f32_16x16x32_bf16 v[48:51], v[180:183], v[200:203], v[48:51]
    buffer_load_dwordx4 v222, s[52:55], s88 offen offset:2048 lds
    v_mfma_f32_16x16x32_bf16 v[52:55], v[180:183], v[204:207], v[52:55]
    buffer_load_dwordx4 v223, s[52:55], s88 offen offset:3072 lds
    v_mfma_f32_16x16x32_bf16 v[56:59], v[180:183], v[208:211], v[56:59]
    s_add_u32 m0, s84, 8192
    s_nop 0
    buffer_load_dwordx4 v224, s[52:55], s88 offen offset:0 lds
    v_mfma_f32_16x16x32_bf16 v[60:63], v[180:183], v[212:215], v[60:63]
    s_waitcnt lgkmcnt(0)
    v_mfma_f32_16x16x32_bf16 v[64:67], v[160:163], v[200:203], v[64:67]
    ds_read_b64_tr_b16 v[172:173], v236 offset:9408
    v_mfma_f32_16x16x32_bf16 v[68:71], v[160:163], v[204:207], v[68:71]
    ds_read_b64_tr_b16 v[174:175], v236 offset:14016
    v_mfma_f32_16x16x32_bf16 v[72:75], v[160:163], v[208:211], v[72:75]
    ds_read_b64_tr_b16 v[176:177], v236 offset:9440
    v_mfma_f32_16x16x32_bf16 v[76:79], v[160:163], v[212:215], v[76:79]
    ds_read_b64_tr_b16 v[178:179], v236 offset:14048
    v_mfma_f32_16x16x32_bf16 v[80:83], v[164:167], v[200:203], v[80:83]
    ds_read_b64_tr_b16 v[180:181], v236 offset:9472
    v_mfma_f32_16x16x32_bf16 v[84:87], v[164:167], v[204:207], v[84:87]
    v_mfma_f32_16x16x32_bf16 v[88:91], v[164:167], v[208:211], v[88:91]
    ds_read_b64_tr_b16 v[182:183], v236 offset:14080
    v_mfma_f32_16x16x32_bf16 v[92:95], v[164:167], v[212:215], v[92:95]
    ds_read_b128 v[184:187], v234 offset:768
    v_mfma_f32_16x16x32_bf16 v[96:99], v[168:171], v[200:203], v[96:99]
    ds_read_b128 v[188:191], v234 offset:19200
    v_mfma_f32_16x16x32_bf16 v[100:103], v[168:171], v[204:207], v[100:103]
    ds_read_b128 v[192:195], v234 offset:37632
    v_mfma_f32_16x16x32_bf16 v[104:107], v[168:171], v[208:211], v[104:107]
    ds_read_b128 v[196:199], v234 offset:56064
    v_mfma_f32_16x16x32_bf16 v[108:111], v[168:171], v[212:215], v[108:111]
    s_waitcnt lgkmcnt(4)
    s_waitcnt vmcnt(0)
    v_mfma_f32_16x16x32_bf16 v[112:115], v[172:175], v[200:203], v[112:115]
    ds_read_b64_tr_b16 v[160:161], v236 offset:0
    v_mfma_f32_16x16x32_bf16 v[116:119], v[172:175], v[204:207], v[116:119]
    ds_read_b64_tr_b16 v[162:163], v236 offset:4608
    v_mfma_f32_16x16x32_bf16 v[120:123], v[172:175], v[208:211], v[120:123]
    ds_read_b64_tr_b16 v[164:165], v236 offset:32
    v_mfma_f32_16x16x32_bf16 v[124:127], v[172:175], v[212:215], v[124:127]
    ds_read_b64_tr_b16 v[166:167], v236 offset:4640
    v_mfma_f32_16x16x32_bf16 v[128:131], v[176:179], v[200:203], v[128:131]
    ds_read_b64_tr_b16 v[168:169], v236 offset:64
    v_mfma_f32_16x16x32_bf16 v[132:135], v[176:179], v[204:207], v[132:135]
    v_mfma_f32_16x16x32_bf16 v[136:139], v[176:179], v[208:211], v[136:139]
    ds_read_b64_tr_b16 v[170:171], v236 offset:4672
    v_mfma_f32_16x16x32_bf16 v[140:143], v[176:179], v[212:215], v[140:143]
    s_add_u32 s88, s85, 3833856
    s_add_u32 m0, s84, 9216
    s_nop 0
    buffer_load_dwordx4 v216, s[52:55], s88 offen offset:0 lds
    v_mfma_f32_16x16x32_bf16 v[144:147], v[180:183], v[200:203], v[144:147]
    buffer_load_dwordx4 v217, s[52:55], s88 offen offset:1024 lds
    v_mfma_f32_16x16x32_bf16 v[148:151], v[180:183], v[204:207], v[148:151]
    buffer_load_dwordx4 v218, s[52:55], s88 offen offset:2048 lds
    v_mfma_f32_16x16x32_bf16 v[152:155], v[180:183], v[208:211], v[152:155]
    buffer_load_dwordx4 v219, s[52:55], s88 offen offset:3072 lds
    v_mfma_f32_16x16x32_bf16 v[156:159], v[180:183], v[212:215], v[156:159]
    s_waitcnt lgkmcnt(0)
    v_mfma_f32_16x16x32_bf16 v[16:19], v[160:163], v[184:187], v[16:19]
    ds_read_b64_tr_b16 v[172:173], v236 offset:96
    v_mfma_f32_16x16x32_bf16 v[20:23], v[160:163], v[188:191], v[20:23]
    ds_read_b64_tr_b16 v[174:175], v236 offset:4704
    v_mfma_f32_16x16x32_bf16 v[24:27], v[160:163], v[192:195], v[24:27]
    ds_read_b64_tr_b16 v[176:177], v236 offset:128
    v_mfma_f32_16x16x32_bf16 v[28:31], v[160:163], v[196:199], v[28:31]
    ds_read_b64_tr_b16 v[178:179], v236 offset:4736
    v_mfma_f32_16x16x32_bf16 v[32:35], v[164:167], v[184:187], v[32:35]
    ds_read_b64_tr_b16 v[180:181], v236 offset:160
    v_mfma_f32_16x16x32_bf16 v[36:39], v[164:167], v[188:191], v[36:39]
    ds_read_b64_tr_b16 v[182:183], v236 offset:4768
    v_mfma_f32_16x16x32_bf16 v[40:43], v[164:167], v[192:195], v[40:43]
    s_add_u32 m0, s84, 13312
    s_nop 0
    buffer_load_dwordx4 v220, s[52:55], s88 offen offset:0 lds
    v_mfma_f32_16x16x32_bf16 v[44:47], v[164:167], v[196:199], v[44:47]
    buffer_load_dwordx4 v221, s[52:55], s88 offen offset:1024 lds
    v_mfma_f32_16x16x32_bf16 v[48:51], v[168:171], v[184:187], v[48:51]
    buffer_load_dwordx4 v222, s[52:55], s88 offen offset:2048 lds
    v_mfma_f32_16x16x32_bf16 v[52:55], v[168:171], v[188:191], v[52:55]
    buffer_load_dwordx4 v223, s[52:55], s88 offen offset:3072 lds
    v_mfma_f32_16x16x32_bf16 v[56:59], v[168:171], v[192:195], v[56:59]
    s_add_u32 m0, s84, 17408
    s_nop 0
    buffer_load_dwordx4 v224, s[52:55], s88 offen offset:0 lds
    v_mfma_f32_16x16x32_bf16 v[60:63], v[168:171], v[196:199], v[60:63]
    s_waitcnt lgkmcnt(0)
    v_mfma_f32_16x16x32_bf16 v[64:67], v[172:175], v[184:187], v[64:67]
    ds_read_b64_tr_b16 v[160:161], v236 offset:192
    v_mfma_f32_16x16x32_bf16 v[68:71], v[172:175], v[188:191], v[68:71]
    ds_read_b64_tr_b16 v[162:163], v236 offset:4800
    v_mfma_f32_16x16x32_bf16 v[72:75], v[172:175], v[192:195], v[72:75]
    ds_read_b64_tr_b16 v[164:165], v236 offset:224
    v_mfma_f32_16x16x32_bf16 v[76:79], v[172:175], v[196:199], v[76:79]
    ds_read_b64_tr_b16 v[166:167], v236 offset:4832
    v_mfma_f32_16x16x32_bf16 v[80:83], v[176:179], v[184:187], v[80:83]
    ds_read_b64_tr_b16 v[168:169], v236 offset:256
    v_mfma_f32_16x16x32_bf16 v[84:87], v[176:179], v[188:191], v[84:87]
    v_mfma_f32_16x16x32_bf16 v[88:91], v[176:179], v[192:195], v[88:91]
    ds_read_b64_tr_b16 v[170:171], v236 offset:4864
    v_mfma_f32_16x16x32_bf16 v[92:95], v[176:179], v[196:199], v[92:95]
    ds_read_b128 v[200:203], v235 offset:768
    v_mfma_f32_16x16x32_bf16 v[96:99], v[180:183], v[184:187], v[96:99]
    ds_read_b128 v[204:207], v235 offset:19200
    v_mfma_f32_16x16x32_bf16 v[100:103], v[180:183], v[188:191], v[100:103]
    ds_read_b128 v[208:211], v235 offset:37632
    v_mfma_f32_16x16x32_bf16 v[104:107], v[180:183], v[192:195], v[104:107]
    ds_read_b128 v[212:215], v235 offset:56064
    v_mfma_f32_16x16x32_bf16 v[108:111], v[180:183], v[196:199], v[108:111]
    s_waitcnt lgkmcnt(4)
    s_waitcnt vmcnt(0)
    v_mfma_f32_16x16x32_bf16 v[112:115], v[160:163], v[184:187], v[112:115]
    ds_read_b64_tr_b16 v[172:173], v236 offset:9216
    v_mfma_f32_16x16x32_bf16 v[116:119], v[160:163], v[188:191], v[116:119]
    ds_read_b64_tr_b16 v[174:175], v236 offset:13824
    v_mfma_f32_16x16x32_bf16 v[120:123], v[160:163], v[192:195], v[120:123]
    ds_read_b64_tr_b16 v[176:177], v236 offset:9248
    v_mfma_f32_16x16x32_bf16 v[124:127], v[160:163], v[196:199], v[124:127]
    ds_read_b64_tr_b16 v[178:179], v236 offset:13856
    v_mfma_f32_16x16x32_bf16 v[128:131], v[164:167], v[184:187], v[128:131]
    ds_read_b64_tr_b16 v[180:181], v236 offset:9280
    v_mfma_f32_16x16x32_bf16 v[132:135], v[164:167], v[188:191], v[132:135]
    v_mfma_f32_16x16x32_bf16 v[136:139], v[164:167], v[192:195], v[136:139]
    ds_read_b64_tr_b16 v[182:183], v236 offset:13888
    v_mfma_f32_16x16x32_bf16 v[140:143], v[164:167], v[196:199], v[140:143]
    s_add_u32 s88, s85, 4128768
    s_add_u32 m0, s84, 0
    s_nop 0
    buffer_load_dwordx4 v216, s[52:55], s88 offen offset:0 lds
    v_mfma_f32_16x16x32_bf16 v[144:147], v[168:171], v[184:187], v[144:147]
    buffer_load_dwordx4 v217, s[52:55], s88 offen offset:1024 lds
    v_mfma_f32_16x16x32_bf16 v[148:151], v[168:171], v[188:191], v[148:151]
    buffer_load_dwordx4 v218, s[52:55], s88 offen offset:2048 lds
    v_mfma_f32_16x16x32_bf16 v[152:155], v[168:171], v[192:195], v[152:155]
    buffer_load_dwordx4 v219, s[52:55], s88 offen offset:3072 lds
    v_mfma_f32_16x16x32_bf16 v[156:159], v[168:171], v[196:199], v[156:159]
    s_waitcnt lgkmcnt(0)
    v_mfma_f32_16x16x32_bf16 v[16:19], v[172:175], v[200:203], v[16:19]
    ds_read_b64_tr_b16 v[160:161], v236 offset:9312
    v_mfma_f32_16x16x32_bf16 v[20:23], v[172:175], v[204:207], v[20:23]
    ds_read_b64_tr_b16 v[162:163], v236 offset:13920
    v_mfma_f32_16x16x32_bf16 v[24:27], v[172:175], v[208:211], v[24:27]
    ds_read_b64_tr_b16 v[164:165], v236 offset:9344
    v_mfma_f32_16x16x32_bf16 v[28:31], v[172:175], v[212:215], v[28:31]
    ds_read_b64_tr_b16 v[166:167], v236 offset:13952
    v_mfma_f32_16x16x32_bf16 v[32:35], v[176:179], v[200:203], v[32:35]
    ds_read_b64_tr_b16 v[168:169], v236 offset:9376
    v_mfma_f32_16x16x32_bf16 v[36:39], v[176:179], v[204:207], v[36:39]
    ds_read_b64_tr_b16 v[170:171], v236 offset:13984
    v_mfma_f32_16x16x32_bf16 v[40:43], v[176:179], v[208:211], v[40:43]
    s_add_u32 m0, s84, 4096
    s_nop 0
    buffer_load_dwordx4 v220, s[52:55], s88 offen offset:0 lds
    v_mfma_f32_16x16x32_bf16 v[44:47], v[176:179], v[212:215], v[44:47]
    buffer_load_dwordx4 v221, s[52:55], s88 offen offset:1024 lds
    v_mfma_f32_16x16x32_bf16 v[48:51], v[180:183], v[200:203], v[48:51]
    buffer_load_dwordx4 v222, s[52:55], s88 offen offset:2048 lds
    v_mfma_f32_16x16x32_bf16 v[52:55], v[180:183], v[204:207], v[52:55]
    buffer_load_dwordx4 v223, s[52:55], s88 offen offset:3072 lds
    v_mfma_f32_16x16x32_bf16 v[56:59], v[180:183], v[208:211], v[56:59]
    s_add_u32 m0, s84, 8192
    s_nop 0
    buffer_load_dwordx4 v224, s[52:55], s88 offen offset:0 lds
    v_mfma_f32_16x16x32_bf16 v[60:63], v[180:183], v[212:215], v[60:63]
    s_waitcnt lgkmcnt(0)
    v_mfma_f32_16x16x32_bf16 v[64:67], v[160:163], v[200:203], v[64:67]
    ds_read_b64_tr_b16 v[172:173], v236 offset:9408
    v_mfma_f32_16x16x32_bf16 v[68:71], v[160:163], v[204:207], v[68:71]
    ds_read_b64_tr_b16 v[174:175], v236 offset:14016
    v_mfma_f32_16x16x32_bf16 v[72:75], v[160:163], v[208:211], v[72:75]
    ds_read_b64_tr_b16 v[176:177], v236 offset:9440
    v_mfma_f32_16x16x32_bf16 v[76:79], v[160:163], v[212:215], v[76:79]
    ds_read_b64_tr_b16 v[178:179], v236 offset:14048
    v_mfma_f32_16x16x32_bf16 v[80:83], v[164:167], v[200:203], v[80:83]
    ds_read_b64_tr_b16 v[180:181], v236 offset:9472
    v_mfma_f32_16x16x32_bf16 v[84:87], v[164:167], v[204:207], v[84:87]
    v_mfma_f32_16x16x32_bf16 v[88:91], v[164:167], v[208:211], v[88:91]
    ds_read_b64_tr_b16 v[182:183], v236 offset:14080
    v_mfma_f32_16x16x32_bf16 v[92:95], v[164:167], v[212:215], v[92:95]
    ds_read_b128 v[184:187], v234 offset:896
    v_mfma_f32_16x16x32_bf16 v[96:99], v[168:171], v[200:203], v[96:99]
    ds_read_b128 v[188:191], v234 offset:19328
    v_mfma_f32_16x16x32_bf16 v[100:103], v[168:171], v[204:207], v[100:103]
    ds_read_b128 v[192:195], v234 offset:37760
    v_mfma_f32_16x16x32_bf16 v[104:107], v[168:171], v[208:211], v[104:107]
    ds_read_b128 v[196:199], v234 offset:56192
    v_mfma_f32_16x16x32_bf16 v[108:111], v[168:171], v[212:215], v[108:111]
    s_waitcnt lgkmcnt(4)
    s_waitcnt vmcnt(0)
    v_mfma_f32_16x16x32_bf16 v[112:115], v[172:175], v[200:203], v[112:115]
    ds_read_b64_tr_b16 v[160:161], v236 offset:0
    v_mfma_f32_16x16x32_bf16 v[116:119], v[172:175], v[204:207], v[116:119]
    ds_read_b64_tr_b16 v[162:163], v236 offset:4608
    v_mfma_f32_16x16x32_bf16 v[120:123], v[172:175], v[208:211], v[120:123]
    ds_read_b64_tr_b16 v[164:165], v236 offset:32
    v_mfma_f32_16x16x32_bf16 v[124:127], v[172:175], v[212:215], v[124:127]
    ds_read_b64_tr_b16 v[166:167], v236 offset:4640
    v_mfma_f32_16x16x32_bf16 v[128:131], v[176:179], v[200:203], v[128:131]
    ds_read_b64_tr_b16 v[168:169], v236 offset:64
    v_mfma_f32_16x16x32_bf16 v[132:135], v[176:179], v[204:207], v[132:135]
    v_mfma_f32_16x16x32_bf16 v[136:139], v[176:179], v[208:211], v[136:139]
    ds_read_b64_tr_b16 v[170:171], v236 offset:4672
    v_mfma_f32_16x16x32_bf16 v[140:143], v[176:179], v[212:215], v[140:143]
    s_add_u32 s88, s85, 4423680
    s_add_u32 m0, s84, 9216
    s_nop 0
    buffer_load_dwordx4 v216, s[52:55], s88 offen offset:0 lds
    v_mfma_f32_16x16x32_bf16 v[144:147], v[180:183], v[200:203], v[144:147]
    buffer_load_dwordx4 v217, s[52:55], s88 offen offset:1024 lds
    v_mfma_f32_16x16x32_bf16 v[148:151], v[180:183], v[204:207], v[148:151]
    buffer_load_dwordx4 v218, s[52:55], s88 offen offset:2048 lds
    v_mfma_f32_16x16x32_bf16 v[152:155], v[180:183], v[208:211], v[152:155]
    buffer_load_dwordx4 v219, s[52:55], s88 offen offset:3072 lds
    v_mfma_f32_16x16x32_bf16 v[156:159], v[180:183], v[212:215], v[156:159]
    s_waitcnt lgkmcnt(0)
    v_mfma_f32_16x16x32_bf16 v[16:19], v[160:163], v[184:187], v[16:19]
    ds_read_b64_tr_b16 v[172:173], v236 offset:96
    v_mfma_f32_16x16x32_bf16 v[20:23], v[160:163], v[188:191], v[20:23]
    ds_read_b64_tr_b16 v[174:175], v236 offset:4704
    v_mfma_f32_16x16x32_bf16 v[24:27], v[160:163], v[192:195], v[24:27]
    ds_read_b64_tr_b16 v[176:177], v236 offset:128
    v_mfma_f32_16x16x32_bf16 v[28:31], v[160:163], v[196:199], v[28:31]
    ds_read_b64_tr_b16 v[178:179], v236 offset:4736
    v_mfma_f32_16x16x32_bf16 v[32:35], v[164:167], v[184:187], v[32:35]
    ds_read_b64_tr_b16 v[180:181], v236 offset:160
    v_mfma_f32_16x16x32_bf16 v[36:39], v[164:167], v[188:191], v[36:39]
    ds_read_b64_tr_b16 v[182:183], v236 offset:4768
    v_mfma_f32_16x16x32_bf16 v[40:43], v[164:167], v[192:195], v[40:43]
    s_add_u32 m0, s84, 13312
    s_nop 0
    buffer_load_dwordx4 v220, s[52:55], s88 offen offset:0 lds
    v_mfma_f32_16x16x32_bf16 v[44:47], v[164:167], v[196:199], v[44:47]
    buffer_load_dwordx4 v221, s[52:55], s88 offen offset:1024 lds
    v_mfma_f32_16x16x32_bf16 v[48:51], v[168:171], v[184:187], v[48:51]
    buffer_load_dwordx4 v222, s[52:55], s88 offen offset:2048 lds
    v_mfma_f32_16x16x32_bf16 v[52:55], v[168:171], v[188:191], v[52:55]
    buffer_load_dwordx4 v223, s[52:55], s88 offen offset:3072 lds
    v_mfma_f32_16x16x32_bf16 v[56:59], v[168:171], v[192:195], v[56:59]
    s_add_u32 m0, s84, 17408
    s_nop 0
    buffer_load_dwordx4 v224, s[52:55], s88 offen offset:0 lds
    v_mfma_f32_16x16x32_bf16 v[60:63], v[168:171], v[196:199], v[60:63]
    s_waitcnt lgkmcnt(0)
    v_mfma_f32_16x16x32_bf16 v[64:67], v[172:175], v[184:187], v[64:67]
    ds_read_b64_tr_b16 v[160:161], v236 offset:192
    v_mfma_f32_16x16x32_bf16 v[68:71], v[172:175], v[188:191], v[68:71]
    ds_read_b64_tr_b16 v[162:163], v236 offset:4800
    v_mfma_f32_16x16x32_bf16 v[72:75], v[172:175], v[192:195], v[72:75]
    ds_read_b64_tr_b16 v[164:165], v236 offset:224
    v_mfma_f32_16x16x32_bf16 v[76:79], v[172:175], v[196:199], v[76:79]
    ds_read_b64_tr_b16 v[166:167], v236 offset:4832
    v_mfma_f32_16x16x32_bf16 v[80:83], v[176:179], v[184:187], v[80:83]
    ds_read_b64_tr_b16 v[168:169], v236 offset:256
    v_mfma_f32_16x16x32_bf16 v[84:87], v[176:179], v[188:191], v[84:87]
    v_mfma_f32_16x16x32_bf16 v[88:91], v[176:179], v[192:195], v[88:91]
    ds_read_b64_tr_b16 v[170:171], v236 offset:4864
    v_mfma_f32_16x16x32_bf16 v[92:95], v[176:179], v[196:199], v[92:95]
    ds_read_b128 v[200:203], v235 offset:896
    v_mfma_f32_16x16x32_bf16 v[96:99], v[180:183], v[184:187], v[96:99]
    ds_read_b128 v[204:207], v235 offset:19328
    v_mfma_f32_16x16x32_bf16 v[100:103], v[180:183], v[188:191], v[100:103]
    ds_read_b128 v[208:211], v235 offset:37760
    v_mfma_f32_16x16x32_bf16 v[104:107], v[180:183], v[192:195], v[104:107]
    ds_read_b128 v[212:215], v235 offset:56192
    v_mfma_f32_16x16x32_bf16 v[108:111], v[180:183], v[196:199], v[108:111]
    s_waitcnt lgkmcnt(4)
    s_waitcnt vmcnt(0)
    v_mfma_f32_16x16x32_bf16 v[112:115], v[160:163], v[184:187], v[112:115]
    ds_read_b64_tr_b16 v[172:173], v236 offset:9216
    v_mfma_f32_16x16x32_bf16 v[116:119], v[160:163], v[188:191], v[116:119]
    ds_read_b64_tr_b16 v[174:175], v236 offset:13824
    v_mfma_f32_16x16x32_bf16 v[120:123], v[160:163], v[192:195], v[120:123]
    ds_read_b64_tr_b16 v[176:177], v236 offset:9248
    v_mfma_f32_16x16x32_bf16 v[124:127], v[160:163], v[196:199], v[124:127]
    ds_read_b64_tr_b16 v[178:179], v236 offset:13856
    v_mfma_f32_16x16x32_bf16 v[128:131], v[164:167], v[184:187], v[128:131]
    ds_read_b64_tr_b16 v[180:181], v236 offset:9280
    v_mfma_f32_16x16x32_bf16 v[132:135], v[164:167], v[188:191], v[132:135]
    v_mfma_f32_16x16x32_bf16 v[136:139], v[164:167], v[192:195], v[136:139]
    ds_read_b64_tr_b16 v[182:183], v236 offset:13888
    v_mfma_f32_16x16x32_bf16 v[140:143], v[164:167], v[196:199], v[140:143]
    s_add_u32 s88, s85, 4718592
    s_add_u32 m0, s84, 0
    s_nop 0
    buffer_load_dwordx4 v216, s[52:55], s88 offen offset:0 lds
    v_mfma_f32_16x16x32_bf16 v[144:147], v[168:171], v[184:187], v[144:147]
    buffer_load_dwordx4 v217, s[52:55], s88 offen offset:1024 lds
    v_mfma_f32_16x16x32_bf16 v[148:151], v[168:171], v[188:191], v[148:151]
    buffer_load_dwordx4 v218, s[52:55], s88 offen offset:2048 lds
    v_mfma_f32_16x16x32_bf16 v[152:155], v[168:171], v[192:195], v[152:155]
    buffer_load_dwordx4 v219, s[52:55], s88 offen offset:3072 lds
    v_mfma_f32_16x16x32_bf16 v[156:159], v[168:171], v[196:199], v[156:159]
    s_waitcnt lgkmcnt(0)
    v_mfma_f32_16x16x32_bf16 v[16:19], v[172:175], v[200:203], v[16:19]
    ds_read_b64_tr_b16 v[160:161], v236 offset:9312
    v_mfma_f32_16x16x32_bf16 v[20:23], v[172:175], v[204:207], v[20:23]
    ds_read_b64_tr_b16 v[162:163], v236 offset:13920
    v_mfma_f32_16x16x32_bf16 v[24:27], v[172:175], v[208:211], v[24:27]
    ds_read_b64_tr_b16 v[164:165], v236 offset:9344
    v_mfma_f32_16x16x32_bf16 v[28:31], v[172:175], v[212:215], v[28:31]
    ds_read_b64_tr_b16 v[166:167], v236 offset:13952
    v_mfma_f32_16x16x32_bf16 v[32:35], v[176:179], v[200:203], v[32:35]
    ds_read_b64_tr_b16 v[168:169], v236 offset:9376
    v_mfma_f32_16x16x32_bf16 v[36:39], v[176:179], v[204:207], v[36:39]
    ds_read_b64_tr_b16 v[170:171], v236 offset:13984
    v_mfma_f32_16x16x32_bf16 v[40:43], v[176:179], v[208:211], v[40:43]
    s_add_u32 m0, s84, 4096
    s_nop 0
    buffer_load_dwordx4 v220, s[52:55], s88 offen offset:0 lds
    v_mfma_f32_16x16x32_bf16 v[44:47], v[176:179], v[212:215], v[44:47]
    buffer_load_dwordx4 v221, s[52:55], s88 offen offset:1024 lds
    v_mfma_f32_16x16x32_bf16 v[48:51], v[180:183], v[200:203], v[48:51]
    buffer_load_dwordx4 v222, s[52:55], s88 offen offset:2048 lds
    v_mfma_f32_16x16x32_bf16 v[52:55], v[180:183], v[204:207], v[52:55]
    buffer_load_dwordx4 v223, s[52:55], s88 offen offset:3072 lds
    v_mfma_f32_16x16x32_bf16 v[56:59], v[180:183], v[208:211], v[56:59]
    s_add_u32 m0, s84, 8192
    s_nop 0
    buffer_load_dwordx4 v224, s[52:55], s88 offen offset:0 lds
    v_mfma_f32_16x16x32_bf16 v[60:63], v[180:183], v[212:215], v[60:63]
    s_waitcnt lgkmcnt(0)
    v_mfma_f32_16x16x32_bf16 v[64:67], v[160:163], v[200:203], v[64:67]
    ds_read_b64_tr_b16 v[172:173], v236 offset:9408
    v_mfma_f32_16x16x32_bf16 v[68:71], v[160:163], v[204:207], v[68:71]
    ds_read_b64_tr_b16 v[174:175], v236 offset:14016
    v_mfma_f32_16x16x32_bf16 v[72:75], v[160:163], v[208:211], v[72:75]
    ds_read_b64_tr_b16 v[176:177], v236 offset:9440
    v_mfma_f32_16x16x32_bf16 v[76:79], v[160:163], v[212:215], v[76:79]
    ds_read_b64_tr_b16 v[178:179], v236 offset:14048
    v_mfma_f32_16x16x32_bf16 v[80:83], v[164:167], v[200:203], v[80:83]
    ds_read_b64_tr_b16 v[180:181], v236 offset:9472
    v_mfma_f32_16x16x32_bf16 v[84:87], v[164:167], v[204:207], v[84:87]
    v_mfma_f32_16x16x32_bf16 v[88:91], v[164:167], v[208:211], v[88:91]
    ds_read_b64_tr_b16 v[182:183], v236 offset:14080
    v_mfma_f32_16x16x32_bf16 v[92:95], v[164:167], v[212:215], v[92:95]
    ds_read_b128 v[184:187], v234 offset:1024
    v_mfma_f32_16x16x32_bf16 v[96:99], v[168:171], v[200:203], v[96:99]
    ds_read_b128 v[188:191], v234 offset:19456
    v_mfma_f32_16x16x32_bf16 v[100:103], v[168:171], v[204:207], v[100:103]
    ds_read_b128 v[192:195], v234 offset:37888
    v_mfma_f32_16x16x32_bf16 v[104:107], v[168:171], v[208:211], v[104:107]
    ds_read_b128 v[196:199], v234 offset:56320
    v_mfma_f32_16x16x32_bf16 v[108:111], v[168:171], v[212:215], v[108:111]
    s_waitcnt lgkmcnt(4)
    s_waitcnt vmcnt(0)
    v_mfma_f32_16x16x32_bf16 v[112:115], v[172:175], v[200:203], v[112:115]
    ds_read_b64_tr_b16 v[160:161], v236 offset:0
    v_mfma_f32_16x16x32_bf16 v[116:119], v[172:175], v[204:207], v[116:119]
    ds_read_b64_tr_b16 v[162:163], v236 offset:4608
    v_mfma_f32_16x16x32_bf16 v[120:123], v[172:175], v[208:211], v[120:123]
    ds_read_b64_tr_b16 v[164:165], v236 offset:32
    v_mfma_f32_16x16x32_bf16 v[124:127], v[172:175], v[212:215], v[124:127]
    ds_read_b64_tr_b16 v[166:167], v236 offset:4640
    v_mfma_f32_16x16x32_bf16 v[128:131], v[176:179], v[200:203], v[128:131]
    ds_read_b64_tr_b16 v[168:169], v236 offset:64
    v_mfma_f32_16x16x32_bf16 v[132:135], v[176:179], v[204:207], v[132:135]
    v_mfma_f32_16x16x32_bf16 v[136:139], v[176:179], v[208:211], v[136:139]
    ds_read_b64_tr_b16 v[170:171], v236 offset:4672
    v_mfma_f32_16x16x32_bf16 v[140:143], v[176:179], v[212:215], v[140:143]
    s_add_u32 s88, s85, 5013504
    s_add_u32 m0, s84, 9216
    s_nop 0
    buffer_load_dwordx4 v216, s[52:55], s88 offen offset:0 lds
    v_mfma_f32_16x16x32_bf16 v[144:147], v[180:183], v[200:203], v[144:147]
    buffer_load_dwordx4 v217, s[52:55], s88 offen offset:1024 lds
    v_mfma_f32_16x16x32_bf16 v[148:151], v[180:183], v[204:207], v[148:151]
    buffer_load_dwordx4 v218, s[52:55], s88 offen offset:2048 lds
    v_mfma_f32_16x16x32_bf16 v[152:155], v[180:183], v[208:211], v[152:155]
    buffer_load_dwordx4 v219, s[52:55], s88 offen offset:3072 lds
    v_mfma_f32_16x16x32_bf16 v[156:159], v[180:183], v[212:215], v[156:159]
    s_waitcnt lgkmcnt(0)
    v_mfma_f32_16x16x32_bf16 v[16:19], v[160:163], v[184:187], v[16:19]
    ds_read_b64_tr_b16 v[172:173], v236 offset:96
    v_mfma_f32_16x16x32_bf16 v[20:23], v[160:163], v[188:191], v[20:23]
    ds_read_b64_tr_b16 v[174:175], v236 offset:4704
    v_mfma_f32_16x16x32_bf16 v[24:27], v[160:163], v[192:195], v[24:27]
    ds_read_b64_tr_b16 v[176:177], v236 offset:128
    v_mfma_f32_16x16x32_bf16 v[28:31], v[160:163], v[196:199], v[28:31]
    ds_read_b64_tr_b16 v[178:179], v236 offset:4736
    v_mfma_f32_16x16x32_bf16 v[32:35], v[164:167], v[184:187], v[32:35]
    ds_read_b64_tr_b16 v[180:181], v236 offset:160
    v_mfma_f32_16x16x32_bf16 v[36:39], v[164:167], v[188:191], v[36:39]
    ds_read_b64_tr_b16 v[182:183], v236 offset:4768
    v_mfma_f32_16x16x32_bf16 v[40:43], v[164:167], v[192:195], v[40:43]
    s_add_u32 m0, s84, 13312
    s_nop 0
    buffer_load_dwordx4 v220, s[52:55], s88 offen offset:0 lds
    v_mfma_f32_16x16x32_bf16 v[44:47], v[164:167], v[196:199], v[44:47]
    buffer_load_dwordx4 v221, s[52:55], s88 offen offset:1024 lds
    v_mfma_f32_16x16x32_bf16 v[48:51], v[168:171], v[184:187], v[48:51]
    buffer_load_dwordx4 v222, s[52:55], s88 offen offset:2048 lds
    v_mfma_f32_16x16x32_bf16 v[52:55], v[168:171], v[188:191], v[52:55]
    buffer_load_dwordx4 v223, s[52:55], s88 offen offset:3072 lds
    v_mfma_f32_16x16x32_bf16 v[56:59], v[168:171], v[192:195], v[56:59]
    s_add_u32 m0, s84, 17408
    s_nop 0
    buffer_load_dwordx4 v224, s[52:55], s88 offen offset:0 lds
    v_mfma_f32_16x16x32_bf16 v[60:63], v[168:171], v[196:199], v[60:63]
    s_waitcnt lgkmcnt(0)
    v_mfma_f32_16x16x32_bf16 v[64:67], v[172:175], v[184:187], v[64:67]
    ds_read_b64_tr_b16 v[160:161], v236 offset:192
    v_mfma_f32_16x16x32_bf16 v[68:71], v[172:175], v[188:191], v[68:71]
    ds_read_b64_tr_b16 v[162:163], v236 offset:4800
    v_mfma_f32_16x16x32_bf16 v[72:75], v[172:175], v[192:195], v[72:75]
    ds_read_b64_tr_b16 v[164:165], v236 offset:224
    v_mfma_f32_16x16x32_bf16 v[76:79], v[172:175], v[196:199], v[76:79]
    ds_read_b64_tr_b16 v[166:167], v236 offset:4832
    v_mfma_f32_16x16x32_bf16 v[80:83], v[176:179], v[184:187], v[80:83]
    ds_read_b64_tr_b16 v[168:169], v236 offset:256
    v_mfma_f32_16x16x32_bf16 v[84:87], v[176:179], v[188:191], v[84:87]
    v_mfma_f32_16x16x32_bf16 v[88:91], v[176:179], v[192:195], v[88:91]
    ds_read_b64_tr_b16 v[170:171], v236 offset:4864
    v_mfma_f32_16x16x32_bf16 v[92:95], v[176:179], v[196:199], v[92:95]
    ds_read_b128 v[200:203], v235 offset:1024
    v_mfma_f32_16x16x32_bf16 v[96:99], v[180:183], v[184:187], v[96:99]
    ds_read_b128 v[204:207], v235 offset:19456
    v_mfma_f32_16x16x32_bf16 v[100:103], v[180:183], v[188:191], v[100:103]
    ds_read_b128 v[208:211], v235 offset:37888
    v_mfma_f32_16x16x32_bf16 v[104:107], v[180:183], v[192:195], v[104:107]
    ds_read_b128 v[212:215], v235 offset:56320
    v_mfma_f32_16x16x32_bf16 v[108:111], v[180:183], v[196:199], v[108:111]
    s_waitcnt lgkmcnt(4)
    s_waitcnt vmcnt(0)
    v_mfma_f32_16x16x32_bf16 v[112:115], v[160:163], v[184:187], v[112:115]
    ds_read_b64_tr_b16 v[172:173], v236 offset:9216
    v_mfma_f32_16x16x32_bf16 v[116:119], v[160:163], v[188:191], v[116:119]
    ds_read_b64_tr_b16 v[174:175], v236 offset:13824
    v_mfma_f32_16x16x32_bf16 v[120:123], v[160:163], v[192:195], v[120:123]
    ds_read_b64_tr_b16 v[176:177], v236 offset:9248
    v_mfma_f32_16x16x32_bf16 v[124:127], v[160:163], v[196:199], v[124:127]
    ds_read_b64_tr_b16 v[178:179], v236 offset:13856
    v_mfma_f32_16x16x32_bf16 v[128:131], v[164:167], v[184:187], v[128:131]
    ds_read_b64_tr_b16 v[180:181], v236 offset:9280
    v_mfma_f32_16x16x32_bf16 v[132:135], v[164:167], v[188:191], v[132:135]
    v_mfma_f32_16x16x32_bf16 v[136:139], v[164:167], v[192:195], v[136:139]
    ds_read_b64_tr_b16 v[182:183], v236 offset:13888
    v_mfma_f32_16x16x32_bf16 v[140:143], v[164:167], v[196:199], v[140:143]
    s_add_u32 s88, s86, 0
    s_add_u32 m0, s84, 0
    s_nop 0
    buffer_load_dwordx4 v225, s[56:59], s88 offen offset:0 lds
    v_mfma_f32_16x16x32_bf16 v[144:147], v[168:171], v[184:187], v[144:147]
    buffer_load_dwordx4 v226, s[56:59], s88 offen offset:1024 lds
    v_mfma_f32_16x16x32_bf16 v[148:151], v[168:171], v[188:191], v[148:151]
    buffer_load_dwordx4 v227, s[56:59], s88 offen offset:2048 lds
    v_mfma_f32_16x16x32_bf16 v[152:155], v[168:171], v[192:195], v[152:155]
    buffer_load_dwordx4 v228, s[56:59], s88 offen offset:3072 lds
    v_mfma_f32_16x16x32_bf16 v[156:159], v[168:171], v[196:199], v[156:159]
    s_waitcnt lgkmcnt(0)
    v_mfma_f32_16x16x32_bf16 v[16:19], v[172:175], v[200:203], v[16:19]
    ds_read_b64_tr_b16 v[160:161], v236 offset:9312
    v_mfma_f32_16x16x32_bf16 v[20:23], v[172:175], v[204:207], v[20:23]
    ds_read_b64_tr_b16 v[162:163], v236 offset:13920
    v_mfma_f32_16x16x32_bf16 v[24:27], v[172:175], v[208:211], v[24:27]
    ds_read_b64_tr_b16 v[164:165], v236 offset:9344
    v_mfma_f32_16x16x32_bf16 v[28:31], v[172:175], v[212:215], v[28:31]
    ds_read_b64_tr_b16 v[166:167], v236 offset:13952
    v_mfma_f32_16x16x32_bf16 v[32:35], v[176:179], v[200:203], v[32:35]
    ds_read_b64_tr_b16 v[168:169], v236 offset:9376
    v_mfma_f32_16x16x32_bf16 v[36:39], v[176:179], v[204:207], v[36:39]
    ds_read_b64_tr_b16 v[170:171], v236 offset:13984
    v_mfma_f32_16x16x32_bf16 v[40:43], v[176:179], v[208:211], v[40:43]
    v_mov_b32 v244, 1
    ds_write_b32 v239, v244
    v_mfma_f32_16x16x32_bf16 v[44:47], v[176:179], v[212:215], v[44:47]
    s_add_u32 m0, s84, 4096
    s_nop 0
    buffer_load_dwordx4 v229, s[56:59], s88 offen offset:0 lds
    v_mfma_f32_16x16x32_bf16 v[48:51], v[180:183], v[200:203], v[48:51]
    buffer_load_dwordx4 v230, s[56:59], s88 offen offset:1024 lds
    v_mfma_f32_16x16x32_bf16 v[52:55], v[180:183], v[204:207], v[52:55]
    buffer_load_dwordx4 v231, s[56:59], s88 offen offset:2048 lds
    v_mfma_f32_16x16x32_bf16 v[56:59], v[180:183], v[208:211], v[56:59]
    buffer_load_dwordx4 v232, s[56:59], s88 offen offset:3072 lds
    v_mfma_f32_16x16x32_bf16 v[60:63], v[180:183], v[212:215], v[60:63]
    s_add_u32 m0, s84, 8192
    s_nop 0
    buffer_load_dwordx4 v233, s[56:59], s88 offen offset:0 lds
    s_waitcnt lgkmcnt(0)
    v_mfma_f32_16x16x32_bf16 v[64:67], v[160:163], v[200:203], v[64:67]
    ds_read_b64_tr_b16 v[172:173], v236 offset:9408
    v_mfma_f32_16x16x32_bf16 v[68:71], v[160:163], v[204:207], v[68:71]
    v_mfma_f32_16x16x32_bf16 v[72:75], v[160:163], v[208:211], v[72:75]
    ds_read_b64_tr_b16 v[174:175], v236 offset:14016
    v_mfma_f32_16x16x32_bf16 v[76:79], v[160:163], v[212:215], v[76:79]
    v_mfma_f32_16x16x32_bf16 v[80:83], v[164:167], v[200:203], v[80:83]
    ds_read_b64_tr_b16 v[176:177], v236 offset:9440
    v_mfma_f32_16x16x32_bf16 v[84:87], v[164:167], v[204:207], v[84:87]
    v_mfma_f32_16x16x32_bf16 v[88:91], v[164:167], v[208:211], v[88:91]
    ds_read_b64_tr_b16 v[178:179], v236 offset:14048
    v_mfma_f32_16x16x32_bf16 v[92:95], v[164:167], v[212:215], v[92:95]
    v_mfma_f32_16x16x32_bf16 v[96:99], v[168:171], v[200:203], v[96:99]
    ds_read_b64_tr_b16 v[180:181], v236 offset:9472
    v_mfma_f32_16x16x32_bf16 v[100:103], v[168:171], v[204:207], v[100:103]
    v_mfma_f32_16x16x32_bf16 v[104:107], v[168:171], v[208:211], v[104:107]
    ds_read_b64_tr_b16 v[182:183], v236 offset:14080
    v_mfma_f32_16x16x32_bf16 v[108:111], v[168:171], v[212:215], v[108:111]
    s_waitcnt lgkmcnt(0)
    s_waitcnt vmcnt(0)
    v_mfma_f32_16x16x32_bf16 v[112:115], v[172:175], v[200:203], v[112:115]
    ds_read_b64_tr_b16 v[160:161], v236 offset:0
    v_mfma_f32_16x16x32_bf16 v[116:119], v[172:175], v[204:207], v[116:119]
    ds_read_b64_tr_b16 v[162:163], v236 offset:4608
    v_mfma_f32_16x16x32_bf16 v[120:123], v[172:175], v[208:211], v[120:123]
    ds_read_b64_tr_b16 v[164:165], v236 offset:32
    v_mfma_f32_16x16x32_bf16 v[124:127], v[172:175], v[212:215], v[124:127]
    ds_read_b64_tr_b16 v[166:167], v236 offset:4640
    v_mfma_f32_16x16x32_bf16 v[128:131], v[176:179], v[200:203], v[128:131]
    ds_read_b64_tr_b16 v[168:169], v236 offset:64
    v_mfma_f32_16x16x32_bf16 v[132:135], v[176:179], v[204:207], v[132:135]
    v_mfma_f32_16x16x32_bf16 v[136:139], v[176:179], v[208:211], v[136:139]
    ds_read_b64_tr_b16 v[170:171], v236 offset:4672
    v_mfma_f32_16x16x32_bf16 v[140:143], v[176:179], v[212:215], v[140:143]
    s_add_u32 s88, s86, 36864
    s_add_u32 m0, s84, 9216
    s_nop 0
    buffer_load_dwordx4 v225, s[56:59], s88 offen offset:0 lds
    v_mfma_f32_16x16x32_bf16 v[144:147], v[180:183], v[200:203], v[144:147]
    buffer_load_dwordx4 v226, s[56:59], s88 offen offset:1024 lds
    v_mfma_f32_16x16x32_bf16 v[148:151], v[180:183], v[204:207], v[148:151]
    buffer_load_dwordx4 v227, s[56:59], s88 offen offset:2048 lds
    v_mfma_f32_16x16x32_bf16 v[152:155], v[180:183], v[208:211], v[152:155]
    buffer_load_dwordx4 v228, s[56:59], s88 offen offset:3072 lds
    v_mfma_f32_16x16x32_bf16 v[156:159], v[180:183], v[212:215], v[156:159]
LM_fx1_109:
    ds_read_b32 v244, v238
    s_waitcnt lgkmcnt(0)
    v_cmp_gt_u32 vcc, 1, v244
    s_nop 4
    s_cbranch_vccz LM_fx1d_110
    s_sleep 1
    s_branch LM_fx1_109
LM_fx1d_110:
    v_subrev_u32 v245, 16, v238
LM_fxa_111:
    ds_read_b32 v244, v245
    s_waitcnt lgkmcnt(0)
    v_cmp_gt_u32 vcc, 2, v244
    s_nop 4
    s_cbranch_vccz LM_fxad_112
    s_sleep 1
    s_branch LM_fxa_111
LM_fxad_112:
    s_setprio 3
    v_max_f32 v16, 0, v16
    v_max_f32 v17, 0, v17
    v_max_f32 v18, 0, v18
    v_max_f32 v19, 0, v19
    v_pk_mul_f32 v[16:17], v[16:17], v[16:17]
    v_pk_mul_f32 v[18:19], v[18:19], v[18:19]
    v_cvt_pk_bf16_f32 v16, v16, v17
    v_cvt_pk_bf16_f32 v17, v18, v19
    ds_write_b64 v240, v[16:17] offset:0
    v_max_f32 v20, 0, v20
    v_max_f32 v21, 0, v21
    v_max_f32 v22, 0, v22
    v_max_f32 v23, 0, v23
    v_pk_mul_f32 v[20:21], v[20:21], v[20:21]
    v_pk_mul_f32 v[22:23], v[22:23], v[22:23]
    v_cvt_pk_bf16_f32 v20, v20, v21
    v_cvt_pk_bf16_f32 v21, v22, v23
    ds_write_b64 v240, v[20:21] offset:18432
    v_max_f32 v24, 0, v24
    v_max_f32 v25, 0, v25
    v_max_f32 v26, 0, v26
    v_max_f32 v27, 0, v27
    v_pk_mul_f32 v[24:25], v[24:25], v[24:25]
    v_pk_mul_f32 v[26:27], v[26:27], v[26:27]
    v_cvt_pk_bf16_f32 v24, v24, v25
    v_cvt_pk_bf16_f32 v25, v26, v27
    ds_write_b64 v240, v[24:25] offset:36864
    v_max_f32 v28, 0, v28
    v_max_f32 v29, 0, v29
    v_max_f32 v30, 0, v30
    v_max_f32 v31, 0, v31
    v_pk_mul_f32 v[28:29], v[28:29], v[28:29]
    v_pk_mul_f32 v[30:31], v[30:31], v[30:31]
    v_cvt_pk_bf16_f32 v28, v28, v29
    v_cvt_pk_bf16_f32 v29, v30, v31
    ds_write_b64 v240, v[28:29] offset:55296
    v_max_f32 v32, 0, v32
    v_max_f32 v33, 0, v33
    v_max_f32 v34, 0, v34
    v_max_f32 v35, 0, v35
    v_pk_mul_f32 v[32:33], v[32:33], v[32:33]
    v_pk_mul_f32 v[34:35], v[34:35], v[34:35]
    v_cvt_pk_bf16_f32 v32, v32, v33
    v_cvt_pk_bf16_f32 v33, v34, v35
    ds_write_b64 v241, v[32:33] offset:0
    v_max_f32 v36, 0, v36
    v_max_f32 v37, 0, v37
    v_max_f32 v38, 0, v38
    v_max_f32 v39, 0, v39
    v_pk_mul_f32 v[36:37], v[36:37], v[36:37]
    v_pk_mul_f32 v[38:39], v[38:39], v[38:39]
    v_cvt_pk_bf16_f32 v36, v36, v37
    v_cvt_pk_bf16_f32 v37, v38, v39
    ds_write_b64 v241, v[36:37] offset:18432
    v_max_f32 v40, 0, v40
    v_max_f32 v41, 0, v41
    v_max_f32 v42, 0, v42
    v_max_f32 v43, 0, v43
    v_pk_mul_f32 v[40:41], v[40:41], v[40:41]
    v_pk_mul_f32 v[42:43], v[42:43], v[42:43]
    v_cvt_pk_bf16_f32 v40, v40, v41
    v_cvt_pk_bf16_f32 v41, v42, v43
    ds_write_b64 v241, v[40:41] offset:36864
    v_max_f32 v44, 0, v44
    v_max_f32 v45, 0, v45
    v_max_f32 v46, 0, v46
    v_max_f32 v47, 0, v47
    v_pk_mul_f32 v[44:45], v[44:45], v[44:45]
    v_pk_mul_f32 v[46:47], v[46:47], v[46:47]
    v_cvt_pk_bf16_f32 v44, v44, v45
    v_cvt_pk_bf16_f32 v45, v46, v47
    ds_write_b64 v241, v[44:45] offset:55296
    v_max_f32 v48, 0, v48
    v_max_f32 v49, 0, v49
    v_max_f32 v50, 0, v50
    v_max_f32 v51, 0, v51
    v_pk_mul_f32 v[48:49], v[48:49], v[48:49]
    v_pk_mul_f32 v[50:51], v[50:51], v[50:51]
    v_cvt_pk_bf16_f32 v48, v48, v49
    v_cvt_pk_bf16_f32 v49, v50, v51
    ds_write_b64 v242, v[48:49] offset:0
    v_max_f32 v52, 0, v52
    v_max_f32 v53, 0, v53
    v_max_f32 v54, 0, v54
    v_max_f32 v55, 0, v55
    v_pk_mul_f32 v[52:53], v[52:53], v[52:53]
    v_pk_mul_f32 v[54:55], v[54:55], v[54:55]
    v_cvt_pk_bf16_f32 v52, v52, v53
    v_cvt_pk_bf16_f32 v53, v54, v55
    ds_write_b64 v242, v[52:53] offset:18432
    v_max_f32 v56, 0, v56
    v_max_f32 v57, 0, v57
    v_max_f32 v58, 0, v58
    v_max_f32 v59, 0, v59
    v_pk_mul_f32 v[56:57], v[56:57], v[56:57]
    v_pk_mul_f32 v[58:59], v[58:59], v[58:59]
    v_cvt_pk_bf16_f32 v56, v56, v57
    v_cvt_pk_bf16_f32 v57, v58, v59
    ds_write_b64 v242, v[56:57] offset:36864
    v_max_f32 v60, 0, v60
    v_max_f32 v61, 0, v61
    v_max_f32 v62, 0, v62
    v_max_f32 v63, 0, v63
    v_pk_mul_f32 v[60:61], v[60:61], v[60:61]
    v_pk_mul_f32 v[62:63], v[62:63], v[62:63]
    v_cvt_pk_bf16_f32 v60, v60, v61
    v_cvt_pk_bf16_f32 v61, v62, v63
    ds_write_b64 v242, v[60:61] offset:55296
    v_max_f32 v64, 0, v64
    v_max_f32 v65, 0, v65
    v_max_f32 v66, 0, v66
    v_max_f32 v67, 0, v67
    v_pk_mul_f32 v[64:65], v[64:65], v[64:65]
    v_pk_mul_f32 v[66:67], v[66:67], v[66:67]
    v_cvt_pk_bf16_f32 v64, v64, v65
    v_cvt_pk_bf16_f32 v65, v66, v67
    ds_write_b64 v243, v[64:65] offset:0
    v_max_f32 v68, 0, v68
    v_max_f32 v69, 0, v69
    v_max_f32 v70, 0, v70
    v_max_f32 v71, 0, v71
    v_pk_mul_f32 v[68:69], v[68:69], v[68:69]
    v_pk_mul_f32 v[70:71], v[70:71], v[70:71]
    v_cvt_pk_bf16_f32 v68, v68, v69
    v_cvt_pk_bf16_f32 v69, v70, v71
    ds_write_b64 v243, v[68:69] offset:18432
    v_max_f32 v72, 0, v72
    v_max_f32 v73, 0, v73
    v_max_f32 v74, 0, v74
    v_max_f32 v75, 0, v75
    v_pk_mul_f32 v[72:73], v[72:73], v[72:73]
    v_pk_mul_f32 v[74:75], v[74:75], v[74:75]
    v_cvt_pk_bf16_f32 v72, v72, v73
    v_cvt_pk_bf16_f32 v73, v74, v75
    ds_write_b64 v243, v[72:73] offset:36864
    v_max_f32 v76, 0, v76
    v_max_f32 v77, 0, v77
    v_max_f32 v78, 0, v78
    v_max_f32 v79, 0, v79
    v_pk_mul_f32 v[76:77], v[76:77], v[76:77]
    v_pk_mul_f32 v[78:79], v[78:79], v[78:79]
    v_cvt_pk_bf16_f32 v76, v76, v77
    v_cvt_pk_bf16_f32 v77, v78, v79
    ds_write_b64 v243, v[76:77] offset:55296
    v_max_f32 v80, 0, v80
    v_max_f32 v81, 0, v81
    v_max_f32 v82, 0, v82
    v_max_f32 v83, 0, v83
    v_pk_mul_f32 v[80:81], v[80:81], v[80:81]
    v_pk_mul_f32 v[82:83], v[82:83], v[82:83]
    v_cvt_pk_bf16_f32 v80, v80, v81
    v_cvt_pk_bf16_f32 v81, v82, v83
    ds_write_b64 v240, v[80:81] offset:128
    v_max_f32 v84, 0, v84
    v_max_f32 v85, 0, v85
    v_max_f32 v86, 0, v86
    v_max_f32 v87, 0, v87
    v_pk_mul_f32 v[84:85], v[84:85], v[84:85]
    v_pk_mul_f32 v[86:87], v[86:87], v[86:87]
    v_cvt_pk_bf16_f32 v84, v84, v85
    v_cvt_pk_bf16_f32 v85, v86, v87
    ds_write_b64 v240, v[84:85] offset:18560
    v_max_f32 v88, 0, v88
    v_max_f32 v89, 0, v89
    v_max_f32 v90, 0, v90
    v_max_f32 v91, 0, v91
    v_pk_mul_f32 v[88:89], v[88:89], v[88:89]
    v_pk_mul_f32 v[90:91], v[90:91], v[90:91]
    v_cvt_pk_bf16_f32 v88, v88, v89
    v_cvt_pk_bf16_f32 v89, v90, v91
    ds_write_b64 v240, v[88:89] offset:36992
    v_max_f32 v92, 0, v92
    v_max_f32 v93, 0, v93
    v_max_f32 v94, 0, v94
    v_max_f32 v95, 0, v95
    v_pk_mul_f32 v[92:93], v[92:93], v[92:93]
    v_pk_mul_f32 v[94:95], v[94:95], v[94:95]
    v_cvt_pk_bf16_f32 v92, v92, v93
    v_cvt_pk_bf16_f32 v93, v94, v95
    ds_write_b64 v240, v[92:93] offset:55424
    v_max_f32 v96, 0, v96
    v_max_f32 v97, 0, v97
    v_max_f32 v98, 0, v98
    v_max_f32 v99, 0, v99
    v_pk_mul_f32 v[96:97], v[96:97], v[96:97]
    v_pk_mul_f32 v[98:99], v[98:99], v[98:99]
    v_cvt_pk_bf16_f32 v96, v96, v97
    v_cvt_pk_bf16_f32 v97, v98, v99
    ds_write_b64 v241, v[96:97] offset:128
    v_max_f32 v100, 0, v100
    v_max_f32 v101, 0, v101
    v_max_f32 v102, 0, v102
    v_max_f32 v103, 0, v103
    v_pk_mul_f32 v[100:101], v[100:101], v[100:101]
    v_pk_mul_f32 v[102:103], v[102:103], v[102:103]
    v_cvt_pk_bf16_f32 v100, v100, v101
    v_cvt_pk_bf16_f32 v101, v102, v103
    ds_write_b64 v241, v[100:101] offset:18560
    v_max_f32 v104, 0, v104
    v_max_f32 v105, 0, v105
    v_max_f32 v106, 0, v106
    v_max_f32 v107, 0, v107
    v_pk_mul_f32 v[104:105], v[104:105], v[104:105]
    v_pk_mul_f32 v[106:107], v[106:107], v[106:107]
    v_cvt_pk_bf16_f32 v104, v104, v105
    v_cvt_pk_bf16_f32 v105, v106, v107
    ds_write_b64 v241, v[104:105] offset:36992
    v_max_f32 v108, 0, v108
    v_max_f32 v109, 0, v109
    v_max_f32 v110, 0, v110
    v_max_f32 v111, 0, v111
    v_pk_mul_f32 v[108:109], v[108:109], v[108:109]
    v_pk_mul_f32 v[110:111], v[110:111], v[110:111]
    v_cvt_pk_bf16_f32 v108, v108, v109
    v_cvt_pk_bf16_f32 v109, v110, v111
    ds_write_b64 v241, v[108:109] offset:55424
    v_max_f32 v112, 0, v112
    v_max_f32 v113, 0, v113
    v_max_f32 v114, 0, v114
    v_max_f32 v115, 0, v115
    v_pk_mul_f32 v[112:113], v[112:113], v[112:113]
    v_pk_mul_f32 v[114:115], v[114:115], v[114:115]
    v_cvt_pk_bf16_f32 v112, v112, v113
    v_cvt_pk_bf16_f32 v113, v114, v115
    ds_write_b64 v242, v[112:113] offset:128
    v_max_f32 v116, 0, v116
    v_max_f32 v117, 0, v117
    v_max_f32 v118, 0, v118
    v_max_f32 v119, 0, v119
    v_pk_mul_f32 v[116:117], v[116:117], v[116:117]
    v_pk_mul_f32 v[118:119], v[118:119], v[118:119]
    v_cvt_pk_bf16_f32 v116, v116, v117
    v_cvt_pk_bf16_f32 v117, v118, v119
    ds_write_b64 v242, v[116:117] offset:18560
    v_max_f32 v120, 0, v120
    v_max_f32 v121, 0, v121
    v_max_f32 v122, 0, v122
    v_max_f32 v123, 0, v123
    v_pk_mul_f32 v[120:121], v[120:121], v[120:121]
    v_pk_mul_f32 v[122:123], v[122:123], v[122:123]
    v_cvt_pk_bf16_f32 v120, v120, v121
    v_cvt_pk_bf16_f32 v121, v122, v123
    ds_write_b64 v242, v[120:121] offset:36992
    v_max_f32 v124, 0, v124
    v_max_f32 v125, 0, v125
    v_max_f32 v126, 0, v126
    v_max_f32 v127, 0, v127
    v_pk_mul_f32 v[124:125], v[124:125], v[124:125]
    v_pk_mul_f32 v[126:127], v[126:127], v[126:127]
    v_cvt_pk_bf16_f32 v124, v124, v125
    v_cvt_pk_bf16_f32 v125, v126, v127
    ds_write_b64 v242, v[124:125] offset:55424
    v_max_f32 v128, 0, v128
    v_max_f32 v129, 0, v129
    v_max_f32 v130, 0, v130
    v_max_f32 v131, 0, v131
    v_pk_mul_f32 v[128:129], v[128:129], v[128:129]
    v_pk_mul_f32 v[130:131], v[130:131], v[130:131]
    v_cvt_pk_bf16_f32 v128, v128, v129
    v_cvt_pk_bf16_f32 v129, v130, v131
    ds_write_b64 v243, v[128:129] offset:128
    v_max_f32 v132, 0, v132
    v_max_f32 v133, 0, v133
    v_max_f32 v134, 0, v134
    v_max_f32 v135, 0, v135
    v_pk_mul_f32 v[132:133], v[132:133], v[132:133]
    v_pk_mul_f32 v[134:135], v[134:135], v[134:135]
    v_cvt_pk_bf16_f32 v132, v132, v133
    v_cvt_pk_bf16_f32 v133, v134, v135
    ds_write_b64 v243, v[132:133] offset:18560
    v_max_f32 v136, 0, v136
    v_max_f32 v137, 0, v137
    v_max_f32 v138, 0, v138
    v_max_f32 v139, 0, v139
    v_pk_mul_f32 v[136:137], v[136:137], v[136:137]
    v_pk_mul_f32 v[138:139], v[138:139], v[138:139]
    v_cvt_pk_bf16_f32 v136, v136, v137
    v_cvt_pk_bf16_f32 v137, v138, v139
    ds_write_b64 v243, v[136:137] offset:36992
    v_max_f32 v140, 0, v140
    v_max_f32 v141, 0, v141
    v_max_f32 v142, 0, v142
    v_max_f32 v143, 0, v143
    v_pk_mul_f32 v[140:141], v[140:141], v[140:141]
    v_pk_mul_f32 v[142:143], v[142:143], v[142:143]
    v_cvt_pk_bf16_f32 v140, v140, v141
    v_cvt_pk_bf16_f32 v141, v142, v143
    ds_write_b64 v243, v[140:141] offset:55424
    v_max_f32 v144, 0, v144
    v_max_f32 v145, 0, v145
    v_max_f32 v146, 0, v146
    v_max_f32 v147, 0, v147
    v_pk_mul_f32 v[144:145], v[144:145], v[144:145]
    v_pk_mul_f32 v[146:147], v[146:147], v[146:147]
    v_cvt_pk_bf16_f32 v144, v144, v145
    v_cvt_pk_bf16_f32 v145, v146, v147
    ds_write_b64 v240, v[144:145] offset:256
    v_max_f32 v148, 0, v148
    v_max_f32 v149, 0, v149
    v_max_f32 v150, 0, v150
    v_max_f32 v151, 0, v151
    v_pk_mul_f32 v[148:149], v[148:149], v[148:149]
    v_pk_mul_f32 v[150:151], v[150:151], v[150:151]
    v_cvt_pk_bf16_f32 v148, v148, v149
    v_cvt_pk_bf16_f32 v149, v150, v151
    ds_write_b64 v240, v[148:149] offset:18688
    v_max_f32 v152, 0, v152
    v_max_f32 v153, 0, v153
    v_max_f32 v154, 0, v154
    v_max_f32 v155, 0, v155
    v_pk_mul_f32 v[152:153], v[152:153], v[152:153]
    v_pk_mul_f32 v[154:155], v[154:155], v[154:155]
    v_cvt_pk_bf16_f32 v152, v152, v153
    v_cvt_pk_bf16_f32 v153, v154, v155
    ds_write_b64 v240, v[152:153] offset:37120
    v_max_f32 v156, 0, v156
    v_max_f32 v157, 0, v157
    v_max_f32 v158, 0, v158
    v_max_f32 v159, 0, v159
    v_pk_mul_f32 v[156:157], v[156:157], v[156:157]
    v_pk_mul_f32 v[158:159], v[158:159], v[158:159]
    v_cvt_pk_bf16_f32 v156, v156, v157
    v_cvt_pk_bf16_f32 v157, v158, v159
    ds_write_b64 v240, v[156:157] offset:55552
    s_waitcnt lgkmcnt(0)
    v_mov_b32 v244, 2
    ds_write_b32 v239, v244
    s_setprio 0
LM_fx2_113:
    ds_read_b32 v244, v238
    s_waitcnt lgkmcnt(0)
    v_cmp_gt_u32 vcc, 2, v244
    s_nop 4
    s_cbranch_vccz LM_fx2d_114
    s_sleep 1
    s_branch LM_fx2_113
LM_fx2d_114:
    ds_read_b128 v[184:187], v234 offset:0
    ds_read_b128 v[188:191], v234 offset:18432
    ds_read_b128 v[192:195], v234 offset:36864
    ds_read_b128 v[196:199], v234 offset:55296
    s_waitcnt lgkmcnt(0)
    v_mfma_f32_16x16x32_bf16 v[16:19], v[160:163], v[184:187], 0
    ds_read_b64_tr_b16 v[172:173], v236 offset:96
    v_mfma_f32_16x16x32_bf16 v[20:23], v[160:163], v[188:191], 0
    ds_read_b64_tr_b16 v[174:175], v236 offset:4704
    v_mfma_f32_16x16x32_bf16 v[24:27], v[160:163], v[192:195], 0
    ds_read_b64_tr_b16 v[176:177], v236 offset:128
    v_mfma_f32_16x16x32_bf16 v[28:31], v[160:163], v[196:199], 0
    ds_read_b64_tr_b16 v[178:179], v236 offset:4736
    v_mfma_f32_16x16x32_bf16 v[32:35], v[164:167], v[184:187], 0
    ds_read_b64_tr_b16 v[180:181], v236 offset:160
    v_mfma_f32_16x16x32_bf16 v[36:39], v[164:167], v[188:191], 0
    ds_read_b64_tr_b16 v[182:183], v236 offset:4768
    v_mfma_f32_16x16x32_bf16 v[40:43], v[164:167], v[192:195], 0
    s_add_u32 m0, s84, 13312
    s_nop 0
    buffer_load_dwordx4 v229, s[56:59], s88 offen offset:0 lds
    v_mfma_f32_16x16x32_bf16 v[44:47], v[164:167], v[196:199], 0
    buffer_load_dwordx4 v230, s[56:59], s88 offen offset:1024 lds
    v_mfma_f32_16x16x32_bf16 v[48:51], v[168:171], v[184:187], 0
    buffer_load_dwordx4 v231, s[56:59], s88 offen offset:2048 lds
    v_mfma_f32_16x16x32_bf16 v[52:55], v[168:171], v[188:191], 0
    buffer_load_dwordx4 v232, s[56:59], s88 offen offset:3072 lds
    v_mfma_f32_16x16x32_bf16 v[56:59], v[168:171], v[192:195], 0
    s_add_u32 m0, s84, 17408
    s_nop 0
    buffer_load_dwordx4 v233, s[56:59], s88 offen offset:0 lds
    v_mfma_f32_16x16x32_bf16 v[60:63], v[168:171], v[196:199], 0
    s_waitcnt lgkmcnt(0)
    v_mfma_f32_16x16x32_bf16 v[64:67], v[172:175], v[184:187], 0
    ds_read_b64_tr_b16 v[160:161], v236 offset:192
    v_mfma_f32_16x16x32_bf16 v[68:71], v[172:175], v[188:191], 0
    ds_read_b64_tr_b16 v[162:163], v236 offset:4800
    v_mfma_f32_16x16x32_bf16 v[72:75], v[172:175], v[192:195], 0
    ds_read_b64_tr_b16 v[164:165], v236 offset:224
    v_mfma_f32_16x16x32_bf16 v[76:79], v[172:175], v[196:199], 0
    ds_read_b64_tr_b16 v[166:167], v236 offset:4832
    v_mfma_f32_16x16x32_bf16 v[80:83], v[176:179], v[184:187], 0
    ds_read_b64_tr_b16 v[168:169], v236 offset:256
    v_mfma_f32_16x16x32_bf16 v[84:87], v[176:179], v[188:191], 0
    v_mfma_f32_16x16x32_bf16 v[88:91], v[176:179], v[192:195], 0
    ds_read_b64_tr_b16 v[170:171], v236 offset:4864
    v_mfma_f32_16x16x32_bf16 v[92:95], v[176:179], v[196:199], 0
    ds_read_b128 v[200:203], v235 offset:0
    v_mfma_f32_16x16x32_bf16 v[96:99], v[180:183], v[184:187], 0
    ds_read_b128 v[204:207], v235 offset:18432
    v_mfma_f32_16x16x32_bf16 v[100:103], v[180:183], v[188:191], 0
    ds_read_b128 v[208:211], v235 offset:36864
    v_mfma_f32_16x16x32_bf16 v[104:107], v[180:183], v[192:195], 0
    ds_read_b128 v[212:215], v235 offset:55296
    v_mfma_f32_16x16x32_bf16 v[108:111], v[180:183], v[196:199], 0
    s_waitcnt lgkmcnt(4)
    s_waitcnt vmcnt(0)
    v_mfma_f32_16x16x32_bf16 v[112:115], v[160:163], v[184:187], 0
    ds_read_b64_tr_b16 v[172:173], v236 offset:9216
    v_mfma_f32_16x16x32_bf16 v[116:119], v[160:163], v[188:191], 0
    ds_read_b64_tr_b16 v[174:175], v236 offset:13824
    v_mfma_f32_16x16x32_bf16 v[120:123], v[160:163], v[192:195], 0
    ds_read_b64_tr_b16 v[176:177], v236 offset:9248
    v_mfma_f32_16x16x32_bf16 v[124:127], v[160:163], v[196:199], 0
    ds_read_b64_tr_b16 v[178:179], v236 offset:13856
    v_mfma_f32_16x16x32_bf16 v[128:131], v[164:167], v[184:187], 0
    ds_read_b64_tr_b16 v[180:181], v236 offset:9280
    v_mfma_f32_16x16x32_bf16 v[132:135], v[164:167], v[188:191], 0
    v_mfma_f32_16x16x32_bf16 v[136:139], v[164:167], v[192:195], 0
    ds_read_b64_tr_b16 v[182:183], v236 offset:13888
    v_mfma_f32_16x16x32_bf16 v[140:143], v[164:167], v[196:199], 0
    s_add_u32 s88, s86, 73728
    s_add_u32 m0, s84, 0
    s_nop 0
    buffer_load_dwordx4 v225, s[56:59], s88 offen offset:0 lds
    v_mfma_f32_16x16x32_bf16 v[144:147], v[168:171], v[184:187], 0
    buffer_load_dwordx4 v226, s[56:59], s88 offen offset:1024 lds
    v_mfma_f32_16x16x32_bf16 v[148:151], v[168:171], v[188:191], 0
    buffer_load_dwordx4 v227, s[56:59], s88 offen offset:2048 lds
    v_mfma_f32_16x16x32_bf16 v[152:155], v[168:171], v[192:195], 0
    buffer_load_dwordx4 v228, s[56:59], s88 offen offset:3072 lds
    v_mfma_f32_16x16x32_bf16 v[156:159], v[168:171], v[196:199], 0
    s_waitcnt lgkmcnt(0)
    v_mfma_f32_16x16x32_bf16 v[16:19], v[172:175], v[200:203], v[16:19]
    ds_read_b64_tr_b16 v[160:161], v236 offset:9312
    v_mfma_f32_16x16x32_bf16 v[20:23], v[172:175], v[204:207], v[20:23]
    ds_read_b64_tr_b16 v[162:163], v236 offset:13920
    v_mfma_f32_16x16x32_bf16 v[24:27], v[172:175], v[208:211], v[24:27]
    ds_read_b64_tr_b16 v[164:165], v236 offset:9344
    v_mfma_f32_16x16x32_bf16 v[28:31], v[172:175], v[212:215], v[28:31]
    ds_read_b64_tr_b16 v[166:167], v236 offset:13952
    v_mfma_f32_16x16x32_bf16 v[32:35], v[176:179], v[200:203], v[32:35]
    ds_read_b64_tr_b16 v[168:169], v236 offset:9376
    v_mfma_f32_16x16x32_bf16 v[36:39], v[176:179], v[204:207], v[36:39]
    ds_read_b64_tr_b16 v[170:171], v236 offset:13984
    v_mfma_f32_16x16x32_bf16 v[40:43], v[176:179], v[208:211], v[40:43]
    s_add_u32 m0, s84, 4096
    s_nop 0
    buffer_load_dwordx4 v229, s[56:59], s88 offen offset:0 lds
    v_mfma_f32_16x16x32_bf16 v[44:47], v[176:179], v[212:215], v[44:47]
    buffer_load_dwordx4 v230, s[56:59], s88 offen offset:1024 lds
    v_mfma_f32_16x16x32_bf16 v[48:51], v[180:183], v[200:203], v[48:51]
    buffer_load_dwordx4 v231, s[56:59], s88 offen offset:2048 lds
    v_mfma_f32_16x16x32_bf16 v[52:55], v[180:183], v[204:207], v[52:55]
    buffer_load_dwordx4 v232, s[56:59], s88 offen offset:3072 lds
    v_mfma_f32_16x16x32_bf16 v[56:59], v[180:183], v[208:211], v[56:59]
    s_add_u32 m0, s84, 8192
    s_nop 0
    buffer_load_dwordx4 v233, s[56:59], s88 offen offset:0 lds
    v_mfma_f32_16x16x32_bf16 v[60:63], v[180:183], v[212:215], v[60:63]
    s_waitcnt lgkmcnt(0)
    v_mfma_f32_16x16x32_bf16 v[64:67], v[160:163], v[200:203], v[64:67]
    ds_read_b64_tr_b16 v[172:173], v236 offset:9408
    v_mfma_f32_16x16x32_bf16 v[68:71], v[160:163], v[204:207], v[68:71]
    ds_read_b64_tr_b16 v[174:175], v236 offset:14016
    v_mfma_f32_16x16x32_bf16 v[72:75], v[160:163], v[208:211], v[72:75]
    ds_read_b64_tr_b16 v[176:177], v236 offset:9440
    v_mfma_f32_16x16x32_bf16 v[76:79], v[160:163], v[212:215], v[76:79]
    ds_read_b64_tr_b16 v[178:179], v236 offset:14048
    v_mfma_f32_16x16x32_bf16 v[80:83], v[164:167], v[200:203], v[80:83]
    ds_read_b64_tr_b16 v[180:181], v236 offset:9472
    v_mfma_f32_16x16x32_bf16 v[84:87], v[164:167], v[204:207], v[84:87]
    v_mfma_f32_16x16x32_bf16 v[88:91], v[164:167], v[208:211], v[88:91]
    ds_read_b64_tr_b16 v[182:183], v236 offset:14080
    v_mfma_f32_16x16x32_bf16 v[92:95], v[164:167], v[212:215], v[92:95]
    ds_read_b128 v[184:187], v234 offset:128
    v_mfma_f32_16x16x32_bf16 v[96:99], v[168:171], v[200:203], v[96:99]
    ds_read_b128 v[188:191], v234 offset:18560
    v_mfma_f32_16x16x32_bf16 v[100:103], v[168:171], v[204:207], v[100:103]
    ds_read_b128 v[192:195], v234 offset:36992
    v_mfma_f32_16x16x32_bf16 v[104:107], v[168:171], v[208:211], v[104:107]
    ds_read_b128 v[196:199], v234 offset:55424
    v_mfma_f32_16x16x32_bf16 v[108:111], v[168:171], v[212:215], v[108:111]
    s_waitcnt lgkmcnt(4)
    s_waitcnt vmcnt(0)
    v_mfma_f32_16x16x32_bf16 v[112:115], v[172:175], v[200:203], v[112:115]
    ds_read_b64_tr_b16 v[160:161], v236 offset:0
    v_mfma_f32_16x16x32_bf16 v[116:119], v[172:175], v[204:207], v[116:119]
    ds_read_b64_tr_b16 v[162:163], v236 offset:4608
    v_mfma_f32_16x16x32_bf16 v[120:123], v[172:175], v[208:211], v[120:123]
    ds_read_b64_tr_b16 v[164:165], v236 offset:32
    v_mfma_f32_16x16x32_bf16 v[124:127], v[172:175], v[212:215], v[124:127]
    ds_read_b64_tr_b16 v[166:167], v236 offset:4640
    v_mfma_f32_16x16x32_bf16 v[128:131], v[176:179], v[200:203], v[128:131]
    ds_read_b64_tr_b16 v[168:169], v236 offset:64
    v_mfma_f32_16x16x32_bf16 v[132:135], v[176:179], v[204:207], v[132:135]
    v_mfma_f32_16x16x32_bf16 v[136:139], v[176:179], v[208:211], v[136:139]
    ds_read_b64_tr_b16 v[170:171], v236 offset:4672
    v_mfma_f32_16x16x32_bf16 v[140:143], v[176:179], v[212:215], v[140:143]
    s_add_u32 s88, s86, 110592
    s_add_u32 m0, s84, 9216
    s_nop 0
    buffer_load_dwordx4 v225, s[56:59], s88 offen offset:0 lds
    v_mfma_f32_16x16x32_bf16 v[144:147], v[180:183], v[200:203], v[144:147]
    buffer_load_dwordx4 v226, s[56:59], s88 offen offset:1024 lds
    v_mfma_f32_16x16x32_bf16 v[148:151], v[180:183], v[204:207], v[148:151]
    buffer_load_dwordx4 v227, s[56:59], s88 offen offset:2048 lds
    v_mfma_f32_16x16x32_bf16 v[152:155], v[180:183], v[208:211], v[152:155]
    buffer_load_dwordx4 v228, s[56:59], s88 offen offset:3072 lds
    v_mfma_f32_16x16x32_bf16 v[156:159], v[180:183], v[212:215], v[156:159]
    s_waitcnt lgkmcnt(0)
    v_mfma_f32_16x16x32_bf16 v[16:19], v[160:163], v[184:187], v[16:19]
    ds_read_b64_tr_b16 v[172:173], v236 offset:96
    v_mfma_f32_16x16x32_bf16 v[20:23], v[160:163], v[188:191], v[20:23]
    ds_read_b64_tr_b16 v[174:175], v236 offset:4704
    v_mfma_f32_16x16x32_bf16 v[24:27], v[160:163], v[192:195], v[24:27]
    ds_read_b64_tr_b16 v[176:177], v236 offset:128
    v_mfma_f32_16x16x32_bf16 v[28:31], v[160:163], v[196:199], v[28:31]
    ds_read_b64_tr_b16 v[178:179], v236 offset:4736
    v_mfma_f32_16x16x32_bf16 v[32:35], v[164:167], v[184:187], v[32:35]
    ds_read_b64_tr_b16 v[180:181], v236 offset:160
    v_mfma_f32_16x16x32_bf16 v[36:39], v[164:167], v[188:191], v[36:39]
    ds_read_b64_tr_b16 v[182:183], v236 offset:4768
    v_mfma_f32_16x16x32_bf16 v[40:43], v[164:167], v[192:195], v[40:43]
    s_add_u32 m0, s84, 13312
    s_nop 0
    buffer_load_dwordx4 v229, s[56:59], s88 offen offset:0 lds
    v_mfma_f32_16x16x32_bf16 v[44:47], v[164:167], v[196:199], v[44:47]
    buffer_load_dwordx4 v230, s[56:59], s88 offen offset:1024 lds
    v_mfma_f32_16x16x32_bf16 v[48:51], v[168:171], v[184:187], v[48:51]
    buffer_load_dwordx4 v231, s[56:59], s88 offen offset:2048 lds
    v_mfma_f32_16x16x32_bf16 v[52:55], v[168:171], v[188:191], v[52:55]
    buffer_load_dwordx4 v232, s[56:59], s88 offen offset:3072 lds
    v_mfma_f32_16x16x32_bf16 v[56:59], v[168:171], v[192:195], v[56:59]
    s_add_u32 m0, s84, 17408
    s_nop 0
    buffer_load_dwordx4 v233, s[56:59], s88 offen offset:0 lds
    v_mfma_f32_16x16x32_bf16 v[60:63], v[168:171], v[196:199], v[60:63]
    s_waitcnt lgkmcnt(0)
    v_mfma_f32_16x16x32_bf16 v[64:67], v[172:175], v[184:187], v[64:67]
    ds_read_b64_tr_b16 v[160:161], v236 offset:192
    v_mfma_f32_16x16x32_bf16 v[68:71], v[172:175], v[188:191], v[68:71]
    ds_read_b64_tr_b16 v[162:163], v236 offset:4800
    v_mfma_f32_16x16x32_bf16 v[72:75], v[172:175], v[192:195], v[72:75]
    ds_read_b64_tr_b16 v[164:165], v236 offset:224
    v_mfma_f32_16x16x32_bf16 v[76:79], v[172:175], v[196:199], v[76:79]
    ds_read_b64_tr_b16 v[166:167], v236 offset:4832
    v_mfma_f32_16x16x32_bf16 v[80:83], v[176:179], v[184:187], v[80:83]
    ds_read_b64_tr_b16 v[168:169], v236 offset:256
    v_mfma_f32_16x16x32_bf16 v[84:87], v[176:179], v[188:191], v[84:87]
    v_mfma_f32_16x16x32_bf16 v[88:91], v[176:179], v[192:195], v[88:91]
    ds_read_b64_tr_b16 v[170:171], v236 offset:4864
    v_mfma_f32_16x16x32_bf16 v[92:95], v[176:179], v[196:199], v[92:95]
    ds_read_b128 v[200:203], v235 offset:128
    v_mfma_f32_16x16x32_bf16 v[96:99], v[180:183], v[184:187], v[96:99]
    ds_read_b128 v[204:207], v235 offset:18560
    v_mfma_f32_16x16x32_bf16 v[100:103], v[180:183], v[188:191], v[100:103]
    ds_read_b128 v[208:211], v235 offset:36992
    v_mfma_f32_16x16x32_bf16 v[104:107], v[180:183], v[192:195], v[104:107]
    ds_read_b128 v[212:215], v235 offset:55424
    v_mfma_f32_16x16x32_bf16 v[108:111], v[180:183], v[196:199], v[108:111]
    s_waitcnt lgkmcnt(4)
    s_waitcnt vmcnt(0)
    v_mfma_f32_16x16x32_bf16 v[112:115], v[160:163], v[184:187], v[112:115]
    ds_read_b64_tr_b16 v[172:173], v236 offset:9216
    v_mfma_f32_16x16x32_bf16 v[116:119], v[160:163], v[188:191], v[116:119]
    ds_read_b64_tr_b16 v[174:175], v236 offset:13824
    v_mfma_f32_16x16x32_bf16 v[120:123], v[160:163], v[192:195], v[120:123]
    ds_read_b64_tr_b16 v[176:177], v236 offset:9248
    v_mfma_f32_16x16x32_bf16 v[124:127], v[160:163], v[196:199], v[124:127]
    ds_read_b64_tr_b16 v[178:179], v236 offset:13856
    v_mfma_f32_16x16x32_bf16 v[128:131], v[164:167], v[184:187], v[128:131]
    ds_read_b64_tr_b16 v[180:181], v236 offset:9280
    v_mfma_f32_16x16x32_bf16 v[132:135], v[164:167], v[188:191], v[132:135]
    v_mfma_f32_16x16x32_bf16 v[136:139], v[164:167], v[192:195], v[136:139]
    ds_read_b64_tr_b16 v[182:183], v236 offset:13888
    v_mfma_f32_16x16x32_bf16 v[140:143], v[164:167], v[196:199], v[140:143]
    s_add_u32 s88, s86, 147456
    s_add_u32 m0, s84, 0
    s_nop 0
    buffer_load_dwordx4 v225, s[56:59], s88 offen offset:0 lds
    v_mfma_f32_16x16x32_bf16 v[144:147], v[168:171], v[184:187], v[144:147]
    buffer_load_dwordx4 v226, s[56:59], s88 offen offset:1024 lds
    v_mfma_f32_16x16x32_bf16 v[148:151], v[168:171], v[188:191], v[148:151]
    buffer_load_dwordx4 v227, s[56:59], s88 offen offset:2048 lds
    v_mfma_f32_16x16x32_bf16 v[152:155], v[168:171], v[192:195], v[152:155]
    buffer_load_dwordx4 v228, s[56:59], s88 offen offset:3072 lds
    v_mfma_f32_16x16x32_bf16 v[156:159], v[168:171], v[196:199], v[156:159]
    s_waitcnt lgkmcnt(0)
    v_mfma_f32_16x16x32_bf16 v[16:19], v[172:175], v[200:203], v[16:19]
    ds_read_b64_tr_b16 v[160:161], v236 offset:9312
    v_mfma_f32_16x16x32_bf16 v[20:23], v[172:175], v[204:207], v[20:23]
    ds_read_b64_tr_b16 v[162:163], v236 offset:13920
    v_mfma_f32_16x16x32_bf16 v[24:27], v[172:175], v[208:211], v[24:27]
    ds_read_b64_tr_b16 v[164:165], v236 offset:9344
    v_mfma_f32_16x16x32_bf16 v[28:31], v[172:175], v[212:215], v[28:31]
    ds_read_b64_tr_b16 v[166:167], v236 offset:13952
    v_mfma_f32_16x16x32_bf16 v[32:35], v[176:179], v[200:203], v[32:35]
    ds_read_b64_tr_b16 v[168:169], v236 offset:9376
    v_mfma_f32_16x16x32_bf16 v[36:39], v[176:179], v[204:207], v[36:39]
    ds_read_b64_tr_b16 v[170:171], v236 offset:13984
    v_mfma_f32_16x16x32_bf16 v[40:43], v[176:179], v[208:211], v[40:43]
    s_add_u32 m0, s84, 4096
    s_nop 0
    buffer_load_dwordx4 v229, s[56:59], s88 offen offset:0 lds
    v_mfma_f32_16x16x32_bf16 v[44:47], v[176:179], v[212:215], v[44:47]
    buffer_load_dwordx4 v230, s[56:59], s88 offen offset:1024 lds
    v_mfma_f32_16x16x32_bf16 v[48:51], v[180:183], v[200:203], v[48:51]
    buffer_load_dwordx4 v231, s[56:59], s88 offen offset:2048 lds
    v_mfma_f32_16x16x32_bf16 v[52:55], v[180:183], v[204:207], v[52:55]
    buffer_load_dwordx4 v232, s[56:59], s88 offen offset:3072 lds
    v_mfma_f32_16x16x32_bf16 v[56:59], v[180:183], v[208:211], v[56:59]
    s_add_u32 m0, s84, 8192
    s_nop 0
    buffer_load_dwordx4 v233, s[56:59], s88 offen offset:0 lds
    v_mfma_f32_16x16x32_bf16 v[60:63], v[180:183], v[212:215], v[60:63]
    s_waitcnt lgkmcnt(0)
    v_mfma_f32_16x16x32_bf16 v[64:67], v[160:163], v[200:203], v[64:67]
    ds_read_b64_tr_b16 v[172:173], v236 offset:9408
    v_mfma_f32_16x16x32_bf16 v[68:71], v[160:163], v[204:207], v[68:71]
    ds_read_b64_tr_b16 v[174:175], v236 offset:14016
    v_mfma_f32_16x16x32_bf16 v[72:75], v[160:163], v[208:211], v[72:75]
    ds_read_b64_tr_b16 v[176:177], v236 offset:9440
    v_mfma_f32_16x16x32_bf16 v[76:79], v[160:163], v[212:215], v[76:79]
    ds_read_b64_tr_b16 v[178:179], v236 offset:14048
    v_mfma_f32_16x16x32_bf16 v[80:83], v[164:167], v[200:203], v[80:83]
    ds_read_b64_tr_b16 v[180:181], v236 offset:9472
    v_mfma_f32_16x16x32_bf16 v[84:87], v[164:167], v[204:207], v[84:87]
    v_mfma_f32_16x16x32_bf16 v[88:91], v[164:167], v[208:211], v[88:91]
    ds_read_b64_tr_b16 v[182:183], v236 offset:14080
    v_mfma_f32_16x16x32_bf16 v[92:95], v[164:167], v[212:215], v[92:95]
    ds_read_b128 v[184:187], v234 offset:256
    v_mfma_f32_16x16x32_bf16 v[96:99], v[168:171], v[200:203], v[96:99]
    ds_read_b128 v[188:191], v234 offset:18688
    v_mfma_f32_16x16x32_bf16 v[100:103], v[168:171], v[204:207], v[100:103]
    ds_read_b128 v[192:195], v234 offset:37120
    v_mfma_f32_16x16x32_bf16 v[104:107], v[168:171], v[208:211], v[104:107]
    ds_read_b128 v[196:199], v234 offset:55552
    v_mfma_f32_16x16x32_bf16 v[108:111], v[168:171], v[212:215], v[108:111]
    s_waitcnt lgkmcnt(4)
    s_waitcnt vmcnt(0)
    v_mfma_f32_16x16x32_bf16 v[112:115], v[172:175], v[200:203], v[112:115]
    ds_read_b64_tr_b16 v[160:161], v236 offset:0
    v_mfma_f32_16x16x32_bf16 v[116:119], v[172:175], v[204:207], v[116:119]
    ds_read_b64_tr_b16 v[162:163], v236 offset:4608
    v_mfma_f32_16x16x32_bf16 v[120:123], v[172:175], v[208:211], v[120:123]
    ds_read_b64_tr_b16 v[164:165], v236 offset:32
    v_mfma_f32_16x16x32_bf16 v[124:127], v[172:175], v[212:215], v[124:127]
    ds_read_b64_tr_b16 v[166:167], v236 offset:4640
    v_mfma_f32_16x16x32_bf16 v[128:131], v[176:179], v[200:203], v[128:131]
    ds_read_b64_tr_b16 v[168:169], v236 offset:64
    v_mfma_f32_16x16x32_bf16 v[132:135], v[176:179], v[204:207], v[132:135]
    v_mfma_f32_16x16x32_bf16 v[136:139], v[176:179], v[208:211], v[136:139]
    ds_read_b64_tr_b16 v[170:171], v236 offset:4672
    v_mfma_f32_16x16x32_bf16 v[140:143], v[176:179], v[212:215], v[140:143]
    s_add_u32 s88, s86, 184320
    s_add_u32 m0, s84, 9216
    s_nop 0
    buffer_load_dwordx4 v225, s[56:59], s88 offen offset:0 lds
    v_mfma_f32_16x16x32_bf16 v[144:147], v[180:183], v[200:203], v[144:147]
    buffer_load_dwordx4 v226, s[56:59], s88 offen offset:1024 lds
    v_mfma_f32_16x16x32_bf16 v[148:151], v[180:183], v[204:207], v[148:151]
    buffer_load_dwordx4 v227, s[56:59], s88 offen offset:2048 lds
    v_mfma_f32_16x16x32_bf16 v[152:155], v[180:183], v[208:211], v[152:155]
    buffer_load_dwordx4 v228, s[56:59], s88 offen offset:3072 lds
    v_mfma_f32_16x16x32_bf16 v[156:159], v[180:183], v[212:215], v[156:159]
    s_waitcnt lgkmcnt(0)
    v_mfma_f32_16x16x32_bf16 v[16:19], v[160:163], v[184:187], v[16:19]
    ds_read_b64_tr_b16 v[172:173], v236 offset:96
    v_mfma_f32_16x16x32_bf16 v[20:23], v[160:163], v[188:191], v[20:23]
    ds_read_b64_tr_b16 v[174:175], v236 offset:4704
    v_mfma_f32_16x16x32_bf16 v[24:27], v[160:163], v[192:195], v[24:27]
    ds_read_b64_tr_b16 v[176:177], v236 offset:128
    v_mfma_f32_16x16x32_bf16 v[28:31], v[160:163], v[196:199], v[28:31]
    ds_read_b64_tr_b16 v[178:179], v236 offset:4736
    v_mfma_f32_16x16x32_bf16 v[32:35], v[164:167], v[184:187], v[32:35]
    ds_read_b64_tr_b16 v[180:181], v236 offset:160
    v_mfma_f32_16x16x32_bf16 v[36:39], v[164:167], v[188:191], v[36:39]
    ds_read_b64_tr_b16 v[182:183], v236 offset:4768
    v_mfma_f32_16x16x32_bf16 v[40:43], v[164:167], v[192:195], v[40:43]
    s_add_u32 m0, s84, 13312
    s_nop 0
    buffer_load_dwordx4 v229, s[56:59], s88 offen offset:0 lds
    v_mfma_f32_16x16x32_bf16 v[44:47], v[164:167], v[196:199], v[44:47]
    buffer_load_dwordx4 v230, s[56:59], s88 offen offset:1024 lds
    v_mfma_f32_16x16x32_bf16 v[48:51], v[168:171], v[184:187], v[48:51]
    buffer_load_dwordx4 v231, s[56:59], s88 offen offset:2048 lds
    v_mfma_f32_16x16x32_bf16 v[52:55], v[168:171], v[188:191], v[52:55]
    buffer_load_dwordx4 v232, s[56:59], s88 offen offset:3072 lds
    v_mfma_f32_16x16x32_bf16 v[56:59], v[168:171], v[192:195], v[56:59]
    s_add_u32 m0, s84, 17408
    s_nop 0
    buffer_load_dwordx4 v233, s[56:59], s88 offen offset:0 lds
    v_mfma_f32_16x16x32_bf16 v[60:63], v[168:171], v[196:199], v[60:63]
    s_waitcnt lgkmcnt(0)
    v_mfma_f32_16x16x32_bf16 v[64:67], v[172:175], v[184:187], v[64:67]
    ds_read_b64_tr_b16 v[160:161], v236 offset:192
    v_mfma_f32_16x16x32_bf16 v[68:71], v[172:175], v[188:191], v[68:71]
    ds_read_b64_tr_b16 v[162:163], v236 offset:4800
    v_mfma_f32_16x16x32_bf16 v[72:75], v[172:175], v[192:195], v[72:75]
    ds_read_b64_tr_b16 v[164:165], v236 offset:224
    v_mfma_f32_16x16x32_bf16 v[76:79], v[172:175], v[196:199], v[76:79]
    ds_read_b64_tr_b16 v[166:167], v236 offset:4832
    v_mfma_f32_16x16x32_bf16 v[80:83], v[176:179], v[184:187], v[80:83]
    ds_read_b64_tr_b16 v[168:169], v236 offset:256
    v_mfma_f32_16x16x32_bf16 v[84:87], v[176:179], v[188:191], v[84:87]
    v_mfma_f32_16x16x32_bf16 v[88:91], v[176:179], v[192:195], v[88:91]
    ds_read_b64_tr_b16 v[170:171], v236 offset:4864
    v_mfma_f32_16x16x32_bf16 v[92:95], v[176:179], v[196:199], v[92:95]
    ds_read_b128 v[200:203], v235 offset:256
    v_mfma_f32_16x16x32_bf16 v[96:99], v[180:183], v[184:187], v[96:99]
    ds_read_b128 v[204:207], v235 offset:18688
    v_mfma_f32_16x16x32_bf16 v[100:103], v[180:183], v[188:191], v[100:103]
    ds_read_b128 v[208:211], v235 offset:37120
    v_mfma_f32_16x16x32_bf16 v[104:107], v[180:183], v[192:195], v[104:107]
    ds_read_b128 v[212:215], v235 offset:55552
    v_mfma_f32_16x16x32_bf16 v[108:111], v[180:183], v[196:199], v[108:111]
    s_waitcnt lgkmcnt(4)
    s_waitcnt vmcnt(0)
    v_mfma_f32_16x16x32_bf16 v[112:115], v[160:163], v[184:187], v[112:115]
    ds_read_b64_tr_b16 v[172:173], v236 offset:9216
    v_mfma_f32_16x16x32_bf16 v[116:119], v[160:163], v[188:191], v[116:119]
    ds_read_b64_tr_b16 v[174:175], v236 offset:13824
    v_mfma_f32_16x16x32_bf16 v[120:123], v[160:163], v[192:195], v[120:123]
    ds_read_b64_tr_b16 v[176:177], v236 offset:9248
    v_mfma_f32_16x16x32_bf16 v[124:127], v[160:163], v[196:199], v[124:127]
    ds_read_b64_tr_b16 v[178:179], v236 offset:13856
    v_mfma_f32_16x16x32_bf16 v[128:131], v[164:167], v[184:187], v[128:131]
    ds_read_b64_tr_b16 v[180:181], v236 offset:9280
    v_mfma_f32_16x16x32_bf16 v[132:135], v[164:167], v[188:191], v[132:135]
    v_mfma_f32_16x16x32_bf16 v[136:139], v[164:167], v[192:195], v[136:139]
    ds_read_b64_tr_b16 v[182:183], v236 offset:13888
    v_mfma_f32_16x16x32_bf16 v[140:143], v[164:167], v[196:199], v[140:143]
    s_add_u32 s88, s86, 221184
    s_add_u32 m0, s84, 0
    s_nop 0
    buffer_load_dwordx4 v225, s[56:59], s88 offen offset:0 lds
    v_mfma_f32_16x16x32_bf16 v[144:147], v[168:171], v[184:187], v[144:147]
    buffer_load_dwordx4 v226, s[56:59], s88 offen offset:1024 lds
    v_mfma_f32_16x16x32_bf16 v[148:151], v[168:171], v[188:191], v[148:151]
    buffer_load_dwordx4 v227, s[56:59], s88 offen offset:2048 lds
    v_mfma_f32_16x16x32_bf16 v[152:155], v[168:171], v[192:195], v[152:155]
    buffer_load_dwordx4 v228, s[56:59], s88 offen offset:3072 lds
    v_mfma_f32_16x16x32_bf16 v[156:159], v[168:171], v[196:199], v[156:159]
    s_waitcnt lgkmcnt(0)
    v_mfma_f32_16x16x32_bf16 v[16:19], v[172:175], v[200:203], v[16:19]
    ds_read_b64_tr_b16 v[160:161], v236 offset:9312
    v_mfma_f32_16x16x32_bf16 v[20:23], v[172:175], v[204:207], v[20:23]
    ds_read_b64_tr_b16 v[162:163], v236 offset:13920
    v_mfma_f32_16x16x32_bf16 v[24:27], v[172:175], v[208:211], v[24:27]
    ds_read_b64_tr_b16 v[164:165], v236 offset:9344
    v_mfma_f32_16x16x32_bf16 v[28:31], v[172:175], v[212:215], v[28:31]
    ds_read_b64_tr_b16 v[166:167], v236 offset:13952
    v_mfma_f32_16x16x32_bf16 v[32:35], v[176:179], v[200:203], v[32:35]
    ds_read_b64_tr_b16 v[168:169], v236 offset:9376
    v_mfma_f32_16x16x32_bf16 v[36:39], v[176:179], v[204:207], v[36:39]
    ds_read_b64_tr_b16 v[170:171], v236 offset:13984
    v_mfma_f32_16x16x32_bf16 v[40:43], v[176:179], v[208:211], v[40:43]
    s_add_u32 m0, s84, 4096
    s_nop 0
    buffer_load_dwordx4 v229, s[56:59], s88 offen offset:0 lds
    v_mfma_f32_16x16x32_bf16 v[44:47], v[176:179], v[212:215], v[44:47]
    buffer_load_dwordx4 v230, s[56:59], s88 offen offset:1024 lds
    v_mfma_f32_16x16x32_bf16 v[48:51], v[180:183], v[200:203], v[48:51]
    buffer_load_dwordx4 v231, s[56:59], s88 offen offset:2048 lds
    v_mfma_f32_16x16x32_bf16 v[52:55], v[180:183], v[204:207], v[52:55]
    buffer_load_dwordx4 v232, s[56:59], s88 offen offset:3072 lds
    v_mfma_f32_16x16x32_bf16 v[56:59], v[180:183], v[208:211], v[56:59]
    s_add_u32 m0, s84, 8192
    s_nop 0
    buffer_load_dwordx4 v233, s[56:59], s88 offen offset:0 lds
    v_mfma_f32_16x16x32_bf16 v[60:63], v[180:183], v[212:215], v[60:63]
    s_waitcnt lgkmcnt(0)
    v_mfma_f32_16x16x32_bf16 v[64:67], v[160:163], v[200:203], v[64:67]
    ds_read_b64_tr_b16 v[172:173], v236 offset:9408
    v_mfma_f32_16x16x32_bf16 v[68:71], v[160:163], v[204:207], v[68:71]
    ds_read_b64_tr_b16 v[174:175], v236 offset:14016
    v_mfma_f32_16x16x32_bf16 v[72:75], v[160:163], v[208:211], v[72:75]
    ds_read_b64_tr_b16 v[176:177], v236 offset:9440
    v_mfma_f32_16x16x32_bf16 v[76:79], v[160:163], v[212:215], v[76:79]
    ds_read_b64_tr_b16 v[178:179], v236 offset:14048
    v_mfma_f32_16x16x32_bf16 v[80:83], v[164:167], v[200:203], v[80:83]
    ds_read_b64_tr_b16 v[180:181], v236 offset:9472
    v_mfma_f32_16x16x32_bf16 v[84:87], v[164:167], v[204:207], v[84:87]
    v_mfma_f32_16x16x32_bf16 v[88:91], v[164:167], v[208:211], v[88:91]
    ds_read_b64_tr_b16 v[182:183], v236 offset:14080
    v_mfma_f32_16x16x32_bf16 v[92:95], v[164:167], v[212:215], v[92:95]
    ds_read_b128 v[184:187], v234 offset:384
    v_mfma_f32_16x16x32_bf16 v[96:99], v[168:171], v[200:203], v[96:99]
    ds_read_b128 v[188:191], v234 offset:18816
    v_mfma_f32_16x16x32_bf16 v[100:103], v[168:171], v[204:207], v[100:103]
    ds_read_b128 v[192:195], v234 offset:37248
    v_mfma_f32_16x16x32_bf16 v[104:107], v[168:171], v[208:211], v[104:107]
    ds_read_b128 v[196:199], v234 offset:55680
    v_mfma_f32_16x16x32_bf16 v[108:111], v[168:171], v[212:215], v[108:111]
    s_waitcnt lgkmcnt(4)
    s_waitcnt vmcnt(0)
    v_mfma_f32_16x16x32_bf16 v[112:115], v[172:175], v[200:203], v[112:115]
    ds_read_b64_tr_b16 v[160:161], v236 offset:0
    v_mfma_f32_16x16x32_bf16 v[116:119], v[172:175], v[204:207], v[116:119]
    ds_read_b64_tr_b16 v[162:163], v236 offset:4608
    v_mfma_f32_16x16x32_bf16 v[120:123], v[172:175], v[208:211], v[120:123]
    ds_read_b64_tr_b16 v[164:165], v236 offset:32
    v_mfma_f32_16x16x32_bf16 v[124:127], v[172:175], v[212:215], v[124:127]
    ds_read_b64_tr_b16 v[166:167], v236 offset:4640
    v_mfma_f32_16x16x32_bf16 v[128:131], v[176:179], v[200:203], v[128:131]
    ds_read_b64_tr_b16 v[168:169], v236 offset:64
    v_mfma_f32_16x16x32_bf16 v[132:135], v[176:179], v[204:207], v[132:135]
    v_mfma_f32_16x16x32_bf16 v[136:139], v[176:179], v[208:211], v[136:139]
    ds_read_b64_tr_b16 v[170:171], v236 offset:4672
    v_mfma_f32_16x16x32_bf16 v[140:143], v[176:179], v[212:215], v[140:143]
    s_add_u32 s88, s86, 258048
    s_add_u32 m0, s84, 9216
    s_nop 0
    buffer_load_dwordx4 v225, s[56:59], s88 offen offset:0 lds
    v_mfma_f32_16x16x32_bf16 v[144:147], v[180:183], v[200:203], v[144:147]
    buffer_load_dwordx4 v226, s[56:59], s88 offen offset:1024 lds
    v_mfma_f32_16x16x32_bf16 v[148:151], v[180:183], v[204:207], v[148:151]
    buffer_load_dwordx4 v227, s[56:59], s88 offen offset:2048 lds
    v_mfma_f32_16x16x32_bf16 v[152:155], v[180:183], v[208:211], v[152:155]
    buffer_load_dwordx4 v228, s[56:59], s88 offen offset:3072 lds
    v_mfma_f32_16x16x32_bf16 v[156:159], v[180:183], v[212:215], v[156:159]
    s_waitcnt lgkmcnt(0)
    v_mfma_f32_16x16x32_bf16 v[16:19], v[160:163], v[184:187], v[16:19]
    ds_read_b64_tr_b16 v[172:173], v236 offset:96
    v_mfma_f32_16x16x32_bf16 v[20:23], v[160:163], v[188:191], v[20:23]
    ds_read_b64_tr_b16 v[174:175], v236 offset:4704
    v_mfma_f32_16x16x32_bf16 v[24:27], v[160:163], v[192:195], v[24:27]
    ds_read_b64_tr_b16 v[176:177], v236 offset:128
    v_mfma_f32_16x16x32_bf16 v[28:31], v[160:163], v[196:199], v[28:31]
    ds_read_b64_tr_b16 v[178:179], v236 offset:4736
    v_mfma_f32_16x16x32_bf16 v[32:35], v[164:167], v[184:187], v[32:35]
    ds_read_b64_tr_b16 v[180:181], v236 offset:160
    v_mfma_f32_16x16x32_bf16 v[36:39], v[164:167], v[188:191], v[36:39]
    ds_read_b64_tr_b16 v[182:183], v236 offset:4768
    v_mfma_f32_16x16x32_bf16 v[40:43], v[164:167], v[192:195], v[40:43]
    s_add_u32 m0, s84, 13312
    s_nop 0
    buffer_load_dwordx4 v229, s[56:59], s88 offen offset:0 lds
    v_mfma_f32_16x16x32_bf16 v[44:47], v[164:167], v[196:199], v[44:47]
    buffer_load_dwordx4 v230, s[56:59], s88 offen offset:1024 lds
    v_mfma_f32_16x16x32_bf16 v[48:51], v[168:171], v[184:187], v[48:51]
    buffer_load_dwordx4 v231, s[56:59], s88 offen offset:2048 lds
    v_mfma_f32_16x16x32_bf16 v[52:55], v[168:171], v[188:191], v[52:55]
    buffer_load_dwordx4 v232, s[56:59], s88 offen offset:3072 lds
    v_mfma_f32_16x16x32_bf16 v[56:59], v[168:171], v[192:195], v[56:59]
    s_add_u32 m0, s84, 17408
    s_nop 0
    buffer_load_dwordx4 v233, s[56:59], s88 offen offset:0 lds
    v_mfma_f32_16x16x32_bf16 v[60:63], v[168:171], v[196:199], v[60:63]
    s_waitcnt lgkmcnt(0)
    v_mfma_f32_16x16x32_bf16 v[64:67], v[172:175], v[184:187], v[64:67]
    ds_read_b64_tr_b16 v[160:161], v236 offset:192
    v_mfma_f32_16x16x32_bf16 v[68:71], v[172:175], v[188:191], v[68:71]
    ds_read_b64_tr_b16 v[162:163], v236 offset:4800
    v_mfma_f32_16x16x32_bf16 v[72:75], v[172:175], v[192:195], v[72:75]
    ds_read_b64_tr_b16 v[164:165], v236 offset:224
    v_mfma_f32_16x16x32_bf16 v[76:79], v[172:175], v[196:199], v[76:79]
    ds_read_b64_tr_b16 v[166:167], v236 offset:4832
    v_mfma_f32_16x16x32_bf16 v[80:83], v[176:179], v[184:187], v[80:83]
    ds_read_b64_tr_b16 v[168:169], v236 offset:256
    v_mfma_f32_16x16x32_bf16 v[84:87], v[176:179], v[188:191], v[84:87]
    v_mfma_f32_16x16x32_bf16 v[88:91], v[176:179], v[192:195], v[88:91]
    ds_read_b64_tr_b16 v[170:171], v236 offset:4864
    v_mfma_f32_16x16x32_bf16 v[92:95], v[176:179], v[196:199], v[92:95]
    ds_read_b128 v[200:203], v235 offset:384
    v_mfma_f32_16x16x32_bf16 v[96:99], v[180:183], v[184:187], v[96:99]
    ds_read_b128 v[204:207], v235 offset:18816
    v_mfma_f32_16x16x32_bf16 v[100:103], v[180:183], v[188:191], v[100:103]
    ds_read_b128 v[208:211], v235 offset:37248
    v_mfma_f32_16x16x32_bf16 v[104:107], v[180:183], v[192:195], v[104:107]
    ds_read_b128 v[212:215], v235 offset:55680
    v_mfma_f32_16x16x32_bf16 v[108:111], v[180:183], v[196:199], v[108:111]
    s_waitcnt lgkmcnt(4)
    s_waitcnt vmcnt(0)
    v_mfma_f32_16x16x32_bf16 v[112:115], v[160:163], v[184:187], v[112:115]
    ds_read_b64_tr_b16 v[172:173], v236 offset:9216
    v_mfma_f32_16x16x32_bf16 v[116:119], v[160:163], v[188:191], v[116:119]
    ds_read_b64_tr_b16 v[174:175], v236 offset:13824
    v_mfma_f32_16x16x32_bf16 v[120:123], v[160:163], v[192:195], v[120:123]
    ds_read_b64_tr_b16 v[176:177], v236 offset:9248
    v_mfma_f32_16x16x32_bf16 v[124:127], v[160:163], v[196:199], v[124:127]
    ds_read_b64_tr_b16 v[178:179], v236 offset:13856
    v_mfma_f32_16x16x32_bf16 v[128:131], v[164:167], v[184:187], v[128:131]
    ds_read_b64_tr_b16 v[180:181], v236 offset:9280
    v_mfma_f32_16x16x32_bf16 v[132:135], v[164:167], v[188:191], v[132:135]
    v_mfma_f32_16x16x32_bf16 v[136:139], v[164:167], v[192:195], v[136:139]
    ds_read_b64_tr_b16 v[182:183], v236 offset:13888
    v_mfma_f32_16x16x32_bf16 v[140:143], v[164:167], v[196:199], v[140:143]
    s_add_u32 s88, s86, 294912
    s_add_u32 m0, s84, 0
    s_nop 0
    buffer_load_dwordx4 v225, s[56:59], s88 offen offset:0 lds
    v_mfma_f32_16x16x32_bf16 v[144:147], v[168:171], v[184:187], v[144:147]
    buffer_load_dwordx4 v226, s[56:59], s88 offen offset:1024 lds
    v_mfma_f32_16x16x32_bf16 v[148:151], v[168:171], v[188:191], v[148:151]
    buffer_load_dwordx4 v227, s[56:59], s88 offen offset:2048 lds
    v_mfma_f32_16x16x32_bf16 v[152:155], v[168:171], v[192:195], v[152:155]
    buffer_load_dwordx4 v228, s[56:59], s88 offen offset:3072 lds
    v_mfma_f32_16x16x32_bf16 v[156:159], v[168:171], v[196:199], v[156:159]
    s_waitcnt lgkmcnt(0)
    v_mfma_f32_16x16x32_bf16 v[16:19], v[172:175], v[200:203], v[16:19]
    ds_read_b64_tr_b16 v[160:161], v236 offset:9312
    v_mfma_f32_16x16x32_bf16 v[20:23], v[172:175], v[204:207], v[20:23]
    ds_read_b64_tr_b16 v[162:163], v236 offset:13920
    v_mfma_f32_16x16x32_bf16 v[24:27], v[172:175], v[208:211], v[24:27]
    ds_read_b64_tr_b16 v[164:165], v236 offset:9344
    v_mfma_f32_16x16x32_bf16 v[28:31], v[172:175], v[212:215], v[28:31]
    ds_read_b64_tr_b16 v[166:167], v236 offset:13952
    v_mfma_f32_16x16x32_bf16 v[32:35], v[176:179], v[200:203], v[32:35]
    ds_read_b64_tr_b16 v[168:169], v236 offset:9376
    v_mfma_f32_16x16x32_bf16 v[36:39], v[176:179], v[204:207], v[36:39]
    ds_read_b64_tr_b16 v[170:171], v236 offset:13984
    v_mfma_f32_16x16x32_bf16 v[40:43], v[176:179], v[208:211], v[40:43]
    s_add_u32 m0, s84, 4096
    s_nop 0
    buffer_load_dwordx4 v229, s[56:59], s88 offen offset:0 lds
    v_mfma_f32_16x16x32_bf16 v[44:47], v[176:179], v[212:215], v[44:47]
    buffer_load_dwordx4 v230, s[56:59], s88 offen offset:1024 lds
    v_mfma_f32_16x16x32_bf16 v[48:51], v[180:183], v[200:203], v[48:51]
    buffer_load_dwordx4 v231, s[56:59], s88 offen offset:2048 lds
    v_mfma_f32_16x16x32_bf16 v[52:55], v[180:183], v[204:207], v[52:55]
    buffer_load_dwordx4 v232, s[56:59], s88 offen offset:3072 lds
    v_mfma_f32_16x16x32_bf16 v[56:59], v[180:183], v[208:211], v[56:59]
    s_add_u32 m0, s84, 8192
    s_nop 0
    buffer_load_dwordx4 v233, s[56:59], s88 offen offset:0 lds
    v_mfma_f32_16x16x32_bf16 v[60:63], v[180:183], v[212:215], v[60:63]
    s_waitcnt lgkmcnt(0)
    v_mfma_f32_16x16x32_bf16 v[64:67], v[160:163], v[200:203], v[64:67]
    ds_read_b64_tr_b16 v[172:173], v236 offset:9408
    v_mfma_f32_16x16x32_bf16 v[68:71], v[160:163], v[204:207], v[68:71]
    ds_read_b64_tr_b16 v[174:175], v236 offset:14016
    v_mfma_f32_16x16x32_bf16 v[72:75], v[160:163], v[208:211], v[72:75]
    ds_read_b64_tr_b16 v[176:177], v236 offset:9440
    v_mfma_f32_16x16x32_bf16 v[76:79], v[160:163], v[212:215], v[76:79]
    ds_read_b64_tr_b16 v[178:179], v236 offset:14048
    v_mfma_f32_16x16x32_bf16 v[80:83], v[164:167], v[200:203], v[80:83]
    ds_read_b64_tr_b16 v[180:181], v236 offset:9472
    v_mfma_f32_16x16x32_bf16 v[84:87], v[164:167], v[204:207], v[84:87]
    v_mfma_f32_16x16x32_bf16 v[88:91], v[164:167], v[208:211], v[88:91]
    ds_read_b64_tr_b16 v[182:183], v236 offset:14080
    v_mfma_f32_16x16x32_bf16 v[92:95], v[164:167], v[212:215], v[92:95]
    ds_read_b128 v[184:187], v234 offset:512
    v_mfma_f32_16x16x32_bf16 v[96:99], v[168:171], v[200:203], v[96:99]
    ds_read_b128 v[188:191], v234 offset:18944
    v_mfma_f32_16x16x32_bf16 v[100:103], v[168:171], v[204:207], v[100:103]
    ds_read_b128 v[192:195], v234 offset:37376
    v_mfma_f32_16x16x32_bf16 v[104:107], v[168:171], v[208:211], v[104:107]
    ds_read_b128 v[196:199], v234 offset:55808
    v_mfma_f32_16x16x32_bf16 v[108:111], v[168:171], v[212:215], v[108:111]
    s_waitcnt lgkmcnt(4)
    s_waitcnt vmcnt(0)
    v_mfma_f32_16x16x32_bf16 v[112:115], v[172:175], v[200:203], v[112:115]
    ds_read_b64_tr_b16 v[160:161], v236 offset:0
    v_mfma_f32_16x16x32_bf16 v[116:119], v[172:175], v[204:207], v[116:119]
    ds_read_b64_tr_b16 v[162:163], v236 offset:4608
    v_mfma_f32_16x16x32_bf16 v[120:123], v[172:175], v[208:211], v[120:123]
    ds_read_b64_tr_b16 v[164:165], v236 offset:32
    v_mfma_f32_16x16x32_bf16 v[124:127], v[172:175], v[212:215], v[124:127]
    ds_read_b64_tr_b16 v[166:167], v236 offset:4640
    v_mfma_f32_16x16x32_bf16 v[128:131], v[176:179], v[200:203], v[128:131]
    ds_read_b64_tr_b16 v[168:169], v236 offset:64
    v_mfma_f32_16x16x32_bf16 v[132:135], v[176:179], v[204:207], v[132:135]
    v_mfma_f32_16x16x32_bf16 v[136:139], v[176:179], v[208:211], v[136:139]
    ds_read_b64_tr_b16 v[170:171], v236 offset:4672
    v_mfma_f32_16x16x32_bf16 v[140:143], v[176:179], v[212:215], v[140:143]
    s_add_u32 s88, s86, 331776
    s_add_u32 m0, s84, 9216
    s_nop 0
    buffer_load_dwordx4 v225, s[56:59], s88 offen offset:0 lds
    v_mfma_f32_16x16x32_bf16 v[144:147], v[180:183], v[200:203], v[144:147]
    buffer_load_dwordx4 v226, s[56:59], s88 offen offset:1024 lds
    v_mfma_f32_16x16x32_bf16 v[148:151], v[180:183], v[204:207], v[148:151]
    buffer_load_dwordx4 v227, s[56:59], s88 offen offset:2048 lds
    v_mfma_f32_16x16x32_bf16 v[152:155], v[180:183], v[208:211], v[152:155]
    buffer_load_dwordx4 v228, s[56:59], s88 offen offset:3072 lds
    v_mfma_f32_16x16x32_bf16 v[156:159], v[180:183], v[212:215], v[156:159]
    s_waitcnt lgkmcnt(0)
    v_mfma_f32_16x16x32_bf16 v[16:19], v[160:163], v[184:187], v[16:19]
    ds_read_b64_tr_b16 v[172:173], v236 offset:96
    v_mfma_f32_16x16x32_bf16 v[20:23], v[160:163], v[188:191], v[20:23]
    ds_read_b64_tr_b16 v[174:175], v236 offset:4704
    v_mfma_f32_16x16x32_bf16 v[24:27], v[160:163], v[192:195], v[24:27]
    ds_read_b64_tr_b16 v[176:177], v236 offset:128
    v_mfma_f32_16x16x32_bf16 v[28:31], v[160:163], v[196:199], v[28:31]
    ds_read_b64_tr_b16 v[178:179], v236 offset:4736
    v_mfma_f32_16x16x32_bf16 v[32:35], v[164:167], v[184:187], v[32:35]
    ds_read_b64_tr_b16 v[180:181], v236 offset:160
    v_mfma_f32_16x16x32_bf16 v[36:39], v[164:167], v[188:191], v[36:39]
    ds_read_b64_tr_b16 v[182:183], v236 offset:4768
    v_mfma_f32_16x16x32_bf16 v[40:43], v[164:167], v[192:195], v[40:43]
    s_add_u32 m0, s84, 13312
    s_nop 0
    buffer_load_dwordx4 v229, s[56:59], s88 offen offset:0 lds
    v_mfma_f32_16x16x32_bf16 v[44:47], v[164:167], v[196:199], v[44:47]
    buffer_load_dwordx4 v230, s[56:59], s88 offen offset:1024 lds
    v_mfma_f32_16x16x32_bf16 v[48:51], v[168:171], v[184:187], v[48:51]
    buffer_load_dwordx4 v231, s[56:59], s88 offen offset:2048 lds
    v_mfma_f32_16x16x32_bf16 v[52:55], v[168:171], v[188:191], v[52:55]
    buffer_load_dwordx4 v232, s[56:59], s88 offen offset:3072 lds
    v_mfma_f32_16x16x32_bf16 v[56:59], v[168:171], v[192:195], v[56:59]
    s_add_u32 m0, s84, 17408
    s_nop 0
    buffer_load_dwordx4 v233, s[56:59], s88 offen offset:0 lds
    v_mfma_f32_16x16x32_bf16 v[60:63], v[168:171], v[196:199], v[60:63]
    s_waitcnt lgkmcnt(0)
    v_mfma_f32_16x16x32_bf16 v[64:67], v[172:175], v[184:187], v[64:67]
    ds_read_b64_tr_b16 v[160:161], v236 offset:192
    v_mfma_f32_16x16x32_bf16 v[68:71], v[172:175], v[188:191], v[68:71]
    ds_read_b64_tr_b16 v[162:163], v236 offset:4800
    v_mfma_f32_16x16x32_bf16 v[72:75], v[172:175], v[192:195], v[72:75]
    ds_read_b64_tr_b16 v[164:165], v236 offset:224
    v_mfma_f32_16x16x32_bf16 v[76:79], v[172:175], v[196:199], v[76:79]
    ds_read_b64_tr_b16 v[166:167], v236 offset:4832
    v_mfma_f32_16x16x32_bf16 v[80:83], v[176:179], v[184:187], v[80:83]
    ds_read_b64_tr_b16 v[168:169], v236 offset:256
    v_mfma_f32_16x16x32_bf16 v[84:87], v[176:179], v[188:191], v[84:87]
    v_mfma_f32_16x16x32_bf16 v[88:91], v[176:179], v[192:195], v[88:91]
    ds_read_b64_tr_b16 v[170:171], v236 offset:4864
    v_mfma_f32_16x16x32_bf16 v[92:95], v[176:179], v[196:199], v[92:95]
    ds_read_b128 v[200:203], v235 offset:512
    v_mfma_f32_16x16x32_bf16 v[96:99], v[180:183], v[184:187], v[96:99]
    ds_read_b128 v[204:207], v235 offset:18944
    v_mfma_f32_16x16x32_bf16 v[100:103], v[180:183], v[188:191], v[100:103]
    ds_read_b128 v[208:211], v235 offset:37376
    v_mfma_f32_16x16x32_bf16 v[104:107], v[180:183], v[192:195], v[104:107]
    ds_read_b128 v[212:215], v235 offset:55808
    v_mfma_f32_16x16x32_bf16 v[108:111], v[180:183], v[196:199], v[108:111]
    s_waitcnt lgkmcnt(4)
    s_waitcnt vmcnt(0)
    v_mfma_f32_16x16x32_bf16 v[112:115], v[160:163], v[184:187], v[112:115]
    ds_read_b64_tr_b16 v[172:173], v236 offset:9216
    v_mfma_f32_16x16x32_bf16 v[116:119], v[160:163], v[188:191], v[116:119]
    ds_read_b64_tr_b16 v[174:175], v236 offset:13824
    v_mfma_f32_16x16x32_bf16 v[120:123], v[160:163], v[192:195], v[120:123]
    ds_read_b64_tr_b16 v[176:177], v236 offset:9248
    v_mfma_f32_16x16x32_bf16 v[124:127], v[160:163], v[196:199], v[124:127]
    ds_read_b64_tr_b16 v[178:179], v236 offset:13856
    v_mfma_f32_16x16x32_bf16 v[128:131], v[164:167], v[184:187], v[128:131]
    ds_read_b64_tr_b16 v[180:181], v236 offset:9280
    v_mfma_f32_16x16x32_bf16 v[132:135], v[164:167], v[188:191], v[132:135]
    v_mfma_f32_16x16x32_bf16 v[136:139], v[164:167], v[192:195], v[136:139]
    ds_read_b64_tr_b16 v[182:183], v236 offset:13888
    v_mfma_f32_16x16x32_bf16 v[140:143], v[164:167], v[196:199], v[140:143]
    s_add_u32 s88, s86, 368640
    s_add_u32 m0, s84, 0
    s_nop 0
    buffer_load_dwordx4 v225, s[56:59], s88 offen offset:0 lds
    v_mfma_f32_16x16x32_bf16 v[144:147], v[168:171], v[184:187], v[144:147]
    buffer_load_dwordx4 v226, s[56:59], s88 offen offset:1024 lds
    v_mfma_f32_16x16x32_bf16 v[148:151], v[168:171], v[188:191], v[148:151]
    buffer_load_dwordx4 v227, s[56:59], s88 offen offset:2048 lds
    v_mfma_f32_16x16x32_bf16 v[152:155], v[168:171], v[192:195], v[152:155]
    buffer_load_dwordx4 v228, s[56:59], s88 offen offset:3072 lds
    v_mfma_f32_16x16x32_bf16 v[156:159], v[168:171], v[196:199], v[156:159]
    s_waitcnt lgkmcnt(0)
    v_mfma_f32_16x16x32_bf16 v[16:19], v[172:175], v[200:203], v[16:19]
    ds_read_b64_tr_b16 v[160:161], v236 offset:9312
    v_mfma_f32_16x16x32_bf16 v[20:23], v[172:175], v[204:207], v[20:23]
    ds_read_b64_tr_b16 v[162:163], v236 offset:13920
    v_mfma_f32_16x16x32_bf16 v[24:27], v[172:175], v[208:211], v[24:27]
    ds_read_b64_tr_b16 v[164:165], v236 offset:9344
    v_mfma_f32_16x16x32_bf16 v[28:31], v[172:175], v[212:215], v[28:31]
    ds_read_b64_tr_b16 v[166:167], v236 offset:13952
    v_mfma_f32_16x16x32_bf16 v[32:35], v[176:179], v[200:203], v[32:35]
    ds_read_b64_tr_b16 v[168:169], v236 offset:9376
    v_mfma_f32_16x16x32_bf16 v[36:39], v[176:179], v[204:207], v[36:39]
    ds_read_b64_tr_b16 v[170:171], v236 offset:13984
    v_mfma_f32_16x16x32_bf16 v[40:43], v[176:179], v[208:211], v[40:43]
    s_add_u32 m0, s84, 4096
    s_nop 0
    buffer_load_dwordx4 v229, s[56:59], s88 offen offset:0 lds
    v_mfma_f32_16x16x32_bf16 v[44:47], v[176:179], v[212:215], v[44:47]
    buffer_load_dwordx4 v230, s[56:59], s88 offen offset:1024 lds
    v_mfma_f32_16x16x32_bf16 v[48:51], v[180:183], v[200:203], v[48:51]
    buffer_load_dwordx4 v231, s[56:59], s88 offen offset:2048 lds
    v_mfma_f32_16x16x32_bf16 v[52:55], v[180:183], v[204:207], v[52:55]
    buffer_load_dwordx4 v232, s[56:59], s88 offen offset:3072 lds
    v_mfma_f32_16x16x32_bf16 v[56:59], v[180:183], v[208:211], v[56:59]
    s_add_u32 m0, s84, 8192
    s_nop 0
    buffer_load_dwordx4 v233, s[56:59], s88 offen offset:0 lds
    v_mfma_f32_16x16x32_bf16 v[60:63], v[180:183], v[212:215], v[60:63]
    s_waitcnt lgkmcnt(0)
    v_mfma_f32_16x16x32_bf16 v[64:67], v[160:163], v[200:203], v[64:67]
    ds_read_b64_tr_b16 v[172:173], v236 offset:9408
    v_mfma_f32_16x16x32_bf16 v[68:71], v[160:163], v[204:207], v[68:71]
    ds_read_b64_tr_b16 v[174:175], v236 offset:14016
    v_mfma_f32_16x16x32_bf16 v[72:75], v[160:163], v[208:211], v[72:75]
    ds_read_b64_tr_b16 v[176:177], v236 offset:9440
    v_mfma_f32_16x16x32_bf16 v[76:79], v[160:163], v[212:215], v[76:79]
    ds_read_b64_tr_b16 v[178:179], v236 offset:14048
    v_mfma_f32_16x16x32_bf16 v[80:83], v[164:167], v[200:203], v[80:83]
    ds_read_b64_tr_b16 v[180:181], v236 offset:9472
    v_mfma_f32_16x16x32_bf16 v[84:87], v[164:167], v[204:207], v[84:87]
    v_mfma_f32_16x16x32_bf16 v[88:91], v[164:167], v[208:211], v[88:91]
    ds_read_b64_tr_b16 v[182:183], v236 offset:14080
    v_mfma_f32_16x16x32_bf16 v[92:95], v[164:167], v[212:215], v[92:95]
    ds_read_b128 v[184:187], v234 offset:640
    v_mfma_f32_16x16x32_bf16 v[96:99], v[168:171], v[200:203], v[96:99]
    ds_read_b128 v[188:191], v234 offset:19072
    v_mfma_f32_16x16x32_bf16 v[100:103], v[168:171], v[204:207], v[100:103]
    ds_read_b128 v[192:195], v234 offset:37504
    v_mfma_f32_16x16x32_bf16 v[104:107], v[168:171], v[208:211], v[104:107]
    ds_read_b128 v[196:199], v234 offset:55936
    v_mfma_f32_16x16x32_bf16 v[108:111], v[168:171], v[212:215], v[108:111]
    s_waitcnt lgkmcnt(4)
    s_waitcnt vmcnt(0)
    v_mfma_f32_16x16x32_bf16 v[112:115], v[172:175], v[200:203], v[112:115]
    ds_read_b64_tr_b16 v[160:161], v236 offset:0
    v_mfma_f32_16x16x32_bf16 v[116:119], v[172:175], v[204:207], v[116:119]
    ds_read_b64_tr_b16 v[162:163], v236 offset:4608
    v_mfma_f32_16x16x32_bf16 v[120:123], v[172:175], v[208:211], v[120:123]
    ds_read_b64_tr_b16 v[164:165], v236 offset:32
    v_mfma_f32_16x16x32_bf16 v[124:127], v[172:175], v[212:215], v[124:127]
    ds_read_b64_tr_b16 v[166:167], v236 offset:4640
    v_mfma_f32_16x16x32_bf16 v[128:131], v[176:179], v[200:203], v[128:131]
    ds_read_b64_tr_b16 v[168:169], v236 offset:64
    v_mfma_f32_16x16x32_bf16 v[132:135], v[176:179], v[204:207], v[132:135]
    v_mfma_f32_16x16x32_bf16 v[136:139], v[176:179], v[208:211], v[136:139]
    ds_read_b64_tr_b16 v[170:171], v236 offset:4672
    v_mfma_f32_16x16x32_bf16 v[140:143], v[176:179], v[212:215], v[140:143]
    s_add_u32 s88, s86, 405504
    s_add_u32 m0, s84, 9216
    s_nop 0
    buffer_load_dwordx4 v225, s[56:59], s88 offen offset:0 lds
    v_mfma_f32_16x16x32_bf16 v[144:147], v[180:183], v[200:203], v[144:147]
    buffer_load_dwordx4 v226, s[56:59], s88 offen offset:1024 lds
    v_mfma_f32_16x16x32_bf16 v[148:151], v[180:183], v[204:207], v[148:151]
    buffer_load_dwordx4 v227, s[56:59], s88 offen offset:2048 lds
    v_mfma_f32_16x16x32_bf16 v[152:155], v[180:183], v[208:211], v[152:155]
    buffer_load_dwordx4 v228, s[56:59], s88 offen offset:3072 lds
    v_mfma_f32_16x16x32_bf16 v[156:159], v[180:183], v[212:215], v[156:159]
    s_waitcnt lgkmcnt(0)
    v_mfma_f32_16x16x32_bf16 v[16:19], v[160:163], v[184:187], v[16:19]
    ds_read_b64_tr_b16 v[172:173], v236 offset:96
    v_mfma_f32_16x16x32_bf16 v[20:23], v[160:163], v[188:191], v[20:23]
    ds_read_b64_tr_b16 v[174:175], v236 offset:4704
    v_mfma_f32_16x16x32_bf16 v[24:27], v[160:163], v[192:195], v[24:27]
    ds_read_b64_tr_b16 v[176:177], v236 offset:128
    v_mfma_f32_16x16x32_bf16 v[28:31], v[160:163], v[196:199], v[28:31]
    ds_read_b64_tr_b16 v[178:179], v236 offset:4736
    v_mfma_f32_16x16x32_bf16 v[32:35], v[164:167], v[184:187], v[32:35]
    ds_read_b64_tr_b16 v[180:181], v236 offset:160
    v_mfma_f32_16x16x32_bf16 v[36:39], v[164:167], v[188:191], v[36:39]
    ds_read_b64_tr_b16 v[182:183], v236 offset:4768
    v_mfma_f32_16x16x32_bf16 v[40:43], v[164:167], v[192:195], v[40:43]
    s_add_u32 m0, s84, 13312
    s_nop 0
    buffer_load_dwordx4 v229, s[56:59], s88 offen offset:0 lds
    v_mfma_f32_16x16x32_bf16 v[44:47], v[164:167], v[196:199], v[44:47]
    buffer_load_dwordx4 v230, s[56:59], s88 offen offset:1024 lds
    v_mfma_f32_16x16x32_bf16 v[48:51], v[168:171], v[184:187], v[48:51]
    buffer_load_dwordx4 v231, s[56:59], s88 offen offset:2048 lds
    v_mfma_f32_16x16x32_bf16 v[52:55], v[168:171], v[188:191], v[52:55]
    buffer_load_dwordx4 v232, s[56:59], s88 offen offset:3072 lds
    v_mfma_f32_16x16x32_bf16 v[56:59], v[168:171], v[192:195], v[56:59]
    s_add_u32 m0, s84, 17408
    s_nop 0
    buffer_load_dwordx4 v233, s[56:59], s88 offen offset:0 lds
    v_mfma_f32_16x16x32_bf16 v[60:63], v[168:171], v[196:199], v[60:63]
    s_waitcnt lgkmcnt(0)
    v_mfma_f32_16x16x32_bf16 v[64:67], v[172:175], v[184:187], v[64:67]
    ds_read_b64_tr_b16 v[160:161], v236 offset:192
    v_mfma_f32_16x16x32_bf16 v[68:71], v[172:175], v[188:191], v[68:71]
    ds_read_b64_tr_b16 v[162:163], v236 offset:4800
    v_mfma_f32_16x16x32_bf16 v[72:75], v[172:175], v[192:195], v[72:75]
    ds_read_b64_tr_b16 v[164:165], v236 offset:224
    v_mfma_f32_16x16x32_bf16 v[76:79], v[172:175], v[196:199], v[76:79]
    ds_read_b64_tr_b16 v[166:167], v236 offset:4832
    v_mfma_f32_16x16x32_bf16 v[80:83], v[176:179], v[184:187], v[80:83]
    ds_read_b64_tr_b16 v[168:169], v236 offset:256
    v_mfma_f32_16x16x32_bf16 v[84:87], v[176:179], v[188:191], v[84:87]
    v_mfma_f32_16x16x32_bf16 v[88:91], v[176:179], v[192:195], v[88:91]
    ds_read_b64_tr_b16 v[170:171], v236 offset:4864
    v_mfma_f32_16x16x32_bf16 v[92:95], v[176:179], v[196:199], v[92:95]
    ds_read_b128 v[200:203], v235 offset:640
    v_mfma_f32_16x16x32_bf16 v[96:99], v[180:183], v[184:187], v[96:99]
    ds_read_b128 v[204:207], v235 offset:19072
    v_mfma_f32_16x16x32_bf16 v[100:103], v[180:183], v[188:191], v[100:103]
    ds_read_b128 v[208:211], v235 offset:37504
    v_mfma_f32_16x16x32_bf16 v[104:107], v[180:183], v[192:195], v[104:107]
    ds_read_b128 v[212:215], v235 offset:55936
    v_mfma_f32_16x16x32_bf16 v[108:111], v[180:183], v[196:199], v[108:111]
    s_waitcnt lgkmcnt(4)
    s_waitcnt vmcnt(0)
    v_mfma_f32_16x16x32_bf16 v[112:115], v[160:163], v[184:187], v[112:115]
    ds_read_b64_tr_b16 v[172:173], v236 offset:9216
    v_mfma_f32_16x16x32_bf16 v[116:119], v[160:163], v[188:191], v[116:119]
    ds_read_b64_tr_b16 v[174:175], v236 offset:13824
    v_mfma_f32_16x16x32_bf16 v[120:123], v[160:163], v[192:195], v[120:123]
    ds_read_b64_tr_b16 v[176:177], v236 offset:9248
    v_mfma_f32_16x16x32_bf16 v[124:127], v[160:163], v[196:199], v[124:127]
    ds_read_b64_tr_b16 v[178:179], v236 offset:13856
    v_mfma_f32_16x16x32_bf16 v[128:131], v[164:167], v[184:187], v[128:131]
    ds_read_b64_tr_b16 v[180:181], v236 offset:9280
    v_mfma_f32_16x16x32_bf16 v[132:135], v[164:167], v[188:191], v[132:135]
    v_mfma_f32_16x16x32_bf16 v[136:139], v[164:167], v[192:195], v[136:139]
    ds_read_b64_tr_b16 v[182:183], v236 offset:13888
    v_mfma_f32_16x16x32_bf16 v[140:143], v[164:167], v[196:199], v[140:143]
    s_add_u32 s88, s86, 442368
    s_add_u32 m0, s84, 0
    s_nop 0
    buffer_load_dwordx4 v225, s[56:59], s88 offen offset:0 lds
    v_mfma_f32_16x16x32_bf16 v[144:147], v[168:171], v[184:187], v[144:147]
    buffer_load_dwordx4 v226, s[56:59], s88 offen offset:1024 lds
    v_mfma_f32_16x16x32_bf16 v[148:151], v[168:171], v[188:191], v[148:151]
    buffer_load_dwordx4 v227, s[56:59], s88 offen offset:2048 lds
    v_mfma_f32_16x16x32_bf16 v[152:155], v[168:171], v[192:195], v[152:155]
    buffer_load_dwordx4 v228, s[56:59], s88 offen offset:3072 lds
    v_mfma_f32_16x16x32_bf16 v[156:159], v[168:171], v[196:199], v[156:159]
    s_waitcnt lgkmcnt(0)
    v_mfma_f32_16x16x32_bf16 v[16:19], v[172:175], v[200:203], v[16:19]
    ds_read_b64_tr_b16 v[160:161], v236 offset:9312
    v_mfma_f32_16x16x32_bf16 v[20:23], v[172:175], v[204:207], v[20:23]
    ds_read_b64_tr_b16 v[162:163], v236 offset:13920
    v_mfma_f32_16x16x32_bf16 v[24:27], v[172:175], v[208:211], v[24:27]
    ds_read_b64_tr_b16 v[164:165], v236 offset:9344
    v_mfma_f32_16x16x32_bf16 v[28:31], v[172:175], v[212:215], v[28:31]
    ds_read_b64_tr_b16 v[166:167], v236 offset:13952
    v_mfma_f32_16x16x32_bf16 v[32:35], v[176:179], v[200:203], v[32:35]
    ds_read_b64_tr_b16 v[168:169], v236 offset:9376
    v_mfma_f32_16x16x32_bf16 v[36:39], v[176:179], v[204:207], v[36:39]
    ds_read_b64_tr_b16 v[170:171], v236 offset:13984
    v_mfma_f32_16x16x32_bf16 v[40:43], v[176:179], v[208:211], v[40:43]
    s_add_u32 m0, s84, 4096
    s_nop 0
    buffer_load_dwordx4 v229, s[56:59], s88 offen offset:0 lds
    v_mfma_f32_16x16x32_bf16 v[44:47], v[176:179], v[212:215], v[44:47]
    buffer_load_dwordx4 v230, s[56:59], s88 offen offset:1024 lds
    v_mfma_f32_16x16x32_bf16 v[48:51], v[180:183], v[200:203], v[48:51]
    buffer_load_dwordx4 v231, s[56:59], s88 offen offset:2048 lds
    v_mfma_f32_16x16x32_bf16 v[52:55], v[180:183], v[204:207], v[52:55]
    buffer_load_dwordx4 v232, s[56:59], s88 offen offset:3072 lds
    v_mfma_f32_16x16x32_bf16 v[56:59], v[180:183], v[208:211], v[56:59]
    s_add_u32 m0, s84, 8192
    s_nop 0
    buffer_load_dwordx4 v233, s[56:59], s88 offen offset:0 lds
    v_mfma_f32_16x16x32_bf16 v[60:63], v[180:183], v[212:215], v[60:63]
    s_waitcnt lgkmcnt(0)
    v_mfma_f32_16x16x32_bf16 v[64:67], v[160:163], v[200:203], v[64:67]
    ds_read_b64_tr_b16 v[172:173], v236 offset:9408
    v_mfma_f32_16x16x32_bf16 v[68:71], v[160:163], v[204:207], v[68:71]
    ds_read_b64_tr_b16 v[174:175], v236 offset:14016
    v_mfma_f32_16x16x32_bf16 v[72:75], v[160:163], v[208:211], v[72:75]
    ds_read_b64_tr_b16 v[176:177], v236 offset:9440
    v_mfma_f32_16x16x32_bf16 v[76:79], v[160:163], v[212:215], v[76:79]
    ds_read_b64_tr_b16 v[178:179], v236 offset:14048
    v_mfma_f32_16x16x32_bf16 v[80:83], v[164:167], v[200:203], v[80:83]
    ds_read_b64_tr_b16 v[180:181], v236 offset:9472
    v_mfma_f32_16x16x32_bf16 v[84:87], v[164:167], v[204:207], v[84:87]
    v_mfma_f32_16x16x32_bf16 v[88:91], v[164:167], v[208:211], v[88:91]
    ds_read_b64_tr_b16 v[182:183], v236 offset:14080
    v_mfma_f32_16x16x32_bf16 v[92:95], v[164:167], v[212:215], v[92:95]
    ds_read_b128 v[184:187], v234 offset:768
    v_mfma_f32_16x16x32_bf16 v[96:99], v[168:171], v[200:203], v[96:99]
    ds_read_b128 v[188:191], v234 offset:19200
    v_mfma_f32_16x16x32_bf16 v[100:103], v[168:171], v[204:207], v[100:103]
    ds_read_b128 v[192:195], v234 offset:37632
    v_mfma_f32_16x16x32_bf16 v[104:107], v[168:171], v[208:211], v[104:107]
    ds_read_b128 v[196:199], v234 offset:56064
    v_mfma_f32_16x16x32_bf16 v[108:111], v[168:171], v[212:215], v[108:111]
    s_waitcnt lgkmcnt(4)
    s_waitcnt vmcnt(0)
    v_mfma_f32_16x16x32_bf16 v[112:115], v[172:175], v[200:203], v[112:115]
    ds_read_b64_tr_b16 v[160:161], v236 offset:0
    v_mfma_f32_16x16x32_bf16 v[116:119], v[172:175], v[204:207], v[116:119]
    ds_read_b64_tr_b16 v[162:163], v236 offset:4608
    v_mfma_f32_16x16x32_bf16 v[120:123], v[172:175], v[208:211], v[120:123]
    ds_read_b64_tr_b16 v[164:165], v236 offset:32
    v_mfma_f32_16x16x32_bf16 v[124:127], v[172:175], v[212:215], v[124:127]
    ds_read_b64_tr_b16 v[166:167], v236 offset:4640
    v_mfma_f32_16x16x32_bf16 v[128:131], v[176:179], v[200:203], v[128:131]
    ds_read_b64_tr_b16 v[168:169], v236 offset:64
    v_mfma_f32_16x16x32_bf16 v[132:135], v[176:179], v[204:207], v[132:135]
    v_mfma_f32_16x16x32_bf16 v[136:139], v[176:179], v[208:211], v[136:139]
    ds_read_b64_tr_b16 v[170:171], v236 offset:4672
    v_mfma_f32_16x16x32_bf16 v[140:143], v[176:179], v[212:215], v[140:143]
    s_add_u32 s88, s86, 479232
    s_add_u32 m0, s84, 9216
    s_nop 0
    buffer_load_dwordx4 v225, s[56:59], s88 offen offset:0 lds
    v_mfma_f32_16x16x32_bf16 v[144:147], v[180:183], v[200:203], v[144:147]
    buffer_load_dwordx4 v226, s[56:59], s88 offen offset:1024 lds
    v_mfma_f32_16x16x32_bf16 v[148:151], v[180:183], v[204:207], v[148:151]
    buffer_load_dwordx4 v227, s[56:59], s88 offen offset:2048 lds
    v_mfma_f32_16x16x32_bf16 v[152:155], v[180:183], v[208:211], v[152:155]
    buffer_load_dwordx4 v228, s[56:59], s88 offen offset:3072 lds
    v_mfma_f32_16x16x32_bf16 v[156:159], v[180:183], v[212:215], v[156:159]
    s_waitcnt lgkmcnt(0)
    v_mfma_f32_16x16x32_bf16 v[16:19], v[160:163], v[184:187], v[16:19]
    ds_read_b64_tr_b16 v[172:173], v236 offset:96
    v_mfma_f32_16x16x32_bf16 v[20:23], v[160:163], v[188:191], v[20:23]
    ds_read_b64_tr_b16 v[174:175], v236 offset:4704
    v_mfma_f32_16x16x32_bf16 v[24:27], v[160:163], v[192:195], v[24:27]
    ds_read_b64_tr_b16 v[176:177], v236 offset:128
    v_mfma_f32_16x16x32_bf16 v[28:31], v[160:163], v[196:199], v[28:31]
    ds_read_b64_tr_b16 v[178:179], v236 offset:4736
    v_mfma_f32_16x16x32_bf16 v[32:35], v[164:167], v[184:187], v[32:35]
    ds_read_b64_tr_b16 v[180:181], v236 offset:160
    v_mfma_f32_16x16x32_bf16 v[36:39], v[164:167], v[188:191], v[36:39]
    ds_read_b64_tr_b16 v[182:183], v236 offset:4768
    v_mfma_f32_16x16x32_bf16 v[40:43], v[164:167], v[192:195], v[40:43]
    s_add_u32 m0, s84, 13312
    s_nop 0
    buffer_load_dwordx4 v229, s[56:59], s88 offen offset:0 lds
    v_mfma_f32_16x16x32_bf16 v[44:47], v[164:167], v[196:199], v[44:47]
    buffer_load_dwordx4 v230, s[56:59], s88 offen offset:1024 lds
    v_mfma_f32_16x16x32_bf16 v[48:51], v[168:171], v[184:187], v[48:51]
    buffer_load_dwordx4 v231, s[56:59], s88 offen offset:2048 lds
    v_mfma_f32_16x16x32_bf16 v[52:55], v[168:171], v[188:191], v[52:55]
    buffer_load_dwordx4 v232, s[56:59], s88 offen offset:3072 lds
    v_mfma_f32_16x16x32_bf16 v[56:59], v[168:171], v[192:195], v[56:59]
    s_add_u32 m0, s84, 17408
    s_nop 0
    buffer_load_dwordx4 v233, s[56:59], s88 offen offset:0 lds
    v_mfma_f32_16x16x32_bf16 v[60:63], v[168:171], v[196:199], v[60:63]
    s_waitcnt lgkmcnt(0)
    v_mfma_f32_16x16x32_bf16 v[64:67], v[172:175], v[184:187], v[64:67]
    ds_read_b64_tr_b16 v[160:161], v236 offset:192
    v_mfma_f32_16x16x32_bf16 v[68:71], v[172:175], v[188:191], v[68:71]
    ds_read_b64_tr_b16 v[162:163], v236 offset:4800
    v_mfma_f32_16x16x32_bf16 v[72:75], v[172:175], v[192:195], v[72:75]
    ds_read_b64_tr_b16 v[164:165], v236 offset:224
    v_mfma_f32_16x16x32_bf16 v[76:79], v[172:175], v[196:199], v[76:79]
    ds_read_b64_tr_b16 v[166:167], v236 offset:4832
    v_mfma_f32_16x16x32_bf16 v[80:83], v[176:179], v[184:187], v[80:83]
    ds_read_b64_tr_b16 v[168:169], v236 offset:256
    v_mfma_f32_16x16x32_bf16 v[84:87], v[176:179], v[188:191], v[84:87]
    v_mfma_f32_16x16x32_bf16 v[88:91], v[176:179], v[192:195], v[88:91]
    ds_read_b64_tr_b16 v[170:171], v236 offset:4864
    v_mfma_f32_16x16x32_bf16 v[92:95], v[176:179], v[196:199], v[92:95]
    ds_read_b128 v[200:203], v235 offset:768
    v_mfma_f32_16x16x32_bf16 v[96:99], v[180:183], v[184:187], v[96:99]
    ds_read_b128 v[204:207], v235 offset:19200
    v_mfma_f32_16x16x32_bf16 v[100:103], v[180:183], v[188:191], v[100:103]
    ds_read_b128 v[208:211], v235 offset:37632
    v_mfma_f32_16x16x32_bf16 v[104:107], v[180:183], v[192:195], v[104:107]
    ds_read_b128 v[212:215], v235 offset:56064
    v_mfma_f32_16x16x32_bf16 v[108:111], v[180:183], v[196:199], v[108:111]
    s_waitcnt lgkmcnt(4)
    s_waitcnt vmcnt(0)
    v_mfma_f32_16x16x32_bf16 v[112:115], v[160:163], v[184:187], v[112:115]
    ds_read_b64_tr_b16 v[172:173], v236 offset:9216
    v_mfma_f32_16x16x32_bf16 v[116:119], v[160:163], v[188:191], v[116:119]
    ds_read_b64_tr_b16 v[174:175], v236 offset:13824
    v_mfma_f32_16x16x32_bf16 v[120:123], v[160:163], v[192:195], v[120:123]
    ds_read_b64_tr_b16 v[176:177], v236 offset:9248
    v_mfma_f32_16x16x32_bf16 v[124:127], v[160:163], v[196:199], v[124:127]
    ds_read_b64_tr_b16 v[178:179], v236 offset:13856
    v_mfma_f32_16x16x32_bf16 v[128:131], v[164:167], v[184:187], v[128:131]
    ds_read_b64_tr_b16 v[180:181], v236 offset:9280
    v_mfma_f32_16x16x32_bf16 v[132:135], v[164:167], v[188:191], v[132:135]
    v_mfma_f32_16x16x32_bf16 v[136:139], v[164:167], v[192:195], v[136:139]
    ds_read_b64_tr_b16 v[182:183], v236 offset:13888
    v_mfma_f32_16x16x32_bf16 v[140:143], v[164:167], v[196:199], v[140:143]
    s_add_u32 s88, s86, 516096
    s_add_u32 m0, s84, 0
    s_nop 0
    buffer_load_dwordx4 v225, s[56:59], s88 offen offset:0 lds
    v_mfma_f32_16x16x32_bf16 v[144:147], v[168:171], v[184:187], v[144:147]
    buffer_load_dwordx4 v226, s[56:59], s88 offen offset:1024 lds
    v_mfma_f32_16x16x32_bf16 v[148:151], v[168:171], v[188:191], v[148:151]
    buffer_load_dwordx4 v227, s[56:59], s88 offen offset:2048 lds
    v_mfma_f32_16x16x32_bf16 v[152:155], v[168:171], v[192:195], v[152:155]
    buffer_load_dwordx4 v228, s[56:59], s88 offen offset:3072 lds
    v_mfma_f32_16x16x32_bf16 v[156:159], v[168:171], v[196:199], v[156:159]
    s_waitcnt lgkmcnt(0)
    v_mfma_f32_16x16x32_bf16 v[16:19], v[172:175], v[200:203], v[16:19]
    ds_read_b64_tr_b16 v[160:161], v236 offset:9312
    v_mfma_f32_16x16x32_bf16 v[20:23], v[172:175], v[204:207], v[20:23]
    ds_read_b64_tr_b16 v[162:163], v236 offset:13920
    v_mfma_f32_16x16x32_bf16 v[24:27], v[172:175], v[208:211], v[24:27]
    ds_read_b64_tr_b16 v[164:165], v236 offset:9344
    v_mfma_f32_16x16x32_bf16 v[28:31], v[172:175], v[212:215], v[28:31]
    ds_read_b64_tr_b16 v[166:167], v236 offset:13952
    v_mfma_f32_16x16x32_bf16 v[32:35], v[176:179], v[200:203], v[32:35]
    ds_read_b64_tr_b16 v[168:169], v236 offset:9376
    v_mfma_f32_16x16x32_bf16 v[36:39], v[176:179], v[204:207], v[36:39]
    ds_read_b64_tr_b16 v[170:171], v236 offset:13984
    v_mfma_f32_16x16x32_bf16 v[40:43], v[176:179], v[208:211], v[40:43]
    s_add_u32 m0, s84, 4096
    s_nop 0
    buffer_load_dwordx4 v229, s[56:59], s88 offen offset:0 lds
    v_mfma_f32_16x16x32_bf16 v[44:47], v[176:179], v[212:215], v[44:47]
    buffer_load_dwordx4 v230, s[56:59], s88 offen offset:1024 lds
    v_mfma_f32_16x16x32_bf16 v[48:51], v[180:183], v[200:203], v[48:51]
    buffer_load_dwordx4 v231, s[56:59], s88 offen offset:2048 lds
    v_mfma_f32_16x16x32_bf16 v[52:55], v[180:183], v[204:207], v[52:55]
    buffer_load_dwordx4 v232, s[56:59], s88 offen offset:3072 lds
    v_mfma_f32_16x16x32_bf16 v[56:59], v[180:183], v[208:211], v[56:59]
    s_add_u32 m0, s84, 8192
    s_nop 0
    buffer_load_dwordx4 v233, s[56:59], s88 offen offset:0 lds
    v_mfma_f32_16x16x32_bf16 v[60:63], v[180:183], v[212:215], v[60:63]
    s_waitcnt lgkmcnt(0)
    v_mfma_f32_16x16x32_bf16 v[64:67], v[160:163], v[200:203], v[64:67]
    ds_read_b64_tr_b16 v[172:173], v236 offset:9408
    v_mfma_f32_16x16x32_bf16 v[68:71], v[160:163], v[204:207], v[68:71]
    ds_read_b64_tr_b16 v[174:175], v236 offset:14016
    v_mfma_f32_16x16x32_bf16 v[72:75], v[160:163], v[208:211], v[72:75]
    ds_read_b64_tr_b16 v[176:177], v236 offset:9440
    v_mfma_f32_16x16x32_bf16 v[76:79], v[160:163], v[212:215], v[76:79]
    ds_read_b64_tr_b16 v[178:179], v236 offset:14048
    v_mfma_f32_16x16x32_bf16 v[80:83], v[164:167], v[200:203], v[80:83]
    ds_read_b64_tr_b16 v[180:181], v236 offset:9472
    v_mfma_f32_16x16x32_bf16 v[84:87], v[164:167], v[204:207], v[84:87]
    v_mfma_f32_16x16x32_bf16 v[88:91], v[164:167], v[208:211], v[88:91]
    ds_read_b64_tr_b16 v[182:183], v236 offset:14080
    v_mfma_f32_16x16x32_bf16 v[92:95], v[164:167], v[212:215], v[92:95]
    ds_read_b128 v[184:187], v234 offset:896
    v_mfma_f32_16x16x32_bf16 v[96:99], v[168:171], v[200:203], v[96:99]
    ds_read_b128 v[188:191], v234 offset:19328
    v_mfma_f32_16x16x32_bf16 v[100:103], v[168:171], v[204:207], v[100:103]
    ds_read_b128 v[192:195], v234 offset:37760
    v_mfma_f32_16x16x32_bf16 v[104:107], v[168:171], v[208:211], v[104:107]
    ds_read_b128 v[196:199], v234 offset:56192
    v_mfma_f32_16x16x32_bf16 v[108:111], v[168:171], v[212:215], v[108:111]
    s_waitcnt lgkmcnt(4)
    s_waitcnt vmcnt(0)
    v_mfma_f32_16x16x32_bf16 v[112:115], v[172:175], v[200:203], v[112:115]
    ds_read_b64_tr_b16 v[160:161], v236 offset:0
    v_mfma_f32_16x16x32_bf16 v[116:119], v[172:175], v[204:207], v[116:119]
    ds_read_b64_tr_b16 v[162:163], v236 offset:4608
    v_mfma_f32_16x16x32_bf16 v[120:123], v[172:175], v[208:211], v[120:123]
    ds_read_b64_tr_b16 v[164:165], v236 offset:32
    v_mfma_f32_16x16x32_bf16 v[124:127], v[172:175], v[212:215], v[124:127]
    ds_read_b64_tr_b16 v[166:167], v236 offset:4640
    v_mfma_f32_16x16x32_bf16 v[128:131], v[176:179], v[200:203], v[128:131]
    ds_read_b64_tr_b16 v[168:169], v236 offset:64
    v_mfma_f32_16x16x32_bf16 v[132:135], v[176:179], v[204:207], v[132:135]
    v_mfma_f32_16x16x32_bf16 v[136:139], v[176:179], v[208:211], v[136:139]
    ds_read_b64_tr_b16 v[170:171], v236 offset:4672
    v_mfma_f32_16x16x32_bf16 v[140:143], v[176:179], v[212:215], v[140:143]
    s_add_u32 s88, s86, 552960
    s_add_u32 m0, s84, 9216
    s_nop 0
    buffer_load_dwordx4 v225, s[56:59], s88 offen offset:0 lds
    v_mfma_f32_16x16x32_bf16 v[144:147], v[180:183], v[200:203], v[144:147]
    buffer_load_dwordx4 v226, s[56:59], s88 offen offset:1024 lds
    v_mfma_f32_16x16x32_bf16 v[148:151], v[180:183], v[204:207], v[148:151]
    buffer_load_dwordx4 v227, s[56:59], s88 offen offset:2048 lds
    v_mfma_f32_16x16x32_bf16 v[152:155], v[180:183], v[208:211], v[152:155]
    buffer_load_dwordx4 v228, s[56:59], s88 offen offset:3072 lds
    v_mfma_f32_16x16x32_bf16 v[156:159], v[180:183], v[212:215], v[156:159]
    s_waitcnt lgkmcnt(0)
    v_mfma_f32_16x16x32_bf16 v[16:19], v[160:163], v[184:187], v[16:19]
    ds_read_b64_tr_b16 v[172:173], v236 offset:96
    v_mfma_f32_16x16x32_bf16 v[20:23], v[160:163], v[188:191], v[20:23]
    ds_read_b64_tr_b16 v[174:175], v236 offset:4704
    v_mfma_f32_16x16x32_bf16 v[24:27], v[160:163], v[192:195], v[24:27]
    ds_read_b64_tr_b16 v[176:177], v236 offset:128
    v_mfma_f32_16x16x32_bf16 v[28:31], v[160:163], v[196:199], v[28:31]
    ds_read_b64_tr_b16 v[178:179], v236 offset:4736
    v_mfma_f32_16x16x32_bf16 v[32:35], v[164:167], v[184:187], v[32:35]
    ds_read_b64_tr_b16 v[180:181], v236 offset:160
    v_mfma_f32_16x16x32_bf16 v[36:39], v[164:167], v[188:191], v[36:39]
    ds_read_b64_tr_b16 v[182:183], v236 offset:4768
    v_mfma_f32_16x16x32_bf16 v[40:43], v[164:167], v[192:195], v[40:43]
    s_add_u32 m0, s84, 13312
    s_nop 0
    buffer_load_dwordx4 v229, s[56:59], s88 offen offset:0 lds
    v_mfma_f32_16x16x32_bf16 v[44:47], v[164:167], v[196:199], v[44:47]
    buffer_load_dwordx4 v230, s[56:59], s88 offen offset:1024 lds
    v_mfma_f32_16x16x32_bf16 v[48:51], v[168:171], v[184:187], v[48:51]
    buffer_load_dwordx4 v231, s[56:59], s88 offen offset:2048 lds
    v_mfma_f32_16x16x32_bf16 v[52:55], v[168:171], v[188:191], v[52:55]
    buffer_load_dwordx4 v232, s[56:59], s88 offen offset:3072 lds
    v_mfma_f32_16x16x32_bf16 v[56:59], v[168:171], v[192:195], v[56:59]
    s_add_u32 m0, s84, 17408
    s_nop 0
    buffer_load_dwordx4 v233, s[56:59], s88 offen offset:0 lds
    v_mfma_f32_16x16x32_bf16 v[60:63], v[168:171], v[196:199], v[60:63]
    s_waitcnt lgkmcnt(0)
    v_mfma_f32_16x16x32_bf16 v[64:67], v[172:175], v[184:187], v[64:67]
    ds_read_b64_tr_b16 v[160:161], v236 offset:192
    v_mfma_f32_16x16x32_bf16 v[68:71], v[172:175], v[188:191], v[68:71]
    ds_read_b64_tr_b16 v[162:163], v236 offset:4800
    v_mfma_f32_16x16x32_bf16 v[72:75], v[172:175], v[192:195], v[72:75]
    ds_read_b64_tr_b16 v[164:165], v236 offset:224
    v_mfma_f32_16x16x32_bf16 v[76:79], v[172:175], v[196:199], v[76:79]
    ds_read_b64_tr_b16 v[166:167], v236 offset:4832
    v_mfma_f32_16x16x32_bf16 v[80:83], v[176:179], v[184:187], v[80:83]
    ds_read_b64_tr_b16 v[168:169], v236 offset:256
    v_mfma_f32_16x16x32_bf16 v[84:87], v[176:179], v[188:191], v[84:87]
    v_mfma_f32_16x16x32_bf16 v[88:91], v[176:179], v[192:195], v[88:91]
    ds_read_b64_tr_b16 v[170:171], v236 offset:4864
    v_mfma_f32_16x16x32_bf16 v[92:95], v[176:179], v[196:199], v[92:95]
    ds_read_b128 v[200:203], v235 offset:896
    v_mfma_f32_16x16x32_bf16 v[96:99], v[180:183], v[184:187], v[96:99]
    ds_read_b128 v[204:207], v235 offset:19328
    v_mfma_f32_16x16x32_bf16 v[100:103], v[180:183], v[188:191], v[100:103]
    ds_read_b128 v[208:211], v235 offset:37760
    v_mfma_f32_16x16x32_bf16 v[104:107], v[180:183], v[192:195], v[104:107]
    ds_read_b128 v[212:215], v235 offset:56192
    v_mfma_f32_16x16x32_bf16 v[108:111], v[180:183], v[196:199], v[108:111]
    s_waitcnt lgkmcnt(4)
    s_waitcnt vmcnt(0)
    v_mfma_f32_16x16x32_bf16 v[112:115], v[160:163], v[184:187], v[112:115]
    ds_read_b64_tr_b16 v[172:173], v236 offset:9216
    v_mfma_f32_16x16x32_bf16 v[116:119], v[160:163], v[188:191], v[116:119]
    ds_read_b64_tr_b16 v[174:175], v236 offset:13824
    v_mfma_f32_16x16x32_bf16 v[120:123], v[160:163], v[192:195], v[120:123]
    ds_read_b64_tr_b16 v[176:177], v236 offset:9248
    v_mfma_f32_16x16x32_bf16 v[124:127], v[160:163], v[196:199], v[124:127]
    ds_read_b64_tr_b16 v[178:179], v236 offset:13856
    v_mfma_f32_16x16x32_bf16 v[128:131], v[164:167], v[184:187], v[128:131]
    ds_read_b64_tr_b16 v[180:181], v236 offset:9280
    v_mfma_f32_16x16x32_bf16 v[132:135], v[164:167], v[188:191], v[132:135]
    v_mfma_f32_16x16x32_bf16 v[136:139], v[164:167], v[192:195], v[136:139]
    ds_read_b64_tr_b16 v[182:183], v236 offset:13888
    v_mfma_f32_16x16x32_bf16 v[140:143], v[164:167], v[196:199], v[140:143]
    s_add_u32 s88, s86, 589824
    s_add_u32 m0, s84, 0
    s_nop 0
    buffer_load_dwordx4 v225, s[56:59], s88 offen offset:0 lds
    v_mfma_f32_16x16x32_bf16 v[144:147], v[168:171], v[184:187], v[144:147]
    buffer_load_dwordx4 v226, s[56:59], s88 offen offset:1024 lds
    v_mfma_f32_16x16x32_bf16 v[148:151], v[168:171], v[188:191], v[148:151]
    buffer_load_dwordx4 v227, s[56:59], s88 offen offset:2048 lds
    v_mfma_f32_16x16x32_bf16 v[152:155], v[168:171], v[192:195], v[152:155]
    buffer_load_dwordx4 v228, s[56:59], s88 offen offset:3072 lds
    v_mfma_f32_16x16x32_bf16 v[156:159], v[168:171], v[196:199], v[156:159]
    s_waitcnt lgkmcnt(0)
    v_mfma_f32_16x16x32_bf16 v[16:19], v[172:175], v[200:203], v[16:19]
    ds_read_b64_tr_b16 v[160:161], v236 offset:9312
    v_mfma_f32_16x16x32_bf16 v[20:23], v[172:175], v[204:207], v[20:23]
    ds_read_b64_tr_b16 v[162:163], v236 offset:13920
    v_mfma_f32_16x16x32_bf16 v[24:27], v[172:175], v[208:211], v[24:27]
    ds_read_b64_tr_b16 v[164:165], v236 offset:9344
    v_mfma_f32_16x16x32_bf16 v[28:31], v[172:175], v[212:215], v[28:31]
    ds_read_b64_tr_b16 v[166:167], v236 offset:13952
    v_mfma_f32_16x16x32_bf16 v[32:35], v[176:179], v[200:203], v[32:35]
    ds_read_b64_tr_b16 v[168:169], v236 offset:9376
    v_mfma_f32_16x16x32_bf16 v[36:39], v[176:179], v[204:207], v[36:39]
    ds_read_b64_tr_b16 v[170:171], v236 offset:13984
    v_mfma_f32_16x16x32_bf16 v[40:43], v[176:179], v[208:211], v[40:43]
    s_add_u32 m0, s84, 4096
    s_nop 0
    buffer_load_dwordx4 v229, s[56:59], s88 offen offset:0 lds
    v_mfma_f32_16x16x32_bf16 v[44:47], v[176:179], v[212:215], v[44:47]
    buffer_load_dwordx4 v230, s[56:59], s88 offen offset:1024 lds
    v_mfma_f32_16x16x32_bf16 v[48:51], v[180:183], v[200:203], v[48:51]
    buffer_load_dwordx4 v231, s[56:59], s88 offen offset:2048 lds
    v_mfma_f32_16x16x32_bf16 v[52:55], v[180:183], v[204:207], v[52:55]
    buffer_load_dwordx4 v232, s[56:59], s88 offen offset:3072 lds
    v_mfma_f32_16x16x32_bf16 v[56:59], v[180:183], v[208:211], v[56:59]
    s_add_u32 m0, s84, 8192
    s_nop 0
    buffer_load_dwordx4 v233, s[56:59], s88 offen offset:0 lds
    v_mfma_f32_16x16x32_bf16 v[60:63], v[180:183], v[212:215], v[60:63]
    s_waitcnt lgkmcnt(0)
    v_mfma_f32_16x16x32_bf16 v[64:67], v[160:163], v[200:203], v[64:67]
    ds_read_b64_tr_b16 v[172:173], v236 offset:9408
    v_mfma_f32_16x16x32_bf16 v[68:71], v[160:163], v[204:207], v[68:71]
    ds_read_b64_tr_b16 v[174:175], v236 offset:14016
    v_mfma_f32_16x16x32_bf16 v[72:75], v[160:163], v[208:211], v[72:75]
    ds_read_b64_tr_b16 v[176:177], v236 offset:9440
    v_mfma_f32_16x16x32_bf16 v[76:79], v[160:163], v[212:215], v[76:79]
    ds_read_b64_tr_b16 v[178:179], v236 offset:14048
    v_mfma_f32_16x16x32_bf16 v[80:83], v[164:167], v[200:203], v[80:83]
    ds_read_b64_tr_b16 v[180:181], v236 offset:9472
    v_mfma_f32_16x16x32_bf16 v[84:87], v[164:167], v[204:207], v[84:87]
    v_mfma_f32_16x16x32_bf16 v[88:91], v[164:167], v[208:211], v[88:91]
    ds_read_b64_tr_b16 v[182:183], v236 offset:14080
    v_mfma_f32_16x16x32_bf16 v[92:95], v[164:167], v[212:215], v[92:95]
    ds_read_b128 v[184:187], v234 offset:1024
    v_mfma_f32_16x16x32_bf16 v[96:99], v[168:171], v[200:203], v[96:99]
    ds_read_b128 v[188:191], v234 offset:19456
    v_mfma_f32_16x16x32_bf16 v[100:103], v[168:171], v[204:207], v[100:103]
    ds_read_b128 v[192:195], v234 offset:37888
    v_mfma_f32_16x16x32_bf16 v[104:107], v[168:171], v[208:211], v[104:107]
    ds_read_b128 v[196:199], v234 offset:56320
    v_mfma_f32_16x16x32_bf16 v[108:111], v[168:171], v[212:215], v[108:111]
    s_waitcnt lgkmcnt(4)
    s_waitcnt vmcnt(0)
    v_mfma_f32_16x16x32_bf16 v[112:115], v[172:175], v[200:203], v[112:115]
    ds_read_b64_tr_b16 v[160:161], v236 offset:0
    v_mfma_f32_16x16x32_bf16 v[116:119], v[172:175], v[204:207], v[116:119]
    ds_read_b64_tr_b16 v[162:163], v236 offset:4608
    v_mfma_f32_16x16x32_bf16 v[120:123], v[172:175], v[208:211], v[120:123]
    ds_read_b64_tr_b16 v[164:165], v236 offset:32
    v_mfma_f32_16x16x32_bf16 v[124:127], v[172:175], v[212:215], v[124:127]
    ds_read_b64_tr_b16 v[166:167], v236 offset:4640
    v_mfma_f32_16x16x32_bf16 v[128:131], v[176:179], v[200:203], v[128:131]
    ds_read_b64_tr_b16 v[168:169], v236 offset:64
    v_mfma_f32_16x16x32_bf16 v[132:135], v[176:179], v[204:207], v[132:135]
    v_mfma_f32_16x16x32_bf16 v[136:139], v[176:179], v[208:211], v[136:139]
    ds_read_b64_tr_b16 v[170:171], v236 offset:4672
    v_mfma_f32_16x16x32_bf16 v[140:143], v[176:179], v[212:215], v[140:143]
    s_add_u32 s88, s86, 626688
    s_add_u32 m0, s84, 9216
    s_nop 0
    buffer_load_dwordx4 v225, s[56:59], s88 offen offset:0 lds
    v_mfma_f32_16x16x32_bf16 v[144:147], v[180:183], v[200:203], v[144:147]
    buffer_load_dwordx4 v226, s[56:59], s88 offen offset:1024 lds
    v_mfma_f32_16x16x32_bf16 v[148:151], v[180:183], v[204:207], v[148:151]
    buffer_load_dwordx4 v227, s[56:59], s88 offen offset:2048 lds
    v_mfma_f32_16x16x32_bf16 v[152:155], v[180:183], v[208:211], v[152:155]
    buffer_load_dwordx4 v228, s[56:59], s88 offen offset:3072 lds
    v_mfma_f32_16x16x32_bf16 v[156:159], v[180:183], v[212:215], v[156:159]
    s_waitcnt lgkmcnt(0)
    v_mfma_f32_16x16x32_bf16 v[16:19], v[160:163], v[184:187], v[16:19]
    ds_read_b64_tr_b16 v[172:173], v236 offset:96
    v_mfma_f32_16x16x32_bf16 v[20:23], v[160:163], v[188:191], v[20:23]
    ds_read_b64_tr_b16 v[174:175], v236 offset:4704
    v_mfma_f32_16x16x32_bf16 v[24:27], v[160:163], v[192:195], v[24:27]
    ds_read_b64_tr_b16 v[176:177], v236 offset:128
    v_mfma_f32_16x16x32_bf16 v[28:31], v[160:163], v[196:199], v[28:31]
    ds_read_b64_tr_b16 v[178:179], v236 offset:4736
    v_mfma_f32_16x16x32_bf16 v[32:35], v[164:167], v[184:187], v[32:35]
    ds_read_b64_tr_b16 v[180:181], v236 offset:160
    v_mfma_f32_16x16x32_bf16 v[36:39], v[164:167], v[188:191], v[36:39]
    ds_read_b64_tr_b16 v[182:183], v236 offset:4768
    v_mfma_f32_16x16x32_bf16 v[40:43], v[164:167], v[192:195], v[40:43]
    s_add_u32 m0, s84, 13312
    s_nop 0
    buffer_load_dwordx4 v229, s[56:59], s88 offen offset:0 lds
    v_mfma_f32_16x16x32_bf16 v[44:47], v[164:167], v[196:199], v[44:47]
    buffer_load_dwordx4 v230, s[56:59], s88 offen offset:1024 lds
    v_mfma_f32_16x16x32_bf16 v[48:51], v[168:171], v[184:187], v[48:51]
    buffer_load_dwordx4 v231, s[56:59], s88 offen offset:2048 lds
    v_mfma_f32_16x16x32_bf16 v[52:55], v[168:171], v[188:191], v[52:55]
    buffer_load_dwordx4 v232, s[56:59], s88 offen offset:3072 lds
    v_mfma_f32_16x16x32_bf16 v[56:59], v[168:171], v[192:195], v[56:59]
    s_add_u32 m0, s84, 17408
    s_nop 0
    buffer_load_dwordx4 v233, s[56:59], s88 offen offset:0 lds
    v_mfma_f32_16x16x32_bf16 v[60:63], v[168:171], v[196:199], v[60:63]
    s_waitcnt lgkmcnt(0)
    v_mfma_f32_16x16x32_bf16 v[64:67], v[172:175], v[184:187], v[64:67]
    ds_read_b64_tr_b16 v[160:161], v236 offset:192
    v_mfma_f32_16x16x32_bf16 v[68:71], v[172:175], v[188:191], v[68:71]
    ds_read_b64_tr_b16 v[162:163], v236 offset:4800
    v_mfma_f32_16x16x32_bf16 v[72:75], v[172:175], v[192:195], v[72:75]
    ds_read_b64_tr_b16 v[164:165], v236 offset:224
    v_mfma_f32_16x16x32_bf16 v[76:79], v[172:175], v[196:199], v[76:79]
    ds_read_b64_tr_b16 v[166:167], v236 offset:4832
    v_mfma_f32_16x16x32_bf16 v[80:83], v[176:179], v[184:187], v[80:83]
    ds_read_b64_tr_b16 v[168:169], v236 offset:256
    v_mfma_f32_16x16x32_bf16 v[84:87], v[176:179], v[188:191], v[84:87]
    v_mfma_f32_16x16x32_bf16 v[88:91], v[176:179], v[192:195], v[88:91]
    ds_read_b64_tr_b16 v[170:171], v236 offset:4864
    v_mfma_f32_16x16x32_bf16 v[92:95], v[176:179], v[196:199], v[92:95]
    ds_read_b128 v[200:203], v235 offset:1024
    v_mfma_f32_16x16x32_bf16 v[96:99], v[180:183], v[184:187], v[96:99]
    ds_read_b128 v[204:207], v235 offset:19456
    v_mfma_f32_16x16x32_bf16 v[100:103], v[180:183], v[188:191], v[100:103]
    ds_read_b128 v[208:211], v235 offset:37888
    v_mfma_f32_16x16x32_bf16 v[104:107], v[180:183], v[192:195], v[104:107]
    ds_read_b128 v[212:215], v235 offset:56320
    v_mfma_f32_16x16x32_bf16 v[108:111], v[180:183], v[196:199], v[108:111]
    s_waitcnt lgkmcnt(4)
    s_waitcnt vmcnt(0)
    v_mfma_f32_16x16x32_bf16 v[112:115], v[160:163], v[184:187], v[112:115]
    ds_read_b64_tr_b16 v[172:173], v236 offset:9216
    v_mfma_f32_16x16x32_bf16 v[116:119], v[160:163], v[188:191], v[116:119]
    ds_read_b64_tr_b16 v[174:175], v236 offset:13824
    v_mfma_f32_16x16x32_bf16 v[120:123], v[160:163], v[192:195], v[120:123]
    ds_read_b64_tr_b16 v[176:177], v236 offset:9248
    v_mfma_f32_16x16x32_bf16 v[124:127], v[160:163], v[196:199], v[124:127]
    ds_read_b64_tr_b16 v[178:179], v236 offset:13856
    v_mfma_f32_16x16x32_bf16 v[128:131], v[164:167], v[184:187], v[128:131]
    ds_read_b64_tr_b16 v[180:181], v236 offset:9280
    v_mfma_f32_16x16x32_bf16 v[132:135], v[164:167], v[188:191], v[132:135]
    v_mfma_f32_16x16x32_bf16 v[136:139], v[164:167], v[192:195], v[136:139]
    ds_read_b64_tr_b16 v[182:183], v236 offset:13888
    v_mfma_f32_16x16x32_bf16 v[140:143], v[164:167], v[196:199], v[140:143]
    s_add_u32 s88, s87, 0
    s_add_u32 m0, s84, 0
    s_nop 0
    buffer_load_dwordx4 v225, s[60:63], s88 offen offset:0 lds
    v_mfma_f32_16x16x32_bf16 v[144:147], v[168:171], v[184:187], v[144:147]
    buffer_load_dwordx4 v226, s[60:63], s88 offen offset:1024 lds
    v_mfma_f32_16x16x32_bf16 v[148:151], v[168:171], v[188:191], v[148:151]
    buffer_load_dwordx4 v227, s[60:63], s88 offen offset:2048 lds
    v_mfma_f32_16x16x32_bf16 v[152:155], v[168:171], v[192:195], v[152:155]
    buffer_load_dwordx4 v228, s[60:63], s88 offen offset:3072 lds
    v_mfma_f32_16x16x32_bf16 v[156:159], v[168:171], v[196:199], v[156:159]
    s_waitcnt lgkmcnt(0)
    v_mfma_f32_16x16x32_bf16 v[16:19], v[172:175], v[200:203], v[16:19]
    ds_read_b64_tr_b16 v[160:161], v236 offset:9312
    v_mfma_f32_16x16x32_bf16 v[20:23], v[172:175], v[204:207], v[20:23]
    ds_read_b64_tr_b16 v[162:163], v236 offset:13920
    v_mfma_f32_16x16x32_bf16 v[24:27], v[172:175], v[208:211], v[24:27]
    ds_read_b64_tr_b16 v[164:165], v236 offset:9344
    v_mfma_f32_16x16x32_bf16 v[28:31], v[172:175], v[212:215], v[28:31]
    ds_read_b64_tr_b16 v[166:167], v236 offset:13952
    v_mfma_f32_16x16x32_bf16 v[32:35], v[176:179], v[200:203], v[32:35]
    ds_read_b64_tr_b16 v[168:169], v236 offset:9376
    v_mfma_f32_16x16x32_bf16 v[36:39], v[176:179], v[204:207], v[36:39]
    ds_read_b64_tr_b16 v[170:171], v236 offset:13984
    v_mfma_f32_16x16x32_bf16 v[40:43], v[176:179], v[208:211], v[40:43]
    s_add_u32 m0, s84, 4096
    s_nop 0
    buffer_load_dwordx4 v229, s[60:63], s88 offen offset:0 lds
    v_mfma_f32_16x16x32_bf16 v[44:47], v[176:179], v[212:215], v[44:47]
    buffer_load_dwordx4 v230, s[60:63], s88 offen offset:1024 lds
    v_mfma_f32_16x16x32_bf16 v[48:51], v[180:183], v[200:203], v[48:51]
    buffer_load_dwordx4 v231, s[60:63], s88 offen offset:2048 lds
    v_mfma_f32_16x16x32_bf16 v[52:55], v[180:183], v[204:207], v[52:55]
    buffer_load_dwordx4 v232, s[60:63], s88 offen offset:3072 lds
    v_mfma_f32_16x16x32_bf16 v[56:59], v[180:183], v[208:211], v[56:59]
    s_add_u32 m0, s84, 8192
    s_nop 0
    buffer_load_dwordx4 v233, s[60:63], s88 offen offset:0 lds
    v_mfma_f32_16x16x32_bf16 v[60:63], v[180:183], v[212:215], v[60:63]
    s_waitcnt lgkmcnt(0)
    v_mfma_f32_16x16x32_bf16 v[64:67], v[160:163], v[200:203], v[64:67]
    ds_read_b64_tr_b16 v[172:173], v236 offset:9408
    v_mfma_f32_16x16x32_bf16 v[68:71], v[160:163], v[204:207], v[68:71]
    v_mfma_f32_16x16x32_bf16 v[72:75], v[160:163], v[208:211], v[72:75]
    ds_read_b64_tr_b16 v[174:175], v236 offset:14016
    v_mfma_f32_16x16x32_bf16 v[76:79], v[160:163], v[212:215], v[76:79]
    v_mfma_f32_16x16x32_bf16 v[80:83], v[164:167], v[200:203], v[80:83]
    ds_read_b64_tr_b16 v[176:177], v236 offset:9440
    v_mfma_f32_16x16x32_bf16 v[84:87], v[164:167], v[204:207], v[84:87]
    v_mfma_f32_16x16x32_bf16 v[88:91], v[164:167], v[208:211], v[88:91]
    ds_read_b64_tr_b16 v[178:179], v236 offset:14048
    v_mfma_f32_16x16x32_bf16 v[92:95], v[164:167], v[212:215], v[92:95]
    v_mfma_f32_16x16x32_bf16 v[96:99], v[168:171], v[200:203], v[96:99]
    ds_read_b64_tr_b16 v[180:181], v236 offset:9472
    v_mfma_f32_16x16x32_bf16 v[100:103], v[168:171], v[204:207], v[100:103]
    v_mfma_f32_16x16x32_bf16 v[104:107], v[168:171], v[208:211], v[104:107]
    ds_read_b64_tr_b16 v[182:183], v236 offset:14080
    v_mfma_f32_16x16x32_bf16 v[108:111], v[168:171], v[212:215], v[108:111]
    s_waitcnt lgkmcnt(0)
    s_waitcnt vmcnt(0)
    v_mfma_f32_16x16x32_bf16 v[112:115], v[172:175], v[200:203], v[112:115]
    ds_read_b64_tr_b16 v[160:161], v236 offset:0
    v_mfma_f32_16x16x32_bf16 v[116:119], v[172:175], v[204:207], v[116:119]
    ds_read_b64_tr_b16 v[162:163], v236 offset:4608
    v_mfma_f32_16x16x32_bf16 v[120:123], v[172:175], v[208:211], v[120:123]
    ds_read_b64_tr_b16 v[164:165], v236 offset:32
    v_mfma_f32_16x16x32_bf16 v[124:127], v[172:175], v[212:215], v[124:127]
    ds_read_b64_tr_b16 v[166:167], v236 offset:4640
    v_mfma_f32_16x16x32_bf16 v[128:131], v[176:179], v[200:203], v[128:131]
    ds_read_b64_tr_b16 v[168:169], v236 offset:64
    v_mfma_f32_16x16x32_bf16 v[132:135], v[176:179], v[204:207], v[132:135]
    v_mfma_f32_16x16x32_bf16 v[136:139], v[176:179], v[208:211], v[136:139]
    ds_read_b64_tr_b16 v[170:171], v236 offset:4672
    v_mfma_f32_16x16x32_bf16 v[140:143], v[176:179], v[212:215], v[140:143]
    s_add_u32 s88, s87, 36864
    s_add_u32 m0, s84, 9216
    s_nop 0
    buffer_load_dwordx4 v225, s[60:63], s88 offen offset:0 lds
    v_mfma_f32_16x16x32_bf16 v[144:147], v[180:183], v[200:203], v[144:147]
    buffer_load_dwordx4 v226, s[60:63], s88 offen offset:1024 lds
    v_mfma_f32_16x16x32_bf16 v[148:151], v[180:183], v[204:207], v[148:151]
    buffer_load_dwordx4 v227, s[60:63], s88 offen offset:2048 lds
    v_mfma_f32_16x16x32_bf16 v[152:155], v[180:183], v[208:211], v[152:155]
    buffer_load_dwordx4 v228, s[60:63], s88 offen offset:3072 lds
    v_mfma_f32_16x16x32_bf16 v[156:159], v[180:183], v[212:215], v[156:159]
    v_add_u32 v238, 16, v238
LM_fo_115:
    ds_read_b32 v244, v238
    s_waitcnt lgkmcnt(0)
    v_cmp_gt_u32 vcc, 1, v244
    s_nop 4
    s_cbranch_vccz LM_fod_116
    s_sleep 1
    s_branch LM_fo_115
LM_fod_116:
    ds_read_b128 v[184:187], v237 offset:0
    ds_read_b128 v[188:191], v237 offset:3584
    ds_read_b128 v[192:195], v237 offset:7168
    ds_read_b128 v[196:199], v237 offset:10752
    s_waitcnt lgkmcnt(0)
    v_mfma_f32_16x16x32_bf16 v[16:19], v[160:163], v[184:187], v[16:19]
    ds_read_b64_tr_b16 v[172:173], v236 offset:96
    v_mfma_f32_16x16x32_bf16 v[20:23], v[160:163], v[188:191], v[20:23]
    ds_read_b64_tr_b16 v[174:175], v236 offset:4704
    v_mfma_f32_16x16x32_bf16 v[24:27], v[160:163], v[192:195], v[24:27]
    ds_read_b64_tr_b16 v[176:177], v236 offset:128
    v_mfma_f32_16x16x32_bf16 v[28:31], v[160:163], v[196:199], v[28:31]
    ds_read_b64_tr_b16 v[178:179], v236 offset:4736
    v_mfma_f32_16x16x32_bf16 v[32:35], v[164:167], v[184:187], v[32:35]
    ds_read_b64_tr_b16 v[180:181], v236 offset:160
    v_mfma_f32_16x16x32_bf16 v[36:39], v[164:167], v[188:191], v[36:39]
    ds_read_b64_tr_b16 v[182:183], v236 offset:4768
    v_mfma_f32_16x16x32_bf16 v[40:43], v[164:167], v[192:195], v[40:43]
    s_add_u32 m0, s84, 13312
    s_nop 0
    buffer_load_dwordx4 v229, s[60:63], s88 offen offset:0 lds
    v_mfma_f32_16x16x32_bf16 v[44:47], v[164:167], v[196:199], v[44:47]
    buffer_load_dwordx4 v230, s[60:63], s88 offen offset:1024 lds
    v_mfma_f32_16x16x32_bf16 v[48:51], v[168:171], v[184:187], v[48:51]
    buffer_load_dwordx4 v231, s[60:63], s88 offen offset:2048 lds
    v_mfma_f32_16x16x32_bf16 v[52:55], v[168:171], v[188:191], v[52:55]
    buffer_load_dwordx4 v232, s[60:63], s88 offen offset:3072 lds
    v_mfma_f32_16x16x32_bf16 v[56:59], v[168:171], v[192:195], v[56:59]
    s_add_u32 m0, s84, 17408
    s_nop 0
    buffer_load_dwordx4 v233, s[60:63], s88 offen offset:0 lds
    v_mfma_f32_16x16x32_bf16 v[60:63], v[168:171], v[196:199], v[60:63]
    s_waitcnt lgkmcnt(0)
    v_mfma_f32_16x16x32_bf16 v[64:67], v[172:175], v[184:187], v[64:67]
    ds_read_b64_tr_b16 v[160:161], v236 offset:192
    v_mfma_f32_16x16x32_bf16 v[68:71], v[172:175], v[188:191], v[68:71]
    ds_read_b64_tr_b16 v[162:163], v236 offset:4800
    v_mfma_f32_16x16x32_bf16 v[72:75], v[172:175], v[192:195], v[72:75]
    ds_read_b64_tr_b16 v[164:165], v236 offset:224
    v_mfma_f32_16x16x32_bf16 v[76:79], v[172:175], v[196:199], v[76:79]
    ds_read_b64_tr_b16 v[166:167], v236 offset:4832
    v_mfma_f32_16x16x32_bf16 v[80:83], v[176:179], v[184:187], v[80:83]
    ds_read_b64_tr_b16 v[168:169], v236 offset:256
    v_mfma_f32_16x16x32_bf16 v[84:87], v[176:179], v[188:191], v[84:87]
    v_mfma_f32_16x16x32_bf16 v[88:91], v[176:179], v[192:195], v[88:91]
    ds_read_b64_tr_b16 v[170:171], v236 offset:4864
    v_mfma_f32_16x16x32_bf16 v[92:95], v[176:179], v[196:199], v[92:95]
    ds_read_b128 v[200:203], v237 offset:64
    v_mfma_f32_16x16x32_bf16 v[96:99], v[180:183], v[184:187], v[96:99]
    ds_read_b128 v[204:207], v237 offset:3648
    v_mfma_f32_16x16x32_bf16 v[100:103], v[180:183], v[188:191], v[100:103]
    ds_read_b128 v[208:211], v237 offset:7232
    v_mfma_f32_16x16x32_bf16 v[104:107], v[180:183], v[192:195], v[104:107]
    ds_read_b128 v[212:215], v237 offset:10816
    v_mfma_f32_16x16x32_bf16 v[108:111], v[180:183], v[196:199], v[108:111]
    s_waitcnt lgkmcnt(4)
    s_waitcnt vmcnt(0)
    v_mfma_f32_16x16x32_bf16 v[112:115], v[160:163], v[184:187], v[112:115]
    ds_read_b64_tr_b16 v[172:173], v236 offset:9216
    v_mfma_f32_16x16x32_bf16 v[116:119], v[160:163], v[188:191], v[116:119]
    ds_read_b64_tr_b16 v[174:175], v236 offset:13824
    v_mfma_f32_16x16x32_bf16 v[120:123], v[160:163], v[192:195], v[120:123]
    ds_read_b64_tr_b16 v[176:177], v236 offset:9248
    v_mfma_f32_16x16x32_bf16 v[124:127], v[160:163], v[196:199], v[124:127]
    ds_read_b64_tr_b16 v[178:179], v236 offset:13856
    v_mfma_f32_16x16x32_bf16 v[128:131], v[164:167], v[184:187], v[128:131]
    ds_read_b64_tr_b16 v[180:181], v236 offset:9280
    v_mfma_f32_16x16x32_bf16 v[132:135], v[164:167], v[188:191], v[132:135]
    v_mfma_f32_16x16x32_bf16 v[136:139], v[164:167], v[192:195], v[136:139]
    ds_read_b64_tr_b16 v[182:183], v236 offset:13888
    v_mfma_f32_16x16x32_bf16 v[140:143], v[164:167], v[196:199], v[140:143]
    s_add_u32 s88, s87, 73728
    s_add_u32 m0, s84, 0
    s_nop 0
    buffer_load_dwordx4 v225, s[60:63], s88 offen offset:0 lds
    v_mfma_f32_16x16x32_bf16 v[144:147], v[168:171], v[184:187], v[144:147]
    buffer_load_dwordx4 v226, s[60:63], s88 offen offset:1024 lds
    v_mfma_f32_16x16x32_bf16 v[148:151], v[168:171], v[188:191], v[148:151]
    buffer_load_dwordx4 v227, s[60:63], s88 offen offset:2048 lds
    v_mfma_f32_16x16x32_bf16 v[152:155], v[168:171], v[192:195], v[152:155]
    buffer_load_dwordx4 v228, s[60:63], s88 offen offset:3072 lds
    v_mfma_f32_16x16x32_bf16 v[156:159], v[168:171], v[196:199], v[156:159]
    s_waitcnt lgkmcnt(0)
    v_mfma_f32_16x16x32_bf16 v[16:19], v[172:175], v[200:203], v[16:19]
    ds_read_b64_tr_b16 v[160:161], v236 offset:9312
    v_mfma_f32_16x16x32_bf16 v[20:23], v[172:175], v[204:207], v[20:23]
    ds_read_b64_tr_b16 v[162:163], v236 offset:13920
    v_mfma_f32_16x16x32_bf16 v[24:27], v[172:175], v[208:211], v[24:27]
    ds_read_b64_tr_b16 v[164:165], v236 offset:9344
    v_mfma_f32_16x16x32_bf16 v[28:31], v[172:175], v[212:215], v[28:31]
    ds_read_b64_tr_b16 v[166:167], v236 offset:13952
    v_mfma_f32_16x16x32_bf16 v[32:35], v[176:179], v[200:203], v[32:35]
    ds_read_b64_tr_b16 v[168:169], v236 offset:9376
    v_mfma_f32_16x16x32_bf16 v[36:39], v[176:179], v[204:207], v[36:39]
    ds_read_b64_tr_b16 v[170:171], v236 offset:13984
    v_mfma_f32_16x16x32_bf16 v[40:43], v[176:179], v[208:211], v[40:43]
    s_add_u32 m0, s84, 4096
    s_nop 0
    buffer_load_dwordx4 v229, s[60:63], s88 offen offset:0 lds
    v_mfma_f32_16x16x32_bf16 v[44:47], v[176:179], v[212:215], v[44:47]
    buffer_load_dwordx4 v230, s[60:63], s88 offen offset:1024 lds
    v_mfma_f32_16x16x32_bf16 v[48:51], v[180:183], v[200:203], v[48:51]
    buffer_load_dwordx4 v231, s[60:63], s88 offen offset:2048 lds
    v_mfma_f32_16x16x32_bf16 v[52:55], v[180:183], v[204:207], v[52:55]
    buffer_load_dwordx4 v232, s[60:63], s88 offen offset:3072 lds
    v_mfma_f32_16x16x32_bf16 v[56:59], v[180:183], v[208:211], v[56:59]
    s_add_u32 m0, s84, 8192
    s_nop 0
    buffer_load_dwordx4 v233, s[60:63], s88 offen offset:0 lds
    v_mfma_f32_16x16x32_bf16 v[60:63], v[180:183], v[212:215], v[60:63]
    s_waitcnt lgkmcnt(0)
    v_mfma_f32_16x16x32_bf16 v[64:67], v[160:163], v[200:203], v[64:67]
    ds_read_b64_tr_b16 v[172:173], v236 offset:9408
    v_mfma_f32_16x16x32_bf16 v[68:71], v[160:163], v[204:207], v[68:71]
    ds_read_b64_tr_b16 v[174:175], v236 offset:14016
    v_mfma_f32_16x16x32_bf16 v[72:75], v[160:163], v[208:211], v[72:75]
    ds_read_b64_tr_b16 v[176:177], v236 offset:9440
    v_mfma_f32_16x16x32_bf16 v[76:79], v[160:163], v[212:215], v[76:79]
    ds_read_b64_tr_b16 v[178:179], v236 offset:14048
    v_mfma_f32_16x16x32_bf16 v[80:83], v[164:167], v[200:203], v[80:83]
    ds_read_b64_tr_b16 v[180:181], v236 offset:9472
    v_mfma_f32_16x16x32_bf16 v[84:87], v[164:167], v[204:207], v[84:87]
    v_mfma_f32_16x16x32_bf16 v[88:91], v[164:167], v[208:211], v[88:91]
    ds_read_b64_tr_b16 v[182:183], v236 offset:14080
    v_mfma_f32_16x16x32_bf16 v[92:95], v[164:167], v[212:215], v[92:95]
    ds_read_b128 v[184:187], v237 offset:128
    v_mfma_f32_16x16x32_bf16 v[96:99], v[168:171], v[200:203], v[96:99]
    ds_read_b128 v[188:191], v237 offset:3712
    v_mfma_f32_16x16x32_bf16 v[100:103], v[168:171], v[204:207], v[100:103]
    ds_read_b128 v[192:195], v237 offset:7296
    v_mfma_f32_16x16x32_bf16 v[104:107], v[168:171], v[208:211], v[104:107]
    ds_read_b128 v[196:199], v237 offset:10880
    v_mfma_f32_16x16x32_bf16 v[108:111], v[168:171], v[212:215], v[108:111]
    s_waitcnt lgkmcnt(4)
    s_waitcnt vmcnt(0)
    v_mfma_f32_16x16x32_bf16 v[112:115], v[172:175], v[200:203], v[112:115]
    ds_read_b64_tr_b16 v[160:161], v236 offset:0
    v_mfma_f32_16x16x32_bf16 v[116:119], v[172:175], v[204:207], v[116:119]
    v_mfma_f32_16x16x32_bf16 v[120:123], v[172:175], v[208:211], v[120:123]
    ds_read_b64_tr_b16 v[162:163], v236 offset:4608
    v_mfma_f32_16x16x32_bf16 v[124:127], v[172:175], v[212:215], v[124:127]
    v_mfma_f32_16x16x32_bf16 v[128:131], v[176:179], v[200:203], v[128:131]
    ds_read_b64_tr_b16 v[164:165], v236 offset:32
    v_mfma_f32_16x16x32_bf16 v[132:135], v[176:179], v[204:207], v[132:135]
    v_mfma_f32_16x16x32_bf16 v[136:139], v[176:179], v[208:211], v[136:139]
    ds_read_b64_tr_b16 v[166:167], v236 offset:4640
    v_mfma_f32_16x16x32_bf16 v[140:143], v[176:179], v[212:215], v[140:143]
    v_mfma_f32_16x16x32_bf16 v[144:147], v[180:183], v[200:203], v[144:147]
    ds_read_b64_tr_b16 v[168:169], v236 offset:64
    v_mfma_f32_16x16x32_bf16 v[148:151], v[180:183], v[204:207], v[148:151]
    v_mfma_f32_16x16x32_bf16 v[152:155], v[180:183], v[208:211], v[152:155]
    ds_read_b64_tr_b16 v[170:171], v236 offset:4672
    v_mfma_f32_16x16x32_bf16 v[156:159], v[180:183], v[212:215], v[156:159]
    s_waitcnt lgkmcnt(0)
    v_mfma_f32_16x16x32_bf16 v[16:19], v[160:163], v[184:187], v[16:19]
    ds_read_b64_tr_b16 v[172:173], v236 offset:96
    v_mfma_f32_16x16x32_bf16 v[20:23], v[160:163], v[188:191], v[20:23]
    ds_read_b64_tr_b16 v[174:175], v236 offset:4704
    v_mfma_f32_16x16x32_bf16 v[24:27], v[160:163], v[192:195], v[24:27]
    ds_read_b64_tr_b16 v[176:177], v236 offset:128
    v_mfma_f32_16x16x32_bf16 v[28:31], v[160:163], v[196:199], v[28:31]
    ds_read_b64_tr_b16 v[178:179], v236 offset:4736
    v_mfma_f32_16x16x32_bf16 v[32:35], v[164:167], v[184:187], v[32:35]
    ds_read_b64_tr_b16 v[180:181], v236 offset:160
    v_mfma_f32_16x16x32_bf16 v[36:39], v[164:167], v[188:191], v[36:39]
    v_mfma_f32_16x16x32_bf16 v[40:43], v[164:167], v[192:195], v[40:43]
    ds_read_b64_tr_b16 v[182:183], v236 offset:4768
    v_mfma_f32_16x16x32_bf16 v[44:47], v[164:167], v[196:199], v[44:47]
    s_lshl_b32 s9, s4, 3
    s_add_u32 s9, s9, s5
    s_mul_i32 s9, s9, 73728
    v_mfma_f32_16x16x32_bf16 v[48:51], v[168:171], v[184:187], v[48:51]
    s_mul_i32 s10, s7, 18432
    s_add_u32 s9, s9, s10
    s_add_u32 s9, s9, 1048576
    v_mfma_f32_16x16x32_bf16 v[52:55], v[168:171], v[188:191], v[52:55]
    v_lshlrev_b32 v2, 4, v1
    v_add_u32 v3, s84, v2
    v_mfma_f32_16x16x32_bf16 v[56:59], v[168:171], v[192:195], v[56:59]
    s_lshr_b32 s10, s5, 1
    s_and_b32 s89, s5, 1
    s_cmp_eq_u32 s10, s7
    s_cselect_b32 s89, s89, 7
    v_mfma_f32_16x16x32_bf16 v[60:63], v[168:171], v[196:199], v[60:63]
    s_waitcnt lgkmcnt(0)
    v_mfma_f32_16x16x32_bf16 v[64:67], v[172:175], v[184:187], v[64:67]
    s_nop 1
    s_nop 1
    v_mfma_f32_16x16x32_bf16 v[68:71], v[172:175], v[188:191], v[68:71]
    ds_read_b64_tr_b16 v[160:161], v236 offset:192
    v_mfma_f32_16x16x32_bf16 v[72:75], v[172:175], v[192:195], v[72:75]
    ds_read_b64_tr_b16 v[162:163], v236 offset:4800
    v_mfma_f32_16x16x32_bf16 v[76:79], v[172:175], v[196:199], v[76:79]
    ds_read_b64_tr_b16 v[164:165], v236 offset:224
    v_mfma_f32_16x16x32_bf16 v[80:83], v[176:179], v[184:187], v[80:83]
    ds_read_b64_tr_b16 v[166:167], v236 offset:4832
    v_mfma_f32_16x16x32_bf16 v[84:87], v[176:179], v[188:191], v[84:87]
    ds_read_b64_tr_b16 v[168:169], v236 offset:256
    v_mfma_f32_16x16x32_bf16 v[88:91], v[176:179], v[192:195], v[88:91]
    ds_read_b64_tr_b16 v[170:171], v236 offset:4864
    v_cvt_pk_bf16_f32 v16, v16, v17
    v_cvt_pk_bf16_f32 v17, v18, v19
    v_cvt_pk_bf16_f32 v18, v20, v21
    v_cvt_pk_bf16_f32 v19, v22, v23
    s_cmp_eq_u32 s89, 0
    s_cbranch_scc1 LM_ownl_117
    buffer_store_dwordx4 v[16:19], v2, s[68:71], s9 offen offset:0 sc1
    s_branch LM_ownn_118
    LM_ownl_117:
    ds_write_b128 v3, v[16:19] offset:9216
    LM_ownn_118:
    v_mfma_f32_16x16x32_bf16 v[92:95], v[176:179], v[196:199], v[92:95]
    v_cvt_pk_bf16_f32 v24, v24, v25
    v_cvt_pk_bf16_f32 v25, v26, v27
    v_cvt_pk_bf16_f32 v26, v28, v29
    v_cvt_pk_bf16_f32 v27, v30, v31
    s_cmp_eq_u32 s89, 1
    s_cbranch_scc1 LM_ownl_119
    buffer_store_dwordx4 v[24:27], v2, s[68:71], s9 offen offset:1024 sc1
    s_branch LM_ownn_120
    LM_ownl_119:
    ds_write_b128 v3, v[24:27] offset:9216
    LM_ownn_120:
    v_mfma_f32_16x16x32_bf16 v[96:99], v[180:183], v[184:187], v[96:99]
    v_cvt_pk_bf16_f32 v32, v32, v33
    v_cvt_pk_bf16_f32 v33, v34, v35
    v_cvt_pk_bf16_f32 v34, v36, v37
    v_cvt_pk_bf16_f32 v35, v38, v39
    s_cmp_eq_u32 s89, 0
    s_cbranch_scc1 LM_ownl_121
    buffer_store_dwordx4 v[32:35], v2, s[68:71], s9 offen offset:2048 sc1
    s_branch LM_ownn_122
    LM_ownl_121:
    ds_write_b128 v3, v[32:35] offset:10240
    LM_ownn_122:
    v_mfma_f32_16x16x32_bf16 v[100:103], v[180:183], v[188:191], v[100:103]
    v_cvt_pk_bf16_f32 v40, v40, v41
    v_cvt_pk_bf16_f32 v41, v42, v43
    v_cvt_pk_bf16_f32 v42, v44, v45
    v_cvt_pk_bf16_f32 v43, v46, v47
    s_cmp_eq_u32 s89, 1
    s_cbranch_scc1 LM_ownl_123
    buffer_store_dwordx4 v[40:43], v2, s[68:71], s9 offen offset:3072 sc1
    s_branch LM_ownn_124
    LM_ownl_123:
    ds_write_b128 v3, v[40:43] offset:10240
    LM_ownn_124:
    v_mfma_f32_16x16x32_bf16 v[104:107], v[180:183], v[192:195], v[104:107]
    v_cvt_pk_bf16_f32 v48, v48, v49
    v_cvt_pk_bf16_f32 v49, v50, v51
    v_cvt_pk_bf16_f32 v50, v52, v53
    v_cvt_pk_bf16_f32 v51, v54, v55
    s_add_u32 s9, s9, 4096
    s_cmp_eq_u32 s89, 0
    s_cbranch_scc1 LM_ownl_125
    buffer_store_dwordx4 v[48:51], v2, s[68:71], s9 offen offset:0 sc1
    s_branch LM_ownn_126
    LM_ownl_125:
    ds_write_b128 v3, v[48:51] offset:11264
    LM_ownn_126:
    v_mfma_f32_16x16x32_bf16 v[108:111], v[180:183], v[196:199], v[108:111]
    v_cvt_pk_bf16_f32 v56, v56, v57
    v_cvt_pk_bf16_f32 v57, v58, v59
    v_cvt_pk_bf16_f32 v58, v60, v61
    v_cvt_pk_bf16_f32 v59, v62, v63
    s_cmp_eq_u32 s89, 1
    s_cbranch_scc1 LM_ownl_127
    buffer_store_dwordx4 v[56:59], v2, s[68:71], s9 offen offset:1024 sc1
    s_branch LM_ownn_128
    LM_ownl_127:
    ds_write_b128 v3, v[56:59] offset:11264
    LM_ownn_128:
    s_waitcnt lgkmcnt(0)
    v_mfma_f32_16x16x32_bf16 v[112:115], v[160:163], v[184:187], v[112:115]
    s_nop 1
    v_mfma_f32_16x16x32_bf16 v[116:119], v[160:163], v[188:191], v[116:119]
    s_nop 1
    v_mfma_f32_16x16x32_bf16 v[120:123], v[160:163], v[192:195], v[120:123]
    v_mfma_f32_16x16x32_bf16 v[124:127], v[160:163], v[196:199], v[124:127]
    v_cvt_pk_bf16_f32 v64, v64, v65
    v_cvt_pk_bf16_f32 v65, v66, v67
    v_cvt_pk_bf16_f32 v66, v68, v69
    v_cvt_pk_bf16_f32 v67, v70, v71
    s_cmp_eq_u32 s89, 0
    s_cbranch_scc1 LM_ownl_129
    buffer_store_dwordx4 v[64:67], v2, s[68:71], s9 offen offset:2048 sc1
    s_branch LM_ownn_130
    LM_ownl_129:
    ds_write_b128 v3, v[64:67] offset:12288
    LM_ownn_130:
    v_mfma_f32_16x16x32_bf16 v[128:131], v[164:167], v[184:187], v[128:131]
    v_cvt_pk_bf16_f32 v72, v72, v73
    v_cvt_pk_bf16_f32 v73, v74, v75
    v_cvt_pk_bf16_f32 v74, v76, v77
    v_cvt_pk_bf16_f32 v75, v78, v79
    s_cmp_eq_u32 s89, 1
    s_cbranch_scc1 LM_ownl_131
    buffer_store_dwordx4 v[72:75], v2, s[68:71], s9 offen offset:3072 sc1
    s_branch LM_ownn_132
    LM_ownl_131:
    ds_write_b128 v3, v[72:75] offset:12288
    LM_ownn_132:
    v_mfma_f32_16x16x32_bf16 v[132:135], v[164:167], v[188:191], v[132:135]
    v_mfma_f32_16x16x32_bf16 v[136:139], v[164:167], v[192:195], v[136:139]
    v_cvt_pk_bf16_f32 v80, v80, v81
    v_cvt_pk_bf16_f32 v81, v82, v83
    v_cvt_pk_bf16_f32 v82, v84, v85
    v_cvt_pk_bf16_f32 v83, v86, v87
    s_add_u32 s9, s9, 4096
    s_cmp_eq_u32 s89, 0
    s_cbranch_scc1 LM_ownl_133
    buffer_store_dwordx4 v[80:83], v2, s[68:71], s9 offen offset:0 sc1
    s_branch LM_ownn_134
    LM_ownl_133:
    ds_write_b128 v3, v[80:83] offset:13312
    LM_ownn_134:
    v_mfma_f32_16x16x32_bf16 v[140:143], v[164:167], v[196:199], v[140:143]
    v_cvt_pk_bf16_f32 v88, v88, v89
    v_cvt_pk_bf16_f32 v89, v90, v91
    v_cvt_pk_bf16_f32 v90, v92, v93
    v_cvt_pk_bf16_f32 v91, v94, v95
    s_cmp_eq_u32 s89, 1
    s_cbranch_scc1 LM_ownl_135
    buffer_store_dwordx4 v[88:91], v2, s[68:71], s9 offen offset:1024 sc1
    s_branch LM_ownn_136
    LM_ownl_135:
    ds_write_b128 v3, v[88:91] offset:13312
    LM_ownn_136:
    v_mfma_f32_16x16x32_bf16 v[144:147], v[168:171], v[184:187], v[144:147]
    v_mfma_f32_16x16x32_bf16 v[148:151], v[168:171], v[188:191], v[148:151]
    v_cvt_pk_bf16_f32 v96, v96, v97
    v_cvt_pk_bf16_f32 v97, v98, v99
    v_cvt_pk_bf16_f32 v98, v100, v101
    v_cvt_pk_bf16_f32 v99, v102, v103
    s_cmp_eq_u32 s89, 0
    s_cbranch_scc1 LM_ownl_137
    buffer_store_dwordx4 v[96:99], v2, s[68:71], s9 offen offset:2048 sc1
    s_branch LM_ownn_138
    LM_ownl_137:
    ds_write_b128 v3, v[96:99] offset:14336
    LM_ownn_138:
    v_mfma_f32_16x16x32_bf16 v[152:155], v[168:171], v[192:195], v[152:155]
    v_cvt_pk_bf16_f32 v104, v104, v105
    v_cvt_pk_bf16_f32 v105, v106, v107
    v_cvt_pk_bf16_f32 v106, v108, v109
    v_cvt_pk_bf16_f32 v107, v110, v111
    s_cmp_eq_u32 s89, 1
    s_cbranch_scc1 LM_ownl_139
    buffer_store_dwordx4 v[104:107], v2, s[68:71], s9 offen offset:3072 sc1
    s_branch LM_ownn_140
    LM_ownl_139:
    ds_write_b128 v3, v[104:107] offset:14336
    LM_ownn_140:
    v_mfma_f32_16x16x32_bf16 v[156:159], v[168:171], v[196:199], v[156:159]
    s_nop 7
    v_cvt_pk_bf16_f32 v112, v112, v113
    v_cvt_pk_bf16_f32 v113, v114, v115
    v_cvt_pk_bf16_f32 v114, v116, v117
    v_cvt_pk_bf16_f32 v115, v118, v119
    s_add_u32 s9, s9, 4096
    s_cmp_eq_u32 s89, 0
    s_cbranch_scc1 LM_ownl_141
    buffer_store_dwordx4 v[112:115], v2, s[68:71], s9 offen offset:0 sc1
    s_branch LM_ownn_142
    LM_ownl_141:
    ds_write_b128 v3, v[112:115] offset:15360
    LM_ownn_142:
    v_cvt_pk_bf16_f32 v120, v120, v121
    v_cvt_pk_bf16_f32 v121, v122, v123
    v_cvt_pk_bf16_f32 v122, v124, v125
    v_cvt_pk_bf16_f32 v123, v126, v127
    s_cmp_eq_u32 s89, 1
    s_cbranch_scc1 LM_ownl_143
    buffer_store_dwordx4 v[120:123], v2, s[68:71], s9 offen offset:1024 sc1
    s_branch LM_ownn_144
    LM_ownl_143:
    ds_write_b128 v3, v[120:123] offset:15360
    LM_ownn_144:
    v_cvt_pk_bf16_f32 v128, v128, v129
    v_cvt_pk_bf16_f32 v129, v130, v131
    v_cvt_pk_bf16_f32 v130, v132, v133
    v_cvt_pk_bf16_f32 v131, v134, v135
    s_cmp_eq_u32 s89, 0
    s_cbranch_scc1 LM_ownl_145
    buffer_store_dwordx4 v[128:131], v2, s[68:71], s9 offen offset:2048 sc1
    s_branch LM_ownn_146
    LM_ownl_145:
    ds_write_b128 v3, v[128:131] offset:16384
    LM_ownn_146:
    v_cvt_pk_bf16_f32 v136, v136, v137
    v_cvt_pk_bf16_f32 v137, v138, v139
    v_cvt_pk_bf16_f32 v138, v140, v141
    v_cvt_pk_bf16_f32 v139, v142, v143
    s_cmp_eq_u32 s89, 1
    s_cbranch_scc1 LM_ownl_147
    buffer_store_dwordx4 v[136:139], v2, s[68:71], s9 offen offset:3072 sc1
    s_branch LM_ownn_148
    LM_ownl_147:
    ds_write_b128 v3, v[136:139] offset:16384
    LM_ownn_148:
    v_cvt_pk_bf16_f32 v144, v144, v145
    v_cvt_pk_bf16_f32 v145, v146, v147
    v_cvt_pk_bf16_f32 v146, v148, v149
    v_cvt_pk_bf16_f32 v147, v150, v151
    s_add_u32 s9, s9, 4096
    s_cmp_eq_u32 s89, 0
    s_cbranch_scc1 LM_ownl_149
    buffer_store_dwordx4 v[144:147], v2, s[68:71], s9 offen offset:0 sc1
    s_branch LM_ownn_150
    LM_ownl_149:
    ds_write_b128 v3, v[144:147] offset:17408
    LM_ownn_150:
    v_cvt_pk_bf16_f32 v152, v152, v153
    v_cvt_pk_bf16_f32 v153, v154, v155
    v_cvt_pk_bf16_f32 v154, v156, v157
    v_cvt_pk_bf16_f32 v155, v158, v159
    s_cmp_eq_u32 s89, 1
    s_cbranch_scc1 LM_ownl_151
    buffer_store_dwordx4 v[152:155], v2, s[68:71], s9 offen offset:1024 sc1
    s_branch LM_ownn_152
    LM_ownl_151:
    ds_write_b128 v3, v[152:155] offset:17408
    LM_ownn_152:
    s_lshl_b32 s9, s4, 2
    s_add_u32 s9, s9, s7
    s_lshl_b32 s9, s9, 7
    s_lshl_b32 s10, s5, 2
    s_add_u32 s9, s9, s10
    s_add_u32 s9, s9, 524288
    v_mov_b32 v7, 1
    v_mov_b32 v10, 0
    s_lshl_b32 s10, s7, 2
    s_add_u32 s10, s10, 163792
    v_mov_b32 v6, s10
    ds_write_b32 v6, v7
    s_waitcnt vmcnt(0)
    s_mov_b64 exec, 1
    buffer_store_dword v7, v10, s[68:71], s9 offen sc1
    s_mov_b64 exec, -1
    s_waitcnt vmcnt(0)
LM_end:
    s_endpgm

.section .rodata,"a"

.p2align 6
.amdhsa_kernel parallel_sum__grouped_kv_mqa__dense_activation_squared_relu__prompt_kernel
  .amdhsa_next_free_vgpr 256
  .amdhsa_next_free_sgpr 100
  .amdhsa_accum_offset 256
  .amdhsa_group_segment_fixed_size 0
  .amdhsa_kernarg_size 104
  .amdhsa_user_sgpr_count 2
  .amdhsa_user_sgpr_kernarg_segment_ptr 1
  .amdhsa_system_sgpr_workgroup_id_x 1
.end_amdhsa_kernel
```
